```python
import torch

def _softmax(x, axis=-1):
    return torch.softmax(x, dim=axis)
def _gelu(x):
    return torch.nn.functional.gelu(x, approximate="tanh")
def _silu(x):
    return torch.nn.functional.silu(x)
def _sigmoid(x):
    return torch.sigmoid(x)
def _layernorm(x, axis=-1, eps=1e-5):
    m = x.mean(dim=axis, keepdim=True)
    v = x.var(dim=axis, keepdim=True, unbiased=False)
    return (x - m) / torch.sqrt(v + eps)
def _scatter_add(tgt, idx, src, axis=0):
    return tgt.clone().index_add_(axis, idx, src)
def _segment_sum(src, seg, n):
    out = torch.zeros((n,) + src.shape[1:], dtype=src.dtype)
    return out.index_add_(0, seg, src)
def _pad(x, pw):
    flat = tuple(v for pair in reversed(pw) for v in pair)
    return torch.nn.functional.pad(x, flat)

kernel_name = 'recurrent_scan__mha_block_cached__dense_activation_relu__prompt'

def setup_inputs():

    _w = (lambda a: (lambda t: t.to(torch.bfloat16) if t.is_floating_point() else t)(torch.as_tensor(a)))
    def _A_setup():
        B, Sq, D = 1, 2048, 1024
        H, Sk, Dh = 32, 2048, 128
        return {
            "x": _w((lambda *s: torch.randn(*s, dtype=torch.bfloat16) * 0.05)(B, Sq, D)),
            "k_cache": _w((lambda *s: torch.randn(*s, dtype=torch.bfloat16) * 0.8)(B, H, Sk, Dh)),
            "v_cache": _w((lambda *s: torch.randn(*s, dtype=torch.bfloat16) * 0.2)(B, H, Sk, Dh)),
            "wq": _w((lambda *s: torch.randn(*s, dtype=torch.bfloat16) * 0.8)(D, H * Dh) * (D ** -0.5)),
            "wo": _w((lambda *s: torch.randn(*s, dtype=torch.bfloat16) * 0.2)(H * Dh, D) * ((H * Dh) ** -0.5)),
        }
    _A_in = _A_setup()

    def _B_setup():
        B, S, D, Dff = 1, 2048, 1024, 3584
        return {
            "x": _w((lambda *s: torch.randn(*s, dtype=torch.bfloat16) * 0.05)(B, S, D)),
            "w1": _w((lambda *s: torch.randn(*s, dtype=torch.bfloat16) * 0.1)(D, Dff)),
            "w2": _w((lambda *s: torch.randn(*s, dtype=torch.bfloat16) * 0.1)(Dff, D)),
        }
    _B_in = _B_setup()

    return {
        "A_x": _A_in["x"],
        "A_k_cache": _A_in["k_cache"],
        "A_v_cache": _A_in["v_cache"],
        "A_wq": _A_in["wq"],
        "A_wo": _A_in["wo"],
        "B_x": _B_in["x"],
        "B_w1": _B_in["w1"],
        "B_w2": _B_in["w2"],
    }

def reference(A_x, A_k_cache, A_v_cache, A_wq, A_wo, B_x, B_w1, B_w2):
    def _A_ref(x, k_cache, v_cache, wq, wo):
        B, Sq, D = x.shape
        H, Dh = 32, 128
        q = (lambda x, *d: x.permute(*d))((x @ wq).reshape(B, Sq, H, Dh), 0, 2, 1, 3)
        scores = torch.einsum("bhqd,bhkd->bhqk", q, k_cache) * (Dh ** -0.5)
        p = _softmax(scores, axis=-1)
        o = torch.einsum("bhqk,bhkd->bhqd", p, v_cache)
        return (lambda x, *d: x.permute(*d))(o, 0, 2, 1, 3).reshape(B, Sq, H * Dh) @ wo

    def _B_ref(x, w1, w2):
        h = torch.einsum("bsd,df->bsf", x, w1)
        zero = torch.zeros_like(h)
        h = torch.maximum(h, zero)
        return torch.einsum("bsf,fd->bsd", h, w2)

    x = A_x
    xn = _layernorm(x, axis=-1)
    s = _A_ref(xn, A_k_cache, A_v_cache, A_wq, A_wo)
    g = _silu(_B_ref(xn, B_w1, B_w2))
    return x + s * g
```

```asm
; @launch grid=(256,1,1) block=(256,1,1) lds=163840
.amdgcn_target "amdgcn-amd-amdhsa--gfx950"
.text
.globl recurrent_scan__mha_block_cached__dense_activation_relu__prompt_kernel
.p2align 8
.type recurrent_scan__mha_block_cached__dense_activation_relu__prompt_kernel,@function
recurrent_scan__mha_block_cached__dense_activation_relu__prompt_kernel:
    s_cmp_ge_u32 s2, 256
    s_cbranch_scc1 L_end
    s_load_dwordx2 s[72:73], s[0:1], 0
    s_load_dwordx4 s[76:79], s[0:1], 64
    s_load_dwordx4 s[52:55], s[0:1], 8
    s_load_dwordx2 s[56:57], s[0:1], 24
    s_load_dwordx2 s[58:59], s[0:1], 48
    s_load_dwordx2 s[60:61], s[0:1], 80
    s_load_dwordx2 s[62:63], s[0:1], 32
    s_load_dwordx2 s[64:65], s[0:1], 56
    v_lshrrev_b32 v7, 6, v0
    v_and_b32 v6, 63, v0
    s_getpc_b64 s[84:85]
L_pc:
    s_bfe_u32 s4, s2, 0x30003
    s_lshl_b32 s4, s4, 11
    v_lshl_add_u32 v124, v0, 3, s4
    global_load_dword v124, v124, s[84:85]
    v_lshlrev_b32 v115, 4, v6
    s_and_b32 s4, s2, 7
    s_lshr_b32 s5, s2, 3
    v_readfirstlane_b32 s3, v7
    s_lshl_b32 s45, s4, 2
    s_and_b32 s4, s5, 3
    s_add_u32 s45, s45, s4
    s_lshr_b32 s46, s5, 2
    s_mov_b32 s49, s45
    s_lshl_b32 s4, s4, 1
    s_lshr_b32 s4, 0x78, s4
    s_and_b32 s4, s4, 3
    s_andn2_b32 s45, s45, 3
    s_or_b32 s45, s45, s4
    v_lshrrev_b32 v64, 4, v6
    v_and_b32 v65, 15, v6
    s_lshl_b32 s4, s3, 3
    v_lshlrev_b32 v66, 2, v64
    v_xor_b32 v65, v65, v66
    v_add_u32 v67, s4, v64
    v_lshlrev_b32 v66, 13, v67
    v_lshl_add_u32 v16, v65, 4, v66
    v_add_u32 v17, 32768, v16
    s_and_b32 s4, s3, 1
    s_lshl_b32 s4, s4, 2
    v_bfe_u32 v65, v6, 1, 3
    v_xor_b32 v65, v65, v64
    v_xor_b32 v65, s4, v65
    s_and_b32 s5, s49, 1
    s_movk_i32 s6, 7168
    v_add_u32 v66, s5, v65
    v_cmp_eq_u32 vcc, 7, v66
    v_mul_lo_u32 v67, v67, s6
    v_and_b32 v68, 1, v6
    v_cndmask_b32 v66, v66, 0, vcc
    v_cmp_eq_u32 vcc, 7, v65
    v_lshl_add_u32 v67, v66, 5, v67
    v_lshl_add_u32 v67, v68, 4, v67
    v_mov_b32 v66, 0x40000000
    v_cndmask_b32 v18, v67, v66, vcc
    v_add_u32 v19, 28672, v18
    s_lshl2_add_u32 s4, s46, s3
    s_lshl_b32 s4, s4, 17
    v_lshrrev_b32 v65, 3, v6
    v_and_b32 v66, 7, v6
    v_xor_b32 v66, v66, v64
    v_lshl_add_u32 v65, v65, 11, s4
    v_lshl_add_u32 v20, v66, 4, v65
    v_xor_b32 v65, 64, v20
    v_add_u32 v21, 15360, v65
    s_lshl_b32 s42, s3, 11
    s_add_u32 s41, s42, 0x10000
    s_bfe_u32 s4, s2, 0x20003
    s_lshl_b32 s11, s4, 15
    s_lshl2_add_u32 s5, s3, s4
    s_lshl_b32 s5, s5, 11
    s_add_u32 s68, s5, 0x8000
    s_and_b32 s4, s46, 3
    s_lshl_b32 s4, s4, 1
    s_sub_u32 s34, s4, 1
    s_and_b32 s4, s2, 3
    s_lshl_b32 s35, s4, 3
    s_mov_b32 s33, -1
    s_add_u32 s33, s33, 2
    s_mov_b32 s4, s33
    s_add_u32 s5, s4, s35
    s_and_b32 s5, s5, 24
    s_add_u32 s4, s4, s34
    s_and_b32 s4, s4, 6
    s_or_b32 s32, s4, s5
    s_lshl_b32 s4, s32, 6
    s_or_b32 s40, s4, s11
    s_lshl_b32 s37, s32, 18
    s_add_u32 s100, s37, 0x40000
    s_mul_i32 s38, s32, 229376
    s_add_u32 s101, s38, 229376
    s_mov_b32 s39, s40
    s_add_u32 s33, s33, 2
    s_mov_b32 s4, s33
    s_add_u32 s5, s4, s35
    s_and_b32 s5, s5, 24
    s_add_u32 s4, s4, s34
    s_and_b32 s4, s4, 6
    s_or_b32 s32, s4, s5
    s_lshl_b32 s4, s32, 6
    s_or_b32 s40, s4, s11
    s_cmp_lt_u32 s46, 4
    s_cselect_b32 s5, 0, 16384
    s_cselect_b32 s4, s37, s100
    s_cselect_b32 s100, s100, s37
    s_cselect_b32 s6, s38, s101
    s_cselect_b32 s101, s101, s38
    s_mov_b32 s37, s4
    s_mov_b32 s38, s6
    s_mov_b32 s4, s5
    s_add_u32 s9, s41, s4
    s_waitcnt lgkmcnt(0)
    s_mov_b32 s72, s72
    s_and_b32 s73, s73, 0xffff
    s_mov_b32 s74, 0x400000
    s_mov_b32 s75, 0x20000
    s_xor_b32 m0, s68, 0x0
    s_nop 0
    buffer_load_dwordx4 v20, s[72:75], s39 offen offset:0 lds
    buffer_load_dwordx4 v21, s[72:75], s39 offen offset:1024 lds
    s_lshl_b32 s4, s45, 8
    s_add_u32 s12, s56, s4
    s_addc_u32 s13, s57, 0
    s_and_b32 s13, s13, 0xffff
    s_sub_u32 s14, 0x800000, s4
    s_mov_b32 s15, 0x20000
    s_mul_i32 s4, s49, 224
    s_add_u32 s16, s58, s4
    s_addc_u32 s17, s59, 0
    s_and_b32 s17, s17, 0xffff
    s_sub_u32 s18, 0x700000, s4
    s_mov_b32 s19, 0x20000
    s_xor_b32 m0, s9, 0
    s_nop 0
    buffer_load_dwordx4 v16, s[12:15], s37 offen lds
    s_xor_b32 m0, s9, 1024
    s_nop 0
    buffer_load_dwordx4 v17, s[12:15], s37 offen lds
    s_xor_b32 m0, s9, 8192
    s_nop 0
    buffer_load_dwordx4 v18, s[16:19], s38 offen lds
    s_xor_b32 m0, s9, 9216
    s_nop 0
    buffer_load_dwordx4 v19, s[16:19], s38 offen lds
    s_xor_b32 m0, s68, 0x28000
    s_nop 0
    buffer_load_dwordx4 v20, s[72:75], s40 offen offset:0 lds
    buffer_load_dwordx4 v21, s[72:75], s40 offen offset:1024 lds
    s_lshr_b32 s4, s2, 1
    s_and_b32 s4, s4, 28
    s_add_u32 s4, s4, s3
    s_min_u32 s4, s4, (L_r2-L_r1)/1024
    s_lshl_b32 s4, s4, 10
    s_add_u32 s4, s4, L_r1-L_pc
    s_add_u32 s0, s84, s4
    s_addc_u32 s1, s85, 0
    s_cmp_lt_u32 s3, 2
    s_cselect_b64 s[84:85], s[12:13], s[16:17]
    s_cselect_b32 s86, s14, s18
    s_mov_b32 s87, 0x20000
    s_mov_b32 s80, s78
    s_and_b32 s81, s79, 0xffff
    s_mov_b32 s82, 0x100
    s_mov_b32 s83, 0x20000
    v_mov_b32 v72, 0
    v_mov_b32 v73, 0
    v_mov_b32 v74, 0
    v_mov_b32 v75, 0
    v_bfe_u32 v65, v6, 2, 2
    v_and_b32 v66, 3, v6
    v_lshl_add_u32 v67, v64, 3, v65
    v_lshlrev_b32 v67, 8, v67
    v_mfma_f32_16x16x32_bf16 a[0:3], v[72:75], v[72:75], 0
    v_add_u32 v67, 0x10000, v67
    v_lshl_add_u32 v68, v65, 6, v67
    v_lshl_add_u32 v68, v66, 4, v68
    v_xor_b32 v8, 0, v68
    v_mfma_f32_16x16x32_bf16 a[4:7], v[72:75], v[72:75], 0
    v_xor_b32 v9, 64, v68
    v_xor_b32 v10, 128, v68
    v_xor_b32 v11, 192, v68
    v_and_b32 v68, 1, v64
    v_mfma_f32_16x16x32_bf16 a[8:11], v[72:75], v[72:75], 0
    v_lshl_add_u32 v68, v68, 2, v65
    v_lshl_add_u32 v68, v68, 5, v67
    v_lshl_add_u32 v68, v66, 3, v68
    v_xor_b32 v12, 0, v68
    v_mfma_f32_16x16x32_bf16 a[12:15], v[72:75], v[72:75], 0
    v_xor_b32 v13, 32, v68
    v_xor_b32 v14, 64, v68
    v_xor_b32 v15, 96, v68
    v_xor_b32 v2, 128, v68
    v_mfma_f32_16x16x32_bf16 a[16:19], v[72:75], v[72:75], 0
    v_xor_b32 v3, 160, v68
    v_xor_b32 v4, 192, v68
    v_and_b32 v68, 1, v64
    v_lshlrev_b32 v68, 9, v68
    v_mfma_f32_16x16x32_bf16 a[20:23], v[72:75], v[72:75], 0
    v_lshrrev_b32 v69, 1, v64
    v_lshl_add_u32 v68, v69, 12, v68
    v_and_b32 v65, 15, v6
    v_lshl_add_u32 v1, v65, 4, v68
    v_mfma_f32_16x16x32_bf16 a[24:27], v[72:75], v[72:75], 0
    s_lshr_b32 s4, s46, 2
    s_lshl_b32 s4, s4, 8
    s_add_u32 s4, s4, s3
    s_lshl_b32 s4, s4, 6
    v_mfma_f32_16x16x32_bf16 a[28:31], v[72:75], v[72:75], 0
    s_cmp_eq_u32 s3, 3
    s_cselect_b32 s5, 0, 32
    s_add_u32 s5, s5, s4
    v_xor_b32 v28, s4, v8
    v_mfma_f32_16x16x32_bf16 a[32:35], v[72:75], v[72:75], 0
    v_xor_b32 v29, s4, v12
    v_xor_b32 v30, s5, v12
    v_mov_b32 v68, 0x3f803f80
    v_cmp_eq_u32 vcc, 0, v65
    v_mfma_f32_16x16x32_bf16 a[36:39], v[72:75], v[72:75], 0
    s_nop 0
    s_nop 0
    v_cndmask_b32 v69, 0, v68, vcc
    v_accvgpr_write_b32 a208, v69
    v_mfma_f32_16x16x32_bf16 a[40:43], v[72:75], v[72:75], 0
    v_accvgpr_write_b32 a209, v69
    v_accvgpr_write_b32 a210, v69
    v_accvgpr_write_b32 a211, v69
    v_cmp_eq_u32 vcc, 4, v65
    v_mfma_f32_16x16x32_bf16 a[44:47], v[72:75], v[72:75], 0
    s_nop 0
    s_nop 0
    v_cndmask_b32 v69, 0, v68, vcc
    v_accvgpr_write_b32 a212, v69
    v_mfma_f32_16x16x32_bf16 a[48:51], v[72:75], v[72:75], 0
    v_accvgpr_write_b32 a213, v69
    v_accvgpr_write_b32 a214, v69
    v_accvgpr_write_b32 a215, v69
    v_cmp_eq_u32 vcc, 8, v65
    v_mfma_f32_16x16x32_bf16 a[52:55], v[72:75], v[72:75], 0
    s_nop 0
    s_nop 0
    v_cndmask_b32 v69, 0, v68, vcc
    v_accvgpr_write_b32 a216, v69
    v_mfma_f32_16x16x32_bf16 a[56:59], v[72:75], v[72:75], 0
    v_accvgpr_write_b32 a217, v69
    v_accvgpr_write_b32 a218, v69
    v_accvgpr_write_b32 a219, v69
    v_cmp_eq_u32 vcc, 12, v65
    v_mfma_f32_16x16x32_bf16 a[60:63], v[72:75], v[72:75], 0
    s_nop 0
    s_nop 0
    v_cndmask_b32 v69, 0, v68, vcc
    v_accvgpr_write_b32 a220, v69
    v_mfma_f32_16x16x32_bf16 a[64:67], v[72:75], v[72:75], 0
    v_accvgpr_write_b32 a221, v69
    v_accvgpr_write_b32 a222, v69
    v_accvgpr_write_b32 a223, v69
    v_and_b32 v69, 2, v6
    v_mfma_f32_16x16x32_bf16 a[68:71], v[72:75], v[72:75], 0
    v_cmp_eq_u32 vcc, 0, v69
    v_and_b32 v0, 1, v6
    v_mul_u32_u24 v0, 0xaaaa, v0
    v_cndmask_b32 v69, 0, v68, vcc
    v_mfma_f32_16x16x32_bf16 a[72:75], v[72:75], v[72:75], 0
    v_add_u32 v0, 0x4444, v0
    v_accvgpr_write_b32 a160, v69
    v_accvgpr_write_b32 a161, v69
    v_accvgpr_write_b32 a162, v69
    v_mfma_f32_16x16x32_bf16 a[76:79], v[72:75], v[72:75], 0
    v_accvgpr_write_b32 a163, v69
    v_lshl_or_b32 v0, v0, 16, v0
    s_lshl2_add_u32 s6, s46, 32
    v_cmp_gt_u32 vcc, 8, v6
    v_mfma_f32_16x16x32_bf16 a[80:83], v[72:75], v[72:75], 0
    v_mov_b32 v23, 0x40000000
    v_lshl_add_u32 v127, v6, 2, 32
    v_cndmask_b32 v5, 0, 32, vcc
    v_cndmask_b32 v127, v23, v127, vcc
    v_mfma_f32_16x16x32_bf16 a[84:87], v[72:75], v[72:75], 0
    v_mov_b32 v31, v23
    v_writelane_b32 v23, s6, 0
    v_writelane_b32 v31, 0, 31
    v_writelane_b32 v31, 16, 63
    v_mfma_f32_16x16x32_bf16 a[88:91], v[72:75], v[72:75], 0
    v_lshrrev_b32 v22, 5, v6
    v_and_b32 v69, 31, v6
    v_lshlrev_b32 v22, 11, v22
    v_lshl_add_u32 v22, v69, 4, v22
    v_mfma_f32_16x16x32_bf16 a[92:95], v[72:75], v[72:75], 0
    v_bfe_u32 v66, v6, 1, 3
    v_xor_b32 v66, v66, v64
    s_lshl_b32 s4, s3, 13
    v_lshl_add_u32 v67, v65, 7, s4
    v_mfma_f32_16x16x32_bf16 a[96:99], v[72:75], v[72:75], 0
    v_lshl_add_u32 v67, v66, 4, v67
    v_add_u32 v24, 0x8000, v67
    v_add_u32 v26, 0x20000, v67
    v_xor_b32 v25, 64, v24
    v_mfma_f32_16x16x32_bf16 a[100:103], v[72:75], v[72:75], 0
    v_xor_b32 v27, 64, v26
    v_xor_b32 v66, v64, v65
    v_lshlrev_b32 v67, 8, v65
    v_lshl_add_u32 v67, v66, 4, v67
    v_mfma_f32_16x16x32_bf16 a[104:107], v[72:75], v[72:75], 0
    v_xor_b32 v100, 0, v67
    v_xor_b32 v101, 64, v67
    v_xor_b32 v102, 128, v67
    v_xor_b32 v103, 192, v67
    v_mfma_f32_16x16x32_bf16 a[108:111], v[72:75], v[72:75], 0
    v_lshrrev_b32 v68, 2, v6
    v_and_b32 v69, 3, v6
    v_and_b32 v70, 7, v68
    v_lshlrev_b32 v71, 8, v68
    v_mfma_f32_16x16x32_bf16 a[144:147], v[72:75], v[72:75], 0
    v_lshl_add_u32 v71, v70, 5, v71
    v_lshl_add_u32 v71, v69, 3, v71
    v_add_u32 v71, 0x10000, v71
    v_xor_b32 v104, 0, v71
    v_mfma_f32_16x16x32_bf16 v[128:131], v[72:75], v[72:75], 0
    v_xor_b32 v105, 32, v71
    v_xor_b32 v106, 64, v71
    v_xor_b32 v107, 96, v71
    v_xor_b32 v108, 128, v71
    v_mfma_f32_16x16x32_bf16 v[132:135], v[72:75], v[72:75], 0
    v_xor_b32 v109, 160, v71
    v_xor_b32 v110, 192, v71
    v_xor_b32 v111, 224, v71
    v_lshrrev_b32 v68, 4, v6
    v_mfma_f32_16x16x32_bf16 v[136:139], v[72:75], v[72:75], 0
    v_and_b32 v69, 15, v6
    s_lshl_b32 s4, s3, 3
    v_add_u32 v68, s4, v68
    v_add_u32 v70, 0, v68
    v_mfma_f32_16x16x32_bf16 v[140:143], v[72:75], v[72:75], 0
    v_and_b32 v70, 15, v70
    v_xor_b32 v70, v70, v69
    v_lshlrev_b32 v71, 8, v68
    v_lshl_add_u32 v112, v70, 4, v71
    v_mfma_f32_16x16x32_bf16 v[144:147], v[72:75], v[72:75], 0
    v_add_u32 v70, 4, v68
    v_and_b32 v70, 15, v70
    v_xor_b32 v70, v70, v69
    v_lshlrev_b32 v71, 8, v68
    v_mfma_f32_16x16x32_bf16 v[148:151], v[72:75], v[72:75], 0
    v_lshl_add_u32 v113, v70, 4, v71
    v_lshrrev_b32 v70, 4, v6
    v_bfe_u32 v69, v6, 1, 3
    v_xor_b32 v70, v70, v69
    v_mfma_f32_16x16x32_bf16 v[152:155], v[72:75], v[72:75], 0
    v_lshlrev_b32 v71, 8, v68
    v_lshl_add_u32 v71, v70, 5, v71
    v_and_b32 v69, 1, v6
    v_lshl_add_u32 v114, v69, 4, v71
    v_mfma_f32_16x16x32_bf16 v[156:159], v[72:75], v[72:75], 0
    v_xor_b32 v125, 128, v114
    s_mov_b32 s44, 0x53800000
    s_lshl_b32 s4, s46, 1
    s_lshr_b32 s5, s3, 1
    v_mfma_f32_16x16x32_bf16 v[160:163], v[72:75], v[72:75], 0
    s_add_u32 s4, s4, s5
    s_and_b32 s5, s3, 1
    s_lshl_b32 s6, s4, 5
    s_add_u32 s6, s6, s45
    s_lshl1_add_u32 s6, s6, s5
    v_mfma_f32_16x16x32_bf16 v[164:167], v[72:75], v[72:75], 0
    s_lshl_b32 s6, s6, 1
    s_add_u32 s71, s6, 0x2600000
    s_lshl_b32 s5, s5, 12
    v_mfma_f32_16x16x32_bf16 v[168:171], v[72:75], v[72:75], 0
    s_mul_i32 s6, s49, 7
    s_add_u32 s6, s6, 1
    s_lshr_b32 s6, s6, 1
    s_mul_i32 s7, s4, 112
    v_mfma_f32_16x16x32_bf16 v[172:175], v[72:75], v[72:75], 0
    s_add_u32 s7, s7, s6
    s_lshl_b32 s7, s7, 13
    s_add_u32 s7, s7, s5
    s_add_u32 s47, s7, 0x400000
    s_and_b32 s6, s49, 1
    v_mfma_f32_16x16x32_bf16 v[176:179], v[72:75], v[72:75], 0
    s_cmp_eq_u32 s6, 0
    s_mov_b32 s6, 0x6000
    s_cselect_b32 s6, s6, 0xffffe008
    v_mfma_f32_16x16x32_bf16 v[180:183], v[72:75], v[72:75], 0
    s_add_u32 s48, s47, s6
    s_lshl_b32 s7, s4, 7
    s_lshl_b32 s6, s45, 2
    s_add_u32 s7, s7, s6
    s_lshl_b32 s7, s7, 13
    v_mfma_f32_16x16x32_bf16 v[184:187], v[72:75], v[72:75], 0
    s_add_u32 s7, s7, s5
    s_add_u32 s49, s7, 0x1200000
    s_mov_b32 s88, s64
    v_mfma_f32_16x16x32_bf16 v[188:191], v[72:75], v[72:75], 0
    s_and_b32 s89, s65, 0xffff
    s_mov_b32 s90, 0x700000
    s_mov_b32 s91, 0x20000
    s_cmp_lt_u32 s3, 2
    v_mfma_f32_16x16x32_bf16 v[192:195], v[72:75], v[72:75], 0
    s_movk_i32 s4, 7168
    s_cselect_b32 s4, 8192, s4
    s_and_b32 s5, s3, 1
    s_lshl_b32 s5, s5, 4
    v_mfma_f32_16x16x32_bf16 v[196:199], v[72:75], v[72:75], 0
    v_lshrrev_b32 v68, 2, v6
    v_add_u32 v68, s5, v68
    v_mul_lo_u32 v68, v68, s4
    v_and_b32 v69, 3, v6
    v_mfma_f32_16x16x32_bf16 v[200:203], v[72:75], v[72:75], 0
    v_lshl_add_u32 v126, v69, 6, v68
    v_and_b32 v69, 1, v6
    v_cmp_eq_u32 vcc, 0, v69
    v_mov_b32 v68, 0x40000000
    v_mfma_f32_16x16x32_bf16 v[204:207], v[72:75], v[72:75], 0
    s_nop 0
    v_cndmask_b32 v126, v68, v126, vcc
    s_lshl_b32 s4, s2, 2
    s_add_u32 s4, s4, s3
    s_lshl_b32 s66, s4, 13
    v_mfma_f32_16x16x32_bf16 v[208:211], v[72:75], v[72:75], 0
    s_mul_i32 s67, s4, 7168
    s_mov_b32 s28, s60
    s_and_b32 s29, s61, 0xffff
    v_mfma_f32_16x16x32_bf16 v[212:215], v[72:75], v[72:75], 0
    s_mov_b32 s30, 0x10000000
    s_mov_b32 s31, 0x20000
    s_lshl_b32 s4, s45, 19
    s_add_u32 s20, s52, s4
    s_addc_u32 s21, s53, 0
    v_mfma_f32_16x16x32_bf16 v[216:219], v[72:75], v[72:75], 0
    s_and_b32 s21, s21, 0xffff
    s_sub_u32 s22, 0x1000000, s4
    s_mov_b32 s23, 0x20000
    v_mfma_f32_16x16x32_bf16 v[220:223], v[72:75], v[72:75], 0
    s_add_u32 s24, s54, s4
    s_addc_u32 s25, s55, 0
    s_and_b32 s25, s25, 0xffff
    s_sub_u32 s26, 0x1000000, s4
    v_mfma_f32_16x16x32_bf16 v[224:227], v[72:75], v[72:75], 0
    s_mov_b32 s27, 0x20000
    s_mov_b32 s22, 0x80000
    s_mov_b32 s76, s76
    s_and_b32 s77, s77, 0xffff
    v_mfma_f32_16x16x32_bf16 v[228:231], v[72:75], v[72:75], 0
    s_mov_b32 s78, 0x400000
    s_mov_b32 s79, 0x20000
    s_lshl_b32 s4, s2, 14
    s_lshl_b32 s5, s3, 12
    v_mfma_f32_16x16x32_bf16 v[232:235], v[72:75], v[72:75], 0
    s_add_u32 s4, s4, s5
    s_add_u32 s69, s4, 0x2200000
    s_add_u32 s52, s5, 0
    s_add_u32 s53, s5, 16384
    s_add_u32 s54, s5, 32768
    s_add_u32 s55, s5, 49152
    s_add_u32 s56, s5, 65536
    s_add_u32 s57, s5, 81920
    s_add_u32 s58, s5, 98304
    s_add_u32 s59, s5, 114688
    s_lshr_b32 s4, s3, 1
    v_mfma_f32_16x16x32_bf16 v[236:239], v[72:75], v[72:75], 0
    s_lshl_b32 s4, s4, 13
    v_mfma_f32_16x16x32_bf16 v[240:243], v[72:75], v[72:75], 0
    s_add_u32 s4, s4, 2048
    v_add_u32 v68, s4, v115
    v_add_u32 v69, 0x10000, v68
    v_add_u32 v70, s42, v115
    v_mfma_f32_16x16x32_bf16 v[244:247], v[72:75], v[72:75], 0
    v_accvgpr_write_b32 a132, v68
    v_accvgpr_write_b32 a133, v69
    v_accvgpr_write_b32 a130, v70
    v_lshrrev_b32 v64, 5, v6
    v_mfma_f32_16x16x32_bf16 v[248:251], v[72:75], v[72:75], 0
    v_bfe_u32 v65, v6, 2, 3
    v_and_b32 v66, 3, v6
    v_lshlrev_b32 v67, 12, v64
    v_lshl_add_u32 v67, v65, 8, v67
    v_mfma_f32_16x16x32_bf16 v[252:255], v[72:75], v[72:75], 0
    v_lshl_add_u32 v67, v65, 5, v67
    v_lshl_add_u32 v67, v66, 3, v67
    s_and_b32 s4, s3, 1
    s_lshl_b32 s4, s4, 7
    v_xor_b32 v67, s4, v67
    v_xor_b32 v68, 0, v67
    v_add_u32 v69, 0x10000, v68
    v_accvgpr_write_b32 a134, v68
    v_accvgpr_write_b32 a138, v69
    v_xor_b32 v68, 32, v67
    v_add_u32 v69, 0x10000, v68
    v_accvgpr_write_b32 a135, v68
    v_accvgpr_write_b32 a139, v69
    v_xor_b32 v68, 64, v67
    v_add_u32 v69, 0x10000, v68
    v_accvgpr_write_b32 a136, v68
    v_accvgpr_write_b32 a140, v69
    v_xor_b32 v68, 96, v67
    v_add_u32 v69, 0x10000, v68
    v_accvgpr_write_b32 a137, v68
    v_accvgpr_write_b32 a141, v69
    v_lshrrev_b32 v64, 4, v6
    v_bfe_u32 v65, v6, 1, 3
    v_and_b32 v66, 1, v6
    s_lshl_b32 s4, s3, 3
    v_add_u32 v67, 0, v64
    v_xor_b32 v68, v65, v67
    v_add_u32 v67, s4, v67
    v_lshlrev_b32 v67, 11, v67
    v_lshl_add_u32 v67, v68, 5, v67
    v_lshl_add_u32 v67, v66, 4, v67
    v_subrev_u32 v67, 0, v67
    v_accvgpr_write_b32 a128, v67
    v_add_u32 v67, 4, v64
    v_xor_b32 v68, v65, v67
    v_add_u32 v67, s4, v67
    v_lshlrev_b32 v67, 11, v67
    v_lshl_add_u32 v67, v68, 5, v67
    v_lshl_add_u32 v67, v66, 4, v67
    v_subrev_u32 v67, 1024, v67
    v_accvgpr_write_b32 a129, v67
    v_and_b32 v65, 12, v6
    v_add_u32 v67, v65, v64
    v_lshlrev_b32 v67, 11, v67
    s_lshr_b32 s5, s3, 1
    s_lshl_b32 s4, s5, 17
    s_and_b32 s5, s3, 1
    s_lshl_b32 s5, s5, 7
    s_add_u32 s4, s4, s5
    v_add_u32 v67, s4, v67
    v_and_b32 v66, 3, v6
    v_lshl_add_u32 v68, v66, 4, v65
    v_add_u32 v68, v68, v64
    v_lshlrev_b32 v68, 2, v68
    v_and_b32 v65, 1, v6
    v_bfe_u32 v66, v6, 1, 1
    v_lshl_add_u32 v67, v65, 5, v67
    v_lshl_add_u32 v67, v66, 4, v67
    v_accvgpr_write_b32 a131, v68
    v_accvgpr_write_b32 a142, v67
    s_and_b32 s4, s2, 31
    s_lshl_b32 s4, s4, 13
    s_lshl_b32 s5, s3, 10
    s_add_u32 s4, s4, s5
    s_lshr_b32 s5, s46, 2
    s_lshl_b32 s5, s5, 8
    s_add_u32 s4, s4, s5
    s_and_b32 s5, s46, 3
    s_lshl2_add_u32 s4, s5, s4
    s_add_u32 s10, s4, 0x20000
    s_mov_b32 s70, 0
    s_and_b32 s4, s46, 1
    s_lshl_b32 s4, s4, 1
    s_lshl_b32 s51, 0x22080, s4
    s_lshr_b32 s4, s46, 2
    s_add_u32 s4, s4, 1
    s_add_u32 s45, s34, s4
    s_mov_b32 s50, 229376
    s_cmp_lt_u32 s3, 2
    s_cselect_b32 s50, 262144, s50
    s_bfe_u32 s4, s2, 0x10003
    s_lshl1_add_u32 s4, s4, 27
    s_cmp_eq_u32 s3, 0
    s_cselect_b32 s8, s4, 0
    s_mov_b32 s43, 0x7fffa000
    s_xor_b32 m0, s9, 16384
    s_nop 0
    buffer_load_dwordx4 v16, s[12:15], s100 offen lds
    s_xor_b32 m0, s9, 17408
    s_nop 0
    buffer_load_dwordx4 v17, s[12:15], s100 offen lds
    s_xor_b32 m0, s9, 24576
    s_nop 0
    buffer_load_dwordx4 v18, s[16:19], s101 offen lds
    s_xor_b32 m0, s9, 25600
    s_nop 0
    buffer_load_dwordx4 v19, s[16:19], s101 offen lds
    s_xor_b32 s36, s39, 0x8000
    s_xor_b32 m0, s68, 0x800
    s_nop 0
    buffer_load_dwordx4 v20, s[72:75], s36 offen offset:0 lds
    buffer_load_dwordx4 v21, s[72:75], s36 offen offset:1024 lds
    s_xor_b32 s36, s39, 0x10000
    s_xor_b32 m0, s68, 0x1000
    s_nop 0
    buffer_load_dwordx4 v20, s[72:75], s36 offen offset:0 lds
    buffer_load_dwordx4 v21, s[72:75], s36 offen offset:1024 lds
    s_xor_b32 s36, s39, 0x18000
    s_xor_b32 m0, s68, 0x1800
    s_nop 0
    buffer_load_dwordx4 v20, s[72:75], s36 offen offset:0 lds
    buffer_load_dwordx4 v21, s[72:75], s36 offen offset:1024 lds
    s_lshl_b32 s37, s32, 18
    s_add_u32 s100, s37, 0x40000
    s_mul_i32 s38, s32, 229376
    s_add_u32 s101, s38, 229376
    s_lshl2_add_u32 s39, s2, s3
    s_lshl_b32 s39, s39, 5
    s_waitcnt vmcnt(0)
    s_barrier
    ds_read_b64_tr_b16 a[164:165], v8 offset:0
    ds_read_b64_tr_b16 a[166:167], v8 offset:1024
    ds_read_b64_tr_b16 a[168:169], v8 offset:16384
    ds_read_b64_tr_b16 a[170:171], v8 offset:17408
    ds_read_b128 v[32:35], v24 offset:0
    ds_read_b128 v[48:51], v25 offset:0
    ds_read_b128 v[36:39], v24 offset:2048
    ds_read_b128 v[52:55], v25 offset:2048
    ds_read_b128 v[40:43], v24 offset:4096
    ds_read_b128 v[56:59], v25 offset:4096
    ds_read_b128 v[44:47], v24 offset:6144
    ds_read_b128 v[60:63], v25 offset:6144
    ds_read_b64_tr_b16 a[172:173], v8 offset:8
    ds_read_b64_tr_b16 a[174:175], v8 offset:1032
    ds_read_b64_tr_b16 a[176:177], v8 offset:16392
    ds_read_b64_tr_b16 a[178:179], v8 offset:17416
    s_add_u32 m0, s41, 32768
    s_nop 0
    buffer_load_dwordx4 v16, s[12:15], s37 offen lds
    s_add_u32 m0, s41, 33792
    s_nop 0
    buffer_load_dwordx4 v17, s[12:15], s37 offen lds
    s_xor_b32 s36, s40, 0x8000
    s_xor_b32 m0, s68, 0x28800
    s_nop 0
    buffer_load_dwordx4 v20, s[72:75], s36 offen offset:0 lds
    buffer_load_dwordx4 v21, s[72:75], s36 offen offset:1024 lds
    s_xor_b32 s36, s40, 0x10000
    s_xor_b32 m0, s68, 0x29000
    s_nop 0
    buffer_load_dwordx4 v20, s[72:75], s36 offen offset:0 lds
    buffer_load_dwordx4 v21, s[72:75], s36 offen offset:1024 lds
    s_xor_b32 s36, s40, 0x18000
    s_xor_b32 m0, s68, 0x29800
    s_nop 0
    buffer_load_dwordx4 v20, s[72:75], s36 offen offset:0 lds
    buffer_load_dwordx4 v21, s[72:75], s36 offen offset:1024 lds
    s_waitcnt lgkmcnt(4)
.p2align 6
L_ph1:
    v_mfma_f32_16x16x32_bf16 v[128:131], a[164:167], v[32:35], v[128:131]
    s_add_u32 s33, s33, 2
    ds_read_b64_tr_b16 a[180:181], v9 offset:0
    v_mfma_f32_16x16x32_bf16 v[128:131], a[168:171], v[48:51], v[128:131]
    s_add_u32 m0, s41, 40960
    ds_read_b64_tr_b16 a[182:183], v9 offset:1024
    v_mfma_f32_16x16x32_bf16 v[132:135], a[164:167], v[36:39], v[132:135]
    buffer_load_dwordx4 v18, s[16:19], s38 offen lds
    v_mfma_f32_16x16x32_bf16 v[132:135], a[168:171], v[52:55], v[132:135]
    s_lshr_b32 s4, s33, 1
    s_xor_b32 s4, s4, s33
    v_mfma_f32_16x16x32_bf16 v[136:139], a[164:167], v[40:43], v[136:139]
    s_lshr_b32 s5, s33, 2
    ds_read_b64_tr_b16 a[184:185], v9 offset:16384
    v_mfma_f32_16x16x32_bf16 v[136:139], a[168:171], v[56:59], v[136:139]
    s_add_u32 m0, s41, 41984
    ds_read_b64_tr_b16 a[186:187], v9 offset:17408
    v_mfma_f32_16x16x32_bf16 v[140:143], a[164:167], v[44:47], v[140:143]
    buffer_load_dwordx4 v19, s[16:19], s38 offen lds
    v_mfma_f32_16x16x32_bf16 v[140:143], a[168:171], v[60:63], v[140:143]
    s_waitcnt lgkmcnt(4)
    v_mfma_f32_16x16x32_bf16 v[144:147], a[172:175], v[32:35], v[144:147]
    s_and_b32 s4, s4, s5
    ds_read_b64_tr_b16 a[164:165], v9 offset:8
    v_mfma_f32_16x16x32_bf16 v[144:147], a[176:179], v[48:51], v[144:147]
    s_and_b32 s4, s4, 4
    ds_read_b64_tr_b16 a[166:167], v9 offset:1032
    v_mfma_f32_16x16x32_bf16 v[148:151], a[172:175], v[36:39], v[148:151]
    s_add_u32 m0, s41, 49152
    s_mul_i32 s4, s4, 3
    v_mfma_f32_16x16x32_bf16 v[148:151], a[176:179], v[52:55], v[148:151]
    buffer_load_dwordx4 v16, s[12:15], s100 offen lds
    v_mfma_f32_16x16x32_bf16 v[152:155], a[172:175], v[40:43], v[152:155]
    s_xor_b32 s4, s4, s33
    ds_read_b64_tr_b16 a[168:169], v9 offset:16392
    v_mfma_f32_16x16x32_bf16 v[152:155], a[176:179], v[56:59], v[152:155]
    s_add_u32 s5, s4, s35
    ds_read_b64_tr_b16 a[170:171], v9 offset:17416
    v_mfma_f32_16x16x32_bf16 v[156:159], a[172:175], v[44:47], v[156:159]
    s_and_b32 s5, s5, 24
    s_add_u32 s4, s4, s34
    v_mfma_f32_16x16x32_bf16 v[156:159], a[176:179], v[60:63], v[156:159]
    s_waitcnt lgkmcnt(4)
    v_mfma_f32_16x16x32_bf16 v[160:163], a[180:183], v[32:35], v[160:163]
    s_and_b32 s4, s4, 6
    ds_read_b64_tr_b16 a[172:173], v10 offset:0
    v_mfma_f32_16x16x32_bf16 v[160:163], a[184:187], v[48:51], v[160:163]
    s_add_u32 m0, s41, 50176
    ds_read_b64_tr_b16 a[174:175], v10 offset:1024
    v_mfma_f32_16x16x32_bf16 v[164:167], a[180:183], v[36:39], v[164:167]
    buffer_load_dwordx4 v17, s[12:15], s100 offen lds
    v_mfma_f32_16x16x32_bf16 v[164:167], a[184:187], v[52:55], v[164:167]
    s_or_b32 s32, s4, s5
    s_lshl_b32 s4, s32, 6
    v_mfma_f32_16x16x32_bf16 v[168:171], a[180:183], v[40:43], v[168:171]
    s_or_b32 s40, s4, s11
    ds_read_b64_tr_b16 a[176:177], v10 offset:16384
    v_mfma_f32_16x16x32_bf16 v[168:171], a[184:187], v[56:59], v[168:171]
    s_add_u32 m0, s41, 57344
    ds_read_b64_tr_b16 a[178:179], v10 offset:17408
    v_mfma_f32_16x16x32_bf16 v[172:175], a[180:183], v[44:47], v[172:175]
    buffer_load_dwordx4 v18, s[16:19], s101 offen lds
    v_mfma_f32_16x16x32_bf16 v[172:175], a[184:187], v[60:63], v[172:175]
    s_waitcnt lgkmcnt(4)
    v_mfma_f32_16x16x32_bf16 v[176:179], a[164:167], v[32:35], v[176:179]
    s_cmp_eq_u32 s33, s8
    ds_read_b64_tr_b16 a[180:181], v10 offset:8
    v_mfma_f32_16x16x32_bf16 v[176:179], a[168:171], v[48:51], v[176:179]
    s_cselect_b32 s5, 0, 0x40000000
    ds_read_b64_tr_b16 a[182:183], v10 offset:1032
    v_mfma_f32_16x16x32_bf16 v[180:183], a[164:167], v[36:39], v[180:183]
    s_add_u32 m0, s41, 58368
    v_mfma_f32_16x16x32_bf16 v[180:183], a[168:171], v[52:55], v[180:183]
    buffer_load_dwordx4 v19, s[16:19], s101 offen lds
    v_mfma_f32_16x16x32_bf16 v[184:187], a[164:167], v[40:43], v[184:187]
    ds_read_b64_tr_b16 a[184:185], v10 offset:16392
    v_mfma_f32_16x16x32_bf16 v[184:187], a[168:171], v[56:59], v[184:187]
    s_lshl1_add_u32 s7, s33, -10
    ds_read_b64_tr_b16 a[186:187], v10 offset:17416
    v_mfma_f32_16x16x32_bf16 v[188:191], a[164:167], v[44:47], v[188:191]
    buffer_atomic_add v5, v23, s[80:83], s5 offen sc1
    v_mfma_f32_16x16x32_bf16 v[188:191], a[168:171], v[60:63], v[188:191]
    s_waitcnt lgkmcnt(4)
    v_mfma_f32_16x16x32_bf16 v[192:195], a[172:175], v[32:35], v[192:195]
    s_and_b32 s7, s7, 24
    ds_read_b64_tr_b16 a[164:165], v11 offset:0
    v_mfma_f32_16x16x32_bf16 v[192:195], a[176:179], v[48:51], v[192:195]
    ds_read_b64_tr_b16 a[166:167], v11 offset:1024
    v_mfma_f32_16x16x32_bf16 v[196:199], a[172:175], v[36:39], v[196:199]
    global_load_dword v124, v115, s[0:1]
    v_mfma_f32_16x16x32_bf16 v[196:199], a[176:179], v[52:55], v[196:199]
    s_max_u32 s7, s7, 8
    s_add_u32 s7, s7, s35
    v_mfma_f32_16x16x32_bf16 v[200:203], a[172:175], v[40:43], v[200:203]
    s_and_b32 s7, s7, 24
    ds_read_b64_tr_b16 a[168:169], v11 offset:16384
    v_mfma_f32_16x16x32_bf16 v[200:203], a[176:179], v[56:59], v[200:203]
    s_or_b32 s7, s7, s45
    ds_read_b64_tr_b16 a[170:171], v11 offset:17408
    v_mfma_f32_16x16x32_bf16 v[204:207], a[172:175], v[44:47], v[204:207]
    v_mfma_f32_16x16x32_bf16 v[204:207], a[176:179], v[60:63], v[204:207]
    s_waitcnt lgkmcnt(4)
    v_mfma_f32_16x16x32_bf16 v[208:211], a[180:183], v[32:35], v[208:211]
    s_mul_i32 s7, s7, s50
    ds_read_b64_tr_b16 a[172:173], v11 offset:8
    v_mfma_f32_16x16x32_bf16 v[208:211], a[184:187], v[48:51], v[208:211]
    s_bitcmp1_b32 s51, s33
    ds_read_b64_tr_b16 a[174:175], v11 offset:1032
    v_mfma_f32_16x16x32_bf16 v[212:215], a[180:183], v[36:39], v[212:215]
    s_cselect_b32 s7, s7, 0x40000000
    v_mfma_f32_16x16x32_bf16 v[212:215], a[184:187], v[52:55], v[212:215]
    buffer_load_dword v124, v126, s[84:87], s7 offen
    v_mfma_f32_16x16x32_bf16 v[216:219], a[180:183], v[40:43], v[216:219]
    ds_read_b64_tr_b16 a[176:177], v11 offset:16392
    v_mfma_f32_16x16x32_bf16 v[216:219], a[184:187], v[56:59], v[216:219]
    ds_read_b64_tr_b16 a[178:179], v11 offset:17416
    v_mfma_f32_16x16x32_bf16 v[220:223], a[180:183], v[44:47], v[220:223]
    v_mfma_f32_16x16x32_bf16 v[220:223], a[184:187], v[60:63], v[220:223]
    s_waitcnt lgkmcnt(4)
    v_mfma_f32_16x16x32_bf16 v[224:227], a[164:167], v[32:35], v[224:227]
    ds_read_b64_tr_b16 a[180:181], v12 offset:8192
    v_mfma_f32_16x16x32_bf16 v[224:227], a[168:171], v[48:51], v[224:227]
    s_xor_b32 m0, s68, 0x0
    ds_read_b64_tr_b16 a[182:183], v12 offset:9216
    v_mfma_f32_16x16x32_bf16 v[228:231], a[164:167], v[36:39], v[228:231]
    buffer_load_dwordx4 v20, s[72:75], s40 offen offset:0 lds
    v_mfma_f32_16x16x32_bf16 v[228:231], a[168:171], v[52:55], v[228:231]
    v_mfma_f32_16x16x32_bf16 v[232:235], a[164:167], v[40:43], v[232:235]
    ds_read_b64_tr_b16 a[184:185], v12 offset:24576
    v_mfma_f32_16x16x32_bf16 v[232:235], a[168:171], v[56:59], v[232:235]
    ds_read_b64_tr_b16 a[186:187], v12 offset:25600
    v_mfma_f32_16x16x32_bf16 v[236:239], a[164:167], v[44:47], v[236:239]
    buffer_load_dwordx4 v21, s[72:75], s40 offen offset:1024 lds
    v_mfma_f32_16x16x32_bf16 v[236:239], a[168:171], v[60:63], v[236:239]
    s_waitcnt lgkmcnt(4)
    v_mfma_f32_16x16x32_bf16 v[240:243], a[172:175], v[32:35], v[240:243]
    ds_read_b64_tr_b16 a[164:165], v13 offset:8192
    v_mfma_f32_16x16x32_bf16 v[240:243], a[176:179], v[48:51], v[240:243]
    s_xor_b32 s36, s40, 0x8000
    ds_read_b64_tr_b16 a[166:167], v13 offset:9216
    v_mfma_f32_16x16x32_bf16 v[244:247], a[172:175], v[36:39], v[244:247]
    s_xor_b32 m0, s68, 0x800
    v_mfma_f32_16x16x32_bf16 v[244:247], a[176:179], v[52:55], v[244:247]
    buffer_load_dwordx4 v20, s[72:75], s36 offen offset:0 lds
    v_mfma_f32_16x16x32_bf16 v[248:251], a[172:175], v[40:43], v[248:251]
    s_lshl_b32 s37, s32, 18
    ds_read_b64_tr_b16 a[168:169], v13 offset:24576
    v_mfma_f32_16x16x32_bf16 v[248:251], a[176:179], v[56:59], v[248:251]
    s_add_u32 s100, s37, 0x40000
    ds_read_b64_tr_b16 a[170:171], v13 offset:25600
    v_mfma_f32_16x16x32_bf16 v[252:255], a[172:175], v[44:47], v[252:255]
    v_mfma_f32_16x16x32_bf16 v[252:255], a[176:179], v[60:63], v[252:255]
    s_waitcnt lgkmcnt(4)
    v_mfma_f32_16x16x32_bf16 a[0:3], a[180:183], v[32:35], a[0:3]
    s_mul_i32 s38, s32, 229376
    ds_read_b64_tr_b16 a[172:173], v14 offset:8192
    v_mfma_f32_16x16x32_bf16 a[0:3], a[184:187], v[48:51], a[0:3]
    s_add_u32 s101, s38, 229376
    ds_read_b64_tr_b16 a[174:175], v14 offset:9216
    v_mfma_f32_16x16x32_bf16 a[4:7], a[180:183], v[36:39], a[4:7]
    buffer_load_dwordx4 v21, s[72:75], s36 offen offset:1024 lds
    v_mfma_f32_16x16x32_bf16 a[4:7], a[184:187], v[52:55], a[4:7]
    v_mfma_f32_16x16x32_bf16 a[8:11], a[180:183], v[40:43], a[8:11]
    s_xor_b32 s36, s40, 0x10000
    ds_read_b64_tr_b16 a[176:177], v14 offset:24576
    v_mfma_f32_16x16x32_bf16 a[8:11], a[184:187], v[56:59], a[8:11]
    s_xor_b32 m0, s68, 0x1000
    ds_read_b64_tr_b16 a[178:179], v14 offset:25600
    v_mfma_f32_16x16x32_bf16 a[12:15], a[180:183], v[44:47], a[12:15]
    buffer_load_dwordx4 v20, s[72:75], s36 offen offset:0 lds
    v_mfma_f32_16x16x32_bf16 a[12:15], a[184:187], v[60:63], a[12:15]
    s_waitcnt lgkmcnt(4)
    v_mfma_f32_16x16x32_bf16 a[16:19], a[164:167], v[32:35], a[16:19]
    ds_read_b64_tr_b16 a[180:181], v15 offset:8192
    v_mfma_f32_16x16x32_bf16 a[16:19], a[168:171], v[48:51], a[16:19]
    ds_read_b64_tr_b16 a[182:183], v15 offset:9216
    v_mfma_f32_16x16x32_bf16 a[20:23], a[164:167], v[36:39], a[20:23]
    v_mfma_f32_16x16x32_bf16 a[20:23], a[168:171], v[52:55], a[20:23]
    buffer_load_dwordx4 v21, s[72:75], s36 offen offset:1024 lds
    v_mfma_f32_16x16x32_bf16 a[24:27], a[164:167], v[40:43], a[24:27]
    ds_read_b64_tr_b16 a[184:185], v15 offset:24576
    v_mfma_f32_16x16x32_bf16 a[24:27], a[168:171], v[56:59], a[24:27]
    ds_read_b64_tr_b16 a[186:187], v15 offset:25600
    v_mfma_f32_16x16x32_bf16 a[28:31], a[164:167], v[44:47], a[28:31]
    v_mfma_f32_16x16x32_bf16 a[28:31], a[168:171], v[60:63], a[28:31]
    s_waitcnt lgkmcnt(4)
    v_mfma_f32_16x16x32_bf16 a[32:35], a[172:175], v[32:35], a[32:35]
    s_xor_b32 s36, s40, 0x18000
    ds_read_b64_tr_b16 a[164:165], v2 offset:8192
    v_mfma_f32_16x16x32_bf16 a[32:35], a[176:179], v[48:51], a[32:35]
    s_xor_b32 m0, s68, 0x1800
    ds_read_b64_tr_b16 a[166:167], v2 offset:9216
    v_mfma_f32_16x16x32_bf16 a[36:39], a[172:175], v[36:39], a[36:39]
    buffer_load_dwordx4 v20, s[72:75], s36 offen offset:0 lds
    v_mfma_f32_16x16x32_bf16 a[36:39], a[176:179], v[52:55], a[36:39]
    v_mfma_f32_16x16x32_bf16 a[40:43], a[172:175], v[40:43], a[40:43]
    ds_read_b64_tr_b16 a[168:169], v2 offset:24576
    v_mfma_f32_16x16x32_bf16 a[40:43], a[176:179], v[56:59], a[40:43]
    ds_read_b64_tr_b16 a[170:171], v2 offset:25600
    v_mfma_f32_16x16x32_bf16 a[44:47], a[172:175], v[44:47], a[44:47]
    buffer_load_dwordx4 v21, s[72:75], s36 offen offset:1024 lds
    v_mfma_f32_16x16x32_bf16 a[44:47], a[176:179], v[60:63], a[44:47]
    s_waitcnt lgkmcnt(4)
    v_mfma_f32_16x16x32_bf16 a[48:51], a[180:183], v[32:35], a[48:51]
    s_waitcnt vmcnt(17)
    ds_read_b64_tr_b16 a[172:173], v3 offset:8192
    v_mfma_f32_16x16x32_bf16 a[48:51], a[184:187], v[48:51], a[48:51]
    ds_read_b64_tr_b16 a[174:175], v3 offset:9216
    v_mfma_f32_16x16x32_bf16 a[52:55], a[180:183], v[36:39], a[52:55]
    ds_read_b128 v[64:67], v26 offset:0
    v_mfma_f32_16x16x32_bf16 a[52:55], a[184:187], v[52:55], a[52:55]
    ds_read_b128 v[80:83], v27 offset:0
    v_mfma_f32_16x16x32_bf16 a[56:59], a[180:183], v[40:43], a[56:59]
    ds_read_b64_tr_b16 a[176:177], v3 offset:24576
    v_mfma_f32_16x16x32_bf16 a[56:59], a[184:187], v[56:59], a[56:59]
    ds_read_b64_tr_b16 a[178:179], v3 offset:25600
    v_mfma_f32_16x16x32_bf16 a[60:63], a[180:183], v[44:47], a[60:63]
    ds_read_b128 v[68:71], v26 offset:2048
    v_mfma_f32_16x16x32_bf16 a[60:63], a[184:187], v[60:63], a[60:63]
    s_waitcnt lgkmcnt(7)
    ds_read_b128 v[84:87], v27 offset:2048
    v_mfma_f32_16x16x32_bf16 a[64:67], a[164:167], v[32:35], a[64:67]
    ds_read_b64_tr_b16 a[180:181], v4 offset:8192
    v_mfma_f32_16x16x32_bf16 a[64:67], a[168:171], v[48:51], a[64:67]
    ds_read_b64_tr_b16 a[182:183], v4 offset:9216
    v_mfma_f32_16x16x32_bf16 a[68:71], a[164:167], v[36:39], a[68:71]
    ds_read_b64_tr_b16 a[184:185], v4 offset:24576
    v_mfma_f32_16x16x32_bf16 a[68:71], a[168:171], v[52:55], a[68:71]
    ds_read_b64_tr_b16 a[186:187], v4 offset:25600
    v_mfma_f32_16x16x32_bf16 a[72:75], a[164:167], v[40:43], a[72:75]
    ds_read_b128 v[72:75], v26 offset:4096
    v_mfma_f32_16x16x32_bf16 a[72:75], a[168:171], v[56:59], a[72:75]
    ds_read_b128 v[88:91], v27 offset:4096
    v_mfma_f32_16x16x32_bf16 a[76:79], a[164:167], v[44:47], a[76:79]
    ds_read_b128 v[76:79], v26 offset:6144
    v_mfma_f32_16x16x32_bf16 a[76:79], a[168:171], v[60:63], a[76:79]
    s_waitcnt lgkmcnt(9)
    v_mfma_f32_16x16x32_bf16 a[80:83], a[172:175], v[32:35], a[80:83]
    ds_read_b128 v[92:95], v27 offset:6144
    v_mfma_f32_16x16x32_bf16 a[80:83], a[176:179], v[48:51], a[80:83]
    s_waitcnt vmcnt(11)
    s_waitcnt lgkmcnt(0)
    s_barrier
    v_mfma_f32_16x16x32_bf16 a[84:87], a[172:175], v[36:39], a[84:87]
    ds_read_b64_tr_b16 a[164:165], v8 offset:32768
    v_mfma_f32_16x16x32_bf16 a[84:87], a[176:179], v[52:55], a[84:87]
    ds_read_b64_tr_b16 a[166:167], v8 offset:33792
    v_mfma_f32_16x16x32_bf16 a[88:91], a[172:175], v[40:43], a[88:91]
    ds_read_b64_tr_b16 a[168:169], v8 offset:49152
    v_mfma_f32_16x16x32_bf16 a[88:91], a[176:179], v[56:59], a[88:91]
    s_add_u32 m0, s41, 0
    ds_read_b64_tr_b16 a[170:171], v8 offset:50176
    v_mfma_f32_16x16x32_bf16 a[92:95], a[172:175], v[44:47], a[92:95]
    buffer_load_dwordx4 v16, s[12:15], s37 offen lds
    v_mfma_f32_16x16x32_bf16 a[92:95], a[176:179], v[60:63], a[92:95]
    v_mfma_f32_16x16x32_bf16 a[96:99], a[180:183], v[32:35], a[96:99]
    ds_read_b64_tr_b16 a[172:173], v8 offset:32776
    v_mfma_f32_16x16x32_bf16 a[96:99], a[184:187], v[48:51], a[96:99]
    ds_read_b64_tr_b16 a[174:175], v8 offset:33800
    v_mfma_f32_16x16x32_bf16 a[100:103], a[180:183], v[36:39], a[100:103]
    s_add_u32 m0, s41, 1024
    v_mfma_f32_16x16x32_bf16 a[100:103], a[184:187], v[52:55], a[100:103]
    buffer_load_dwordx4 v17, s[12:15], s37 offen lds
    v_mfma_f32_16x16x32_bf16 a[104:107], a[180:183], v[40:43], a[104:107]
    ds_read_b64_tr_b16 a[176:177], v8 offset:49160
    v_mfma_f32_16x16x32_bf16 a[104:107], a[184:187], v[56:59], a[104:107]
    ds_read_b64_tr_b16 a[178:179], v8 offset:50184
    v_mfma_f32_16x16x32_bf16 a[108:111], a[180:183], v[44:47], a[108:111]
    v_mfma_f32_16x16x32_bf16 a[108:111], a[184:187], v[60:63], a[108:111]
    s_waitcnt lgkmcnt(4)
    v_mfma_f32_16x16x32_bf16 v[128:131], a[164:167], v[64:67], v[128:131]
    s_add_u32 s33, s33, 2
    ds_read_b64_tr_b16 a[180:181], v9 offset:32768
    v_mfma_f32_16x16x32_bf16 v[128:131], a[168:171], v[80:83], v[128:131]
    s_add_u32 m0, s41, 8192
    ds_read_b64_tr_b16 a[182:183], v9 offset:33792
    v_mfma_f32_16x16x32_bf16 v[132:135], a[164:167], v[68:71], v[132:135]
    buffer_load_dwordx4 v18, s[16:19], s38 offen lds
    v_mfma_f32_16x16x32_bf16 v[132:135], a[168:171], v[84:87], v[132:135]
    s_lshr_b32 s4, s33, 1
    s_xor_b32 s4, s4, s33
    v_mfma_f32_16x16x32_bf16 v[136:139], a[164:167], v[72:75], v[136:139]
    s_lshr_b32 s5, s33, 2
    ds_read_b64_tr_b16 a[184:185], v9 offset:49152
    v_mfma_f32_16x16x32_bf16 v[136:139], a[168:171], v[88:91], v[136:139]
    s_add_u32 m0, s41, 9216
    ds_read_b64_tr_b16 a[186:187], v9 offset:50176
    v_mfma_f32_16x16x32_bf16 v[140:143], a[164:167], v[76:79], v[140:143]
    buffer_load_dwordx4 v19, s[16:19], s38 offen lds
    v_mfma_f32_16x16x32_bf16 v[140:143], a[168:171], v[92:95], v[140:143]
    s_waitcnt lgkmcnt(4)
    v_mfma_f32_16x16x32_bf16 v[144:147], a[172:175], v[64:67], v[144:147]
    s_and_b32 s4, s4, s5
    ds_read_b64_tr_b16 a[164:165], v9 offset:32776
    v_mfma_f32_16x16x32_bf16 v[144:147], a[176:179], v[80:83], v[144:147]
    s_and_b32 s4, s4, 4
    ds_read_b64_tr_b16 a[166:167], v9 offset:33800
    v_mfma_f32_16x16x32_bf16 v[148:151], a[172:175], v[68:71], v[148:151]
    s_add_u32 m0, s41, 16384
    s_mul_i32 s4, s4, 3
    v_mfma_f32_16x16x32_bf16 v[148:151], a[176:179], v[84:87], v[148:151]
    buffer_load_dwordx4 v16, s[12:15], s100 offen lds
    v_mfma_f32_16x16x32_bf16 v[152:155], a[172:175], v[72:75], v[152:155]
    s_xor_b32 s4, s4, s33
    ds_read_b64_tr_b16 a[168:169], v9 offset:49160
    v_mfma_f32_16x16x32_bf16 v[152:155], a[176:179], v[88:91], v[152:155]
    s_add_u32 s5, s4, s35
    ds_read_b64_tr_b16 a[170:171], v9 offset:50184
    v_mfma_f32_16x16x32_bf16 v[156:159], a[172:175], v[76:79], v[156:159]
    s_and_b32 s5, s5, 24
    s_add_u32 s4, s4, s34
    v_mfma_f32_16x16x32_bf16 v[156:159], a[176:179], v[92:95], v[156:159]
    s_waitcnt lgkmcnt(4)
    v_mfma_f32_16x16x32_bf16 v[160:163], a[180:183], v[64:67], v[160:163]
    s_and_b32 s4, s4, 6
    ds_read_b64_tr_b16 a[172:173], v10 offset:32768
    v_mfma_f32_16x16x32_bf16 v[160:163], a[184:187], v[80:83], v[160:163]
    s_add_u32 m0, s41, 17408
    ds_read_b64_tr_b16 a[174:175], v10 offset:33792
    v_mfma_f32_16x16x32_bf16 v[164:167], a[180:183], v[68:71], v[164:167]
    buffer_load_dwordx4 v17, s[12:15], s100 offen lds
    v_mfma_f32_16x16x32_bf16 v[164:167], a[184:187], v[84:87], v[164:167]
    s_or_b32 s32, s4, s5
    s_lshl_b32 s4, s32, 6
    v_mfma_f32_16x16x32_bf16 v[168:171], a[180:183], v[72:75], v[168:171]
    s_or_b32 s40, s4, s11
    ds_read_b64_tr_b16 a[176:177], v10 offset:49152
    v_mfma_f32_16x16x32_bf16 v[168:171], a[184:187], v[88:91], v[168:171]
    s_add_u32 m0, s41, 24576
    ds_read_b64_tr_b16 a[178:179], v10 offset:50176
    v_mfma_f32_16x16x32_bf16 v[172:175], a[180:183], v[76:79], v[172:175]
    buffer_load_dwordx4 v18, s[16:19], s101 offen lds
    v_mfma_f32_16x16x32_bf16 v[172:175], a[184:187], v[92:95], v[172:175]
    s_waitcnt lgkmcnt(4)
    v_mfma_f32_16x16x32_bf16 v[176:179], a[164:167], v[64:67], v[176:179]
    s_cmp_eq_u32 s33, s8
    ds_read_b64_tr_b16 a[180:181], v10 offset:32776
    v_mfma_f32_16x16x32_bf16 v[176:179], a[168:171], v[80:83], v[176:179]
    s_cselect_b32 s5, 0, 0x40000000
    ds_read_b64_tr_b16 a[182:183], v10 offset:33800
    v_mfma_f32_16x16x32_bf16 v[180:183], a[164:167], v[68:71], v[180:183]
    s_add_u32 m0, s41, 25600
    v_mfma_f32_16x16x32_bf16 v[180:183], a[168:171], v[84:87], v[180:183]
    buffer_load_dwordx4 v19, s[16:19], s101 offen lds
    v_mfma_f32_16x16x32_bf16 v[184:187], a[164:167], v[72:75], v[184:187]
    s_and_b32 s4, s43, 0x6000
    ds_read_b64_tr_b16 a[184:185], v10 offset:49160
    v_mfma_f32_16x16x32_bf16 v[184:187], a[168:171], v[88:91], v[184:187]
    s_lshl1_add_u32 s7, s33, -10
    ds_read_b64_tr_b16 a[186:187], v10 offset:50184
    v_mfma_f32_16x16x32_bf16 v[188:191], a[164:167], v[76:79], v[188:191]
    buffer_atomic_add v5, v23, s[80:83], s5 offen sc1
    v_mfma_f32_16x16x32_bf16 v[188:191], a[168:171], v[92:95], v[188:191]
    s_waitcnt lgkmcnt(4)
    v_mfma_f32_16x16x32_bf16 v[192:195], a[172:175], v[64:67], v[192:195]
    s_and_b32 s7, s7, 24
    ds_read_b64_tr_b16 a[164:165], v11 offset:32768
    v_mfma_f32_16x16x32_bf16 v[192:195], a[176:179], v[80:83], v[192:195]
    s_add_u32 m0, s42, s4
    ds_read_b64_tr_b16 a[166:167], v11 offset:33792
    v_mfma_f32_16x16x32_bf16 v[196:199], a[172:175], v[68:71], v[196:199]
    buffer_load_dwordx4 v112, s[20:23], s43 offen offset:0 lds
    v_mfma_f32_16x16x32_bf16 v[196:199], a[176:179], v[84:87], v[196:199]
    s_max_u32 s7, s7, 8
    s_add_u32 s7, s7, s35
    v_mfma_f32_16x16x32_bf16 v[200:203], a[172:175], v[72:75], v[200:203]
    s_and_b32 s7, s7, 24
    ds_read_b64_tr_b16 a[168:169], v11 offset:49152
    v_mfma_f32_16x16x32_bf16 v[200:203], a[176:179], v[88:91], v[200:203]
    s_or_b32 s7, s7, s45
    ds_read_b64_tr_b16 a[170:171], v11 offset:50176
    v_mfma_f32_16x16x32_bf16 v[204:207], a[172:175], v[76:79], v[204:207]
    buffer_load_dwordx4 v113, s[20:23], s43 offen offset:1024 lds
    v_mfma_f32_16x16x32_bf16 v[204:207], a[176:179], v[92:95], v[204:207]
    s_waitcnt lgkmcnt(4)
    v_mfma_f32_16x16x32_bf16 v[208:211], a[180:183], v[64:67], v[208:211]
    s_mul_i32 s7, s7, s50
    ds_read_b64_tr_b16 a[172:173], v11 offset:32776
    v_mfma_f32_16x16x32_bf16 v[208:211], a[184:187], v[80:83], v[208:211]
    s_bitcmp1_b32 s51, s33
    ds_read_b64_tr_b16 a[174:175], v11 offset:33800
    v_mfma_f32_16x16x32_bf16 v[212:215], a[180:183], v[68:71], v[212:215]
    s_cselect_b32 s7, s7, 0x40000000
    v_mfma_f32_16x16x32_bf16 v[212:215], a[184:187], v[84:87], v[212:215]
    buffer_load_dword v124, v126, s[84:87], s7 offen
    v_mfma_f32_16x16x32_bf16 v[216:219], a[180:183], v[72:75], v[216:219]
    ds_read_b64_tr_b16 a[176:177], v11 offset:49160
    v_mfma_f32_16x16x32_bf16 v[216:219], a[184:187], v[88:91], v[216:219]
    ds_read_b64_tr_b16 a[178:179], v11 offset:50184
    v_mfma_f32_16x16x32_bf16 v[220:223], a[180:183], v[76:79], v[220:223]
    v_mfma_f32_16x16x32_bf16 v[220:223], a[184:187], v[92:95], v[220:223]
    s_waitcnt lgkmcnt(4)
    v_mfma_f32_16x16x32_bf16 v[224:227], a[164:167], v[64:67], v[224:227]
    ds_read_b64_tr_b16 a[180:181], v12 offset:40960
    v_mfma_f32_16x16x32_bf16 v[224:227], a[168:171], v[80:83], v[224:227]
    s_xor_b32 m0, s68, 0x28000
    ds_read_b64_tr_b16 a[182:183], v12 offset:41984
    v_mfma_f32_16x16x32_bf16 v[228:231], a[164:167], v[68:71], v[228:231]
    buffer_load_dwordx4 v20, s[72:75], s40 offen offset:0 lds
    v_mfma_f32_16x16x32_bf16 v[228:231], a[168:171], v[84:87], v[228:231]
    v_mfma_f32_16x16x32_bf16 v[232:235], a[164:167], v[72:75], v[232:235]
    ds_read_b64_tr_b16 a[184:185], v12 offset:57344
    v_mfma_f32_16x16x32_bf16 v[232:235], a[168:171], v[88:91], v[232:235]
    ds_read_b64_tr_b16 a[186:187], v12 offset:58368
    v_mfma_f32_16x16x32_bf16 v[236:239], a[164:167], v[76:79], v[236:239]
    buffer_load_dwordx4 v21, s[72:75], s40 offen offset:1024 lds
    v_mfma_f32_16x16x32_bf16 v[236:239], a[168:171], v[92:95], v[236:239]
    s_waitcnt lgkmcnt(4)
    v_mfma_f32_16x16x32_bf16 v[240:243], a[172:175], v[64:67], v[240:243]
    ds_read_b64_tr_b16 a[164:165], v13 offset:40960
    v_mfma_f32_16x16x32_bf16 v[240:243], a[176:179], v[80:83], v[240:243]
    s_xor_b32 s36, s40, 0x8000
    ds_read_b64_tr_b16 a[166:167], v13 offset:41984
    v_mfma_f32_16x16x32_bf16 v[244:247], a[172:175], v[68:71], v[244:247]
    s_xor_b32 m0, s68, 0x28800
    v_mfma_f32_16x16x32_bf16 v[244:247], a[176:179], v[84:87], v[244:247]
    buffer_load_dwordx4 v20, s[72:75], s36 offen offset:0 lds
    v_mfma_f32_16x16x32_bf16 v[248:251], a[172:175], v[72:75], v[248:251]
    s_lshl_b32 s37, s32, 18
    ds_read_b64_tr_b16 a[168:169], v13 offset:57344
    v_mfma_f32_16x16x32_bf16 v[248:251], a[176:179], v[88:91], v[248:251]
    s_add_u32 s100, s37, 0x40000
    ds_read_b64_tr_b16 a[170:171], v13 offset:58368
    v_mfma_f32_16x16x32_bf16 v[252:255], a[172:175], v[76:79], v[252:255]
    v_mfma_f32_16x16x32_bf16 v[252:255], a[176:179], v[92:95], v[252:255]
    s_waitcnt lgkmcnt(4)
    v_mfma_f32_16x16x32_bf16 a[0:3], a[180:183], v[64:67], a[0:3]
    s_mul_i32 s38, s32, 229376
    ds_read_b64_tr_b16 a[172:173], v14 offset:40960
    v_mfma_f32_16x16x32_bf16 a[0:3], a[184:187], v[80:83], a[0:3]
    s_add_u32 s101, s38, 229376
    ds_read_b64_tr_b16 a[174:175], v14 offset:41984
    v_mfma_f32_16x16x32_bf16 a[4:7], a[180:183], v[68:71], a[4:7]
    buffer_load_dwordx4 v21, s[72:75], s36 offen offset:1024 lds
    v_mfma_f32_16x16x32_bf16 a[4:7], a[184:187], v[84:87], a[4:7]
    v_mfma_f32_16x16x32_bf16 a[8:11], a[180:183], v[72:75], a[8:11]
    s_xor_b32 s36, s40, 0x10000
    ds_read_b64_tr_b16 a[176:177], v14 offset:57344
    v_mfma_f32_16x16x32_bf16 a[8:11], a[184:187], v[88:91], a[8:11]
    s_xor_b32 m0, s68, 0x29000
    ds_read_b64_tr_b16 a[178:179], v14 offset:58368
    v_mfma_f32_16x16x32_bf16 a[12:15], a[180:183], v[76:79], a[12:15]
    buffer_load_dwordx4 v20, s[72:75], s36 offen offset:0 lds
    v_mfma_f32_16x16x32_bf16 a[12:15], a[184:187], v[92:95], a[12:15]
    s_waitcnt lgkmcnt(4)
    v_mfma_f32_16x16x32_bf16 a[16:19], a[164:167], v[64:67], a[16:19]
    s_add_u32 s43, s43, 8192
    ds_read_b64_tr_b16 a[180:181], v15 offset:40960
    v_mfma_f32_16x16x32_bf16 a[16:19], a[168:171], v[80:83], a[16:19]
    s_and_b32 s43, s43, 0x7fffffff
    ds_read_b64_tr_b16 a[182:183], v15 offset:41984
    v_mfma_f32_16x16x32_bf16 a[20:23], a[164:167], v[68:71], a[20:23]
    v_mfma_f32_16x16x32_bf16 a[20:23], a[168:171], v[84:87], a[20:23]
    buffer_load_dwordx4 v21, s[72:75], s36 offen offset:1024 lds
    v_mfma_f32_16x16x32_bf16 a[24:27], a[164:167], v[72:75], a[24:27]
    ds_read_b64_tr_b16 a[184:185], v15 offset:57344
    v_mfma_f32_16x16x32_bf16 a[24:27], a[168:171], v[88:91], a[24:27]
    ds_read_b64_tr_b16 a[186:187], v15 offset:58368
    v_mfma_f32_16x16x32_bf16 a[28:31], a[164:167], v[76:79], a[28:31]
    v_mfma_f32_16x16x32_bf16 a[28:31], a[168:171], v[92:95], a[28:31]
    s_waitcnt lgkmcnt(4)
    v_mfma_f32_16x16x32_bf16 a[32:35], a[172:175], v[64:67], a[32:35]
    s_xor_b32 s36, s40, 0x18000
    ds_read_b64_tr_b16 a[164:165], v2 offset:40960
    v_mfma_f32_16x16x32_bf16 a[32:35], a[176:179], v[80:83], a[32:35]
    s_xor_b32 m0, s68, 0x29800
    ds_read_b64_tr_b16 a[166:167], v2 offset:41984
    v_mfma_f32_16x16x32_bf16 a[36:39], a[172:175], v[68:71], a[36:39]
    buffer_load_dwordx4 v20, s[72:75], s36 offen offset:0 lds
    v_mfma_f32_16x16x32_bf16 a[36:39], a[176:179], v[84:87], a[36:39]
    v_mfma_f32_16x16x32_bf16 a[40:43], a[172:175], v[72:75], a[40:43]
    ds_read_b64_tr_b16 a[168:169], v2 offset:57344
    v_mfma_f32_16x16x32_bf16 a[40:43], a[176:179], v[88:91], a[40:43]
    ds_read_b64_tr_b16 a[170:171], v2 offset:58368
    v_mfma_f32_16x16x32_bf16 a[44:47], a[172:175], v[76:79], a[44:47]
    buffer_load_dwordx4 v21, s[72:75], s36 offen offset:1024 lds
    v_mfma_f32_16x16x32_bf16 a[44:47], a[176:179], v[92:95], a[44:47]
    s_waitcnt lgkmcnt(4)
    v_mfma_f32_16x16x32_bf16 a[48:51], a[180:183], v[64:67], a[48:51]
    s_waitcnt vmcnt(20)
    ds_read_b64_tr_b16 a[172:173], v3 offset:40960
    v_mfma_f32_16x16x32_bf16 a[48:51], a[184:187], v[80:83], a[48:51]
    ds_read_b64_tr_b16 a[174:175], v3 offset:41984
    v_mfma_f32_16x16x32_bf16 a[52:55], a[180:183], v[68:71], a[52:55]
    ds_read_b128 v[32:35], v24 offset:0
    v_mfma_f32_16x16x32_bf16 a[52:55], a[184:187], v[84:87], a[52:55]
    ds_read_b128 v[48:51], v25 offset:0
    v_mfma_f32_16x16x32_bf16 a[56:59], a[180:183], v[72:75], a[56:59]
    ds_read_b64_tr_b16 a[176:177], v3 offset:57344
    v_mfma_f32_16x16x32_bf16 a[56:59], a[184:187], v[88:91], a[56:59]
    ds_read_b64_tr_b16 a[178:179], v3 offset:58368
    v_mfma_f32_16x16x32_bf16 a[60:63], a[180:183], v[76:79], a[60:63]
    ds_read_b128 v[36:39], v24 offset:2048
    v_mfma_f32_16x16x32_bf16 a[60:63], a[184:187], v[92:95], a[60:63]
    s_waitcnt lgkmcnt(7)
    ds_read_b128 v[52:55], v25 offset:2048
    v_mfma_f32_16x16x32_bf16 a[64:67], a[164:167], v[64:67], a[64:67]
    ds_read_b64_tr_b16 a[180:181], v4 offset:40960
    v_mfma_f32_16x16x32_bf16 a[64:67], a[168:171], v[80:83], a[64:67]
    ds_read_b64_tr_b16 a[182:183], v4 offset:41984
    v_mfma_f32_16x16x32_bf16 a[68:71], a[164:167], v[68:71], a[68:71]
    ds_read_b64_tr_b16 a[184:185], v4 offset:57344
    v_mfma_f32_16x16x32_bf16 a[68:71], a[168:171], v[84:87], a[68:71]
    ds_read_b64_tr_b16 a[186:187], v4 offset:58368
    v_mfma_f32_16x16x32_bf16 a[72:75], a[164:167], v[72:75], a[72:75]
    ds_read_b128 v[40:43], v24 offset:4096
    v_mfma_f32_16x16x32_bf16 a[72:75], a[168:171], v[88:91], a[72:75]
    ds_read_b128 v[56:59], v25 offset:4096
    v_mfma_f32_16x16x32_bf16 a[76:79], a[164:167], v[76:79], a[76:79]
    ds_read_b128 v[44:47], v24 offset:6144
    v_mfma_f32_16x16x32_bf16 a[76:79], a[168:171], v[92:95], a[76:79]
    s_waitcnt lgkmcnt(9)
    v_mfma_f32_16x16x32_bf16 a[80:83], a[172:175], v[64:67], a[80:83]
    ds_read_b128 v[60:63], v25 offset:6144
    v_mfma_f32_16x16x32_bf16 a[80:83], a[176:179], v[80:83], a[80:83]
    s_waitcnt vmcnt(12)
    s_waitcnt lgkmcnt(0)
    s_barrier
    v_mfma_f32_16x16x32_bf16 a[84:87], a[172:175], v[68:71], a[84:87]
    ds_read_b64_tr_b16 a[164:165], v8 offset:0
    v_mfma_f32_16x16x32_bf16 a[84:87], a[176:179], v[84:87], a[84:87]
    ds_read_b64_tr_b16 a[166:167], v8 offset:1024
    v_mfma_f32_16x16x32_bf16 a[88:91], a[172:175], v[72:75], a[88:91]
    ds_read_b64_tr_b16 a[168:169], v8 offset:16384
    v_mfma_f32_16x16x32_bf16 a[88:91], a[176:179], v[88:91], a[88:91]
    s_add_u32 m0, s41, 32768
    ds_read_b64_tr_b16 a[170:171], v8 offset:17408
    v_mfma_f32_16x16x32_bf16 a[92:95], a[172:175], v[76:79], a[92:95]
    buffer_load_dwordx4 v16, s[12:15], s37 offen lds
    v_mfma_f32_16x16x32_bf16 a[92:95], a[176:179], v[92:95], a[92:95]
    s_cmp_eq_u32 s33, 31
    v_mfma_f32_16x16x32_bf16 a[96:99], a[180:183], v[64:67], a[96:99]
    s_cselect_b64 vcc, -1, 0
    ds_read_b64_tr_b16 a[172:173], v8 offset:8
    v_mfma_f32_16x16x32_bf16 a[96:99], a[184:187], v[80:83], a[96:99]
    ds_read_b64_tr_b16 a[174:175], v8 offset:1032
    v_mfma_f32_16x16x32_bf16 a[100:103], a[180:183], v[68:71], a[100:103]
    s_add_u32 m0, s41, 33792
    v_mfma_f32_16x16x32_bf16 a[100:103], a[184:187], v[84:87], a[100:103]
    buffer_load_dwordx4 v17, s[12:15], s37 offen lds
    v_mfma_f32_16x16x32_bf16 a[104:107], a[180:183], v[72:75], a[104:107]
    ds_read_b64_tr_b16 a[176:177], v8 offset:16392
    v_mfma_f32_16x16x32_bf16 a[104:107], a[184:187], v[88:91], a[104:107]
    ds_read_b64_tr_b16 a[178:179], v8 offset:17416
    v_mfma_f32_16x16x32_bf16 a[108:111], a[180:183], v[76:79], a[108:111]
    s_bitcmp1_b32 0x8008000, s33
    v_mfma_f32_16x16x32_bf16 a[108:111], a[184:187], v[92:95], a[108:111]
    s_waitcnt lgkmcnt(4)
    s_cbranch_scc1 L_ph1
    s_cbranch_vccnz L_r1
    v_mfma_f32_16x16x32_bf16 v[128:131], a[164:167], v[32:35], v[128:131]
    s_add_u32 s33, s33, 2
    ds_read_b64_tr_b16 a[180:181], v9 offset:0
    v_accvgpr_read_b32 v116, a192
    v_mfma_f32_16x16x32_bf16 v[128:131], a[168:171], v[48:51], v[128:131]
    s_add_u32 m0, s41, 40960
    ds_read_b64_tr_b16 a[182:183], v9 offset:1024
    v_lshlrev_b32 v118, 16, v116
    v_mfma_f32_16x16x32_bf16 v[132:135], a[164:167], v[36:39], v[132:135]
    buffer_load_dwordx4 v18, s[16:19], s38 offen lds
    v_mfma_f32_16x16x32_bf16 v[132:135], a[168:171], v[52:55], v[132:135]
    s_lshr_b32 s4, s33, 1
    s_xor_b32 s4, s4, s33
    ds_read_b64_tr_b16 a[224:225], v28 offset:0
    v_mfma_f32_16x16x32_bf16 v[136:139], a[164:167], v[40:43], v[136:139]
    s_lshr_b32 s5, s33, 2
    ds_read_b64_tr_b16 a[184:185], v9 offset:16384
    v_and_b32 v116, 0xffff0000, v116
    v_mfma_f32_16x16x32_bf16 v[136:139], a[168:171], v[56:59], v[136:139]
    s_add_u32 m0, s41, 41984
    ds_read_b64_tr_b16 a[186:187], v9 offset:17408
    v_add_f32 v120, v118, v116
    v_mfma_f32_16x16x32_bf16 v[140:143], a[164:167], v[44:47], v[140:143]
    buffer_load_dwordx4 v19, s[16:19], s38 offen lds
    v_mfma_f32_16x16x32_bf16 v[140:143], a[168:171], v[60:63], v[140:143]
    s_waitcnt lgkmcnt(5)
    ds_read_b64_tr_b16 a[226:227], v28 offset:1024
    v_mul_f32 v121, v118, v118
    v_mfma_f32_16x16x32_bf16 v[144:147], a[172:175], v[32:35], v[144:147]
    s_and_b32 s4, s4, s5
    ds_read_b64_tr_b16 a[164:165], v9 offset:8
    v_fmac_f32 v121, v116, v116
    v_mfma_f32_16x16x32_bf16 v[144:147], a[176:179], v[48:51], v[144:147]
    s_and_b32 s4, s4, 4
    ds_read_b64_tr_b16 a[166:167], v9 offset:1032
    v_accvgpr_read_b32 v117, a193
    v_mfma_f32_16x16x32_bf16 v[148:151], a[172:175], v[36:39], v[148:151]
    s_add_u32 m0, s41, 49152
    s_mul_i32 s4, s4, 3
    ds_read_b64_tr_b16 a[228:229], v28 offset:8
    v_mfma_f32_16x16x32_bf16 v[148:151], a[176:179], v[52:55], v[148:151]
    buffer_load_dwordx4 v16, s[12:15], s100 offen lds
    v_mfma_f32_16x16x32_bf16 v[152:155], a[172:175], v[40:43], v[152:155]
    s_xor_b32 s4, s4, s33
    ds_read_b64_tr_b16 a[168:169], v9 offset:16392
    v_lshlrev_b32 v119, 16, v117
    v_mfma_f32_16x16x32_bf16 v[152:155], a[176:179], v[56:59], v[152:155]
    s_add_u32 s5, s4, s35
    ds_read_b64_tr_b16 a[170:171], v9 offset:17416
    v_and_b32 v117, 0xffff0000, v117
    v_mfma_f32_16x16x32_bf16 v[156:159], a[172:175], v[44:47], v[156:159]
    s_and_b32 s5, s5, 24
    s_add_u32 s4, s4, s34
    ds_read_b64_tr_b16 a[230:231], v28 offset:1032
    v_mfma_f32_16x16x32_bf16 v[156:159], a[176:179], v[60:63], v[156:159]
    s_waitcnt lgkmcnt(7)
    ds_read_b64_tr_b16 a[232:233], v29 offset:8192
    v_add_f32 v120, v120, v119
    v_mfma_f32_16x16x32_bf16 v[160:163], a[180:183], v[32:35], v[160:163]
    s_and_b32 s4, s4, 6
    ds_read_b64_tr_b16 a[172:173], v10 offset:0
    v_fmac_f32 v121, v119, v119
    v_mfma_f32_16x16x32_bf16 v[160:163], a[184:187], v[48:51], v[160:163]
    s_add_u32 m0, s41, 50176
    ds_read_b64_tr_b16 a[174:175], v10 offset:1024
    v_add_f32 v120, v120, v117
    v_mfma_f32_16x16x32_bf16 v[164:167], a[180:183], v[36:39], v[164:167]
    buffer_load_dwordx4 v17, s[12:15], s100 offen lds
    v_mfma_f32_16x16x32_bf16 v[164:167], a[184:187], v[52:55], v[164:167]
    s_or_b32 s32, s4, s5
    s_lshl_b32 s4, s32, 6
    ds_read_b64_tr_b16 a[234:235], v29 offset:9216
    v_mfma_f32_16x16x32_bf16 v[168:171], a[180:183], v[40:43], v[168:171]
    s_or_b32 s40, s4, s11
    ds_read_b64_tr_b16 a[176:177], v10 offset:16384
    v_fmac_f32 v121, v117, v117
    v_mfma_f32_16x16x32_bf16 v[168:171], a[184:187], v[56:59], v[168:171]
    s_add_u32 m0, s41, 57344
    ds_read_b64_tr_b16 a[178:179], v10 offset:17408
    v_accvgpr_read_b32 v116, a194
    v_mfma_f32_16x16x32_bf16 v[172:175], a[180:183], v[44:47], v[172:175]
    buffer_load_dwordx4 v18, s[16:19], s101 offen lds
    v_mfma_f32_16x16x32_bf16 v[172:175], a[184:187], v[60:63], v[172:175]
    s_waitcnt lgkmcnt(7)
    ds_read_b64_tr_b16 a[236:237], v30 offset:8192
    v_lshlrev_b32 v118, 16, v116
    v_mfma_f32_16x16x32_bf16 v[176:179], a[164:167], v[32:35], v[176:179]
    ds_read_b64_tr_b16 a[180:181], v10 offset:8
    v_and_b32 v116, 0xffff0000, v116
    v_mfma_f32_16x16x32_bf16 v[176:179], a[168:171], v[48:51], v[176:179]
    ds_read_b64_tr_b16 a[182:183], v10 offset:1032
    v_add_f32 v120, v120, v118
    v_mfma_f32_16x16x32_bf16 v[180:183], a[164:167], v[36:39], v[180:183]
    s_add_u32 m0, s41, 58368
    ds_read_b64_tr_b16 a[238:239], v30 offset:9216
    v_fmac_f32 v121, v118, v118
    v_mfma_f32_16x16x32_bf16 v[180:183], a[168:171], v[52:55], v[180:183]
    buffer_load_dwordx4 v19, s[16:19], s101 offen lds
    v_mfma_f32_16x16x32_bf16 v[184:187], a[164:167], v[40:43], v[184:187]
    ds_read_b64_tr_b16 a[184:185], v10 offset:16392
    v_add_f32 v120, v120, v116
    v_mfma_f32_16x16x32_bf16 v[184:187], a[168:171], v[56:59], v[184:187]
    s_lshl1_add_u32 s7, s33, -10
    ds_read_b64_tr_b16 a[186:187], v10 offset:17416
    v_fmac_f32 v121, v116, v116
    v_mfma_f32_16x16x32_bf16 v[188:191], a[164:167], v[44:47], v[188:191]
    v_accvgpr_read_b32 v117, a195
    v_lshlrev_b32 v119, 16, v117
    v_mfma_f32_16x16x32_bf16 v[188:191], a[168:171], v[60:63], v[188:191]
    s_waitcnt lgkmcnt(6)
    v_and_b32 v117, 0xffff0000, v117
    v_add_f32 v120, v120, v119
    v_mfma_f32_16x16x32_bf16 v[192:195], a[172:175], v[32:35], v[192:195]
    s_and_b32 s7, s7, 24
    ds_read_b64_tr_b16 a[164:165], v11 offset:0
    v_fmac_f32 v121, v119, v119
    v_mfma_f32_16x16x32_bf16 v[192:195], a[176:179], v[48:51], v[192:195]
    ds_read_b64_tr_b16 a[166:167], v11 offset:1024
    v_add_f32 v120, v120, v117
    v_mfma_f32_16x16x32_bf16 v[196:199], a[172:175], v[36:39], v[196:199]
    global_load_dword v124, v115, s[0:1]
    v_mfma_f32_16x16x32_bf16 v[196:199], a[176:179], v[52:55], v[196:199]
    s_max_u32 s7, s7, 8
    s_add_u32 s7, s7, s35
    v_fmac_f32 v121, v117, v117
    v_mfma_f32_16x16x32_bf16 v[200:203], a[172:175], v[40:43], v[200:203]
    s_and_b32 s7, s7, 24
    ds_read_b64_tr_b16 a[168:169], v11 offset:16384
    v_accvgpr_read_b32 v116, a196
    v_mfma_f32_16x16x32_bf16 v[200:203], a[176:179], v[56:59], v[200:203]
    s_or_b32 s7, s7, s45
    ds_read_b64_tr_b16 a[170:171], v11 offset:17408
    v_lshlrev_b32 v118, 16, v116
    v_mfma_f32_16x16x32_bf16 v[204:207], a[172:175], v[44:47], v[204:207]
    v_and_b32 v116, 0xffff0000, v116
    v_add_f32 v120, v120, v118
    v_mfma_f32_16x16x32_bf16 v[204:207], a[176:179], v[60:63], v[204:207]
    s_waitcnt lgkmcnt(4)
    v_fmac_f32 v121, v118, v118
    v_add_f32 v120, v120, v116
    v_mfma_f32_16x16x32_bf16 v[208:211], a[180:183], v[32:35], v[208:211]
    s_mul_i32 s7, s7, s50
    ds_read_b64_tr_b16 a[172:173], v11 offset:8
    v_fmac_f32 v121, v116, v116
    v_mfma_f32_16x16x32_bf16 v[208:211], a[184:187], v[48:51], v[208:211]
    s_bitcmp1_b32 s51, s33
    ds_read_b64_tr_b16 a[174:175], v11 offset:1032
    v_accvgpr_read_b32 v117, a197
    v_mfma_f32_16x16x32_bf16 v[212:215], a[180:183], v[36:39], v[212:215]
    s_cselect_b32 s7, s7, 0x40000000
    v_lshlrev_b32 v119, 16, v117
    v_and_b32 v117, 0xffff0000, v117
    v_mfma_f32_16x16x32_bf16 v[212:215], a[184:187], v[52:55], v[212:215]
    buffer_load_dword v124, v126, s[84:87], s7 offen
    v_mfma_f32_16x16x32_bf16 v[216:219], a[180:183], v[40:43], v[216:219]
    ds_read_b64_tr_b16 a[176:177], v11 offset:16392
    v_add_f32 v120, v120, v119
    v_mfma_f32_16x16x32_bf16 v[216:219], a[184:187], v[56:59], v[216:219]
    ds_read_b64_tr_b16 a[178:179], v11 offset:17416
    v_fmac_f32 v121, v119, v119
    v_mfma_f32_16x16x32_bf16 v[220:223], a[180:183], v[44:47], v[220:223]
    v_add_f32 v120, v120, v117
    v_fmac_f32 v121, v117, v117
    v_mfma_f32_16x16x32_bf16 v[220:223], a[184:187], v[60:63], v[220:223]
    s_waitcnt lgkmcnt(4)
    v_accvgpr_read_b32 v116, a198
    v_lshlrev_b32 v118, 16, v116
    v_mfma_f32_16x16x32_bf16 v[224:227], a[164:167], v[32:35], v[224:227]
    ds_read_b64_tr_b16 a[180:181], v12 offset:8192
    v_and_b32 v116, 0xffff0000, v116
    v_mfma_f32_16x16x32_bf16 v[224:227], a[168:171], v[48:51], v[224:227]
    s_xor_b32 m0, s68, 0x0
    ds_read_b64_tr_b16 a[182:183], v12 offset:9216
    v_add_f32 v120, v120, v118
    v_mfma_f32_16x16x32_bf16 v[228:231], a[164:167], v[36:39], v[228:231]
    buffer_load_dwordx4 v20, s[72:75], s40 offen offset:0 lds
    v_mfma_f32_16x16x32_bf16 v[228:231], a[168:171], v[52:55], v[228:231]
    v_fmac_f32 v121, v118, v118
    v_add_f32 v120, v120, v116
    v_mfma_f32_16x16x32_bf16 v[232:235], a[164:167], v[40:43], v[232:235]
    ds_read_b64_tr_b16 a[184:185], v12 offset:24576
    v_fmac_f32 v121, v116, v116
    v_mfma_f32_16x16x32_bf16 v[232:235], a[168:171], v[56:59], v[232:235]
    ds_read_b64_tr_b16 a[186:187], v12 offset:25600
    v_accvgpr_read_b32 v117, a199
    v_mfma_f32_16x16x32_bf16 v[236:239], a[164:167], v[44:47], v[236:239]
    buffer_load_dwordx4 v21, s[72:75], s40 offen offset:1024 lds
    v_mfma_f32_16x16x32_bf16 v[236:239], a[168:171], v[60:63], v[236:239]
    s_waitcnt lgkmcnt(4)
    v_lshlrev_b32 v119, 16, v117
    v_and_b32 v117, 0xffff0000, v117
    v_mfma_f32_16x16x32_bf16 v[240:243], a[172:175], v[32:35], v[240:243]
    ds_read_b64_tr_b16 a[164:165], v13 offset:8192
    v_add_f32 v120, v120, v119
    v_mfma_f32_16x16x32_bf16 v[240:243], a[176:179], v[48:51], v[240:243]
    s_xor_b32 s36, s40, 0x8000
    ds_read_b64_tr_b16 a[166:167], v13 offset:9216
    v_fmac_f32 v121, v119, v119
    v_mfma_f32_16x16x32_bf16 v[244:247], a[172:175], v[36:39], v[244:247]
    s_xor_b32 m0, s68, 0x800
    v_add_f32 v120, v120, v117
    v_fmac_f32 v121, v117, v117
    v_mfma_f32_16x16x32_bf16 v[244:247], a[176:179], v[52:55], v[244:247]
    buffer_load_dwordx4 v20, s[72:75], s36 offen offset:0 lds
    v_mfma_f32_16x16x32_bf16 v[248:251], a[172:175], v[40:43], v[248:251]
    s_lshl_b32 s37, s32, 18
    ds_read_b64_tr_b16 a[168:169], v13 offset:24576
    v_accvgpr_read_b32 v116, a200
    v_mfma_f32_16x16x32_bf16 v[248:251], a[176:179], v[56:59], v[248:251]
    s_add_u32 s100, s37, 0x40000
    ds_read_b64_tr_b16 a[170:171], v13 offset:25600
    v_lshlrev_b32 v118, 16, v116
    v_mfma_f32_16x16x32_bf16 v[252:255], a[172:175], v[44:47], v[252:255]
    v_and_b32 v116, 0xffff0000, v116
    v_add_f32 v120, v120, v118
    v_mfma_f32_16x16x32_bf16 v[252:255], a[176:179], v[60:63], v[252:255]
    s_waitcnt lgkmcnt(4)
    s_waitcnt lgkmcnt(15)
    v_mfma_f32_16x16x32_bf16 a[144:147], a[208:211], a[224:227], a[144:147]
    v_mfma_f32_16x16x32_bf16 a[144:147], a[212:215], a[228:231], a[144:147]
    v_mfma_f32_16x16x32_bf16 a[144:147], a[216:219], a[232:235], a[144:147]
    v_mfma_f32_16x16x32_bf16 a[144:147], a[220:223], a[236:239], a[144:147]
    v_mfma_f32_16x16x32_bf16 a[0:3], a[180:183], v[32:35], a[0:3]
    s_mul_i32 s38, s32, 229376
    ds_read_b64_tr_b16 a[172:173], v14 offset:8192
    v_fmac_f32 v121, v118, v118
    v_mfma_f32_16x16x32_bf16 a[0:3], a[184:187], v[48:51], a[0:3]
    s_add_u32 s101, s38, 229376
    ds_read_b64_tr_b16 a[174:175], v14 offset:9216
    v_add_f32 v120, v120, v116
    v_mfma_f32_16x16x32_bf16 a[4:7], a[180:183], v[36:39], a[4:7]
    buffer_load_dwordx4 v21, s[72:75], s36 offen offset:1024 lds
    v_mfma_f32_16x16x32_bf16 a[4:7], a[184:187], v[52:55], a[4:7]
    v_fmac_f32 v121, v116, v116
    v_accvgpr_read_b32 v117, a201
    v_mfma_f32_16x16x32_bf16 a[8:11], a[180:183], v[40:43], a[8:11]
    s_xor_b32 s36, s40, 0x10000
    ds_read_b64_tr_b16 a[176:177], v14 offset:24576
    v_lshlrev_b32 v119, 16, v117
    v_mfma_f32_16x16x32_bf16 a[8:11], a[184:187], v[56:59], a[8:11]
    s_xor_b32 m0, s68, 0x1000
    ds_read_b64_tr_b16 a[178:179], v14 offset:25600
    v_and_b32 v117, 0xffff0000, v117
    v_mfma_f32_16x16x32_bf16 a[12:15], a[180:183], v[44:47], a[12:15]
    buffer_load_dwordx4 v20, s[72:75], s36 offen offset:0 lds
    v_mfma_f32_16x16x32_bf16 a[12:15], a[184:187], v[60:63], a[12:15]
    s_waitcnt lgkmcnt(4)
    v_add_f32 v120, v120, v119
    v_fmac_f32 v121, v119, v119
    v_mfma_f32_16x16x32_bf16 a[16:19], a[164:167], v[32:35], a[16:19]
    ds_read_b64_tr_b16 a[180:181], v15 offset:8192
    v_add_f32 v120, v120, v117
    v_mfma_f32_16x16x32_bf16 a[16:19], a[168:171], v[48:51], a[16:19]
    ds_read_b64_tr_b16 a[182:183], v15 offset:9216
    v_fmac_f32 v121, v117, v117
    v_mfma_f32_16x16x32_bf16 a[20:23], a[164:167], v[36:39], a[20:23]
    v_accvgpr_read_b32 v116, a202
    v_lshlrev_b32 v118, 16, v116
    v_mfma_f32_16x16x32_bf16 a[20:23], a[168:171], v[52:55], a[20:23]
    buffer_load_dwordx4 v21, s[72:75], s36 offen offset:1024 lds
    v_mfma_f32_16x16x32_bf16 a[24:27], a[164:167], v[40:43], a[24:27]
    ds_read_b64_tr_b16 a[184:185], v15 offset:24576
    v_and_b32 v116, 0xffff0000, v116
    v_mfma_f32_16x16x32_bf16 a[24:27], a[168:171], v[56:59], a[24:27]
    ds_read_b64_tr_b16 a[186:187], v15 offset:25600
    v_add_f32 v120, v120, v118
    v_mfma_f32_16x16x32_bf16 a[28:31], a[164:167], v[44:47], a[28:31]
    v_fmac_f32 v121, v118, v118
    v_add_f32 v120, v120, v116
    v_mfma_f32_16x16x32_bf16 a[28:31], a[168:171], v[60:63], a[28:31]
    s_waitcnt lgkmcnt(4)
    v_fmac_f32 v121, v116, v116
    v_accvgpr_read_b32 v117, a203
    v_mfma_f32_16x16x32_bf16 a[32:35], a[172:175], v[32:35], a[32:35]
    s_xor_b32 s36, s40, 0x18000
    ds_read_b64_tr_b16 a[164:165], v2 offset:8192
    v_lshlrev_b32 v119, 16, v117
    v_mfma_f32_16x16x32_bf16 a[32:35], a[176:179], v[48:51], a[32:35]
    s_xor_b32 m0, s68, 0x1800
    ds_read_b64_tr_b16 a[166:167], v2 offset:9216
    v_and_b32 v117, 0xffff0000, v117
    v_mfma_f32_16x16x32_bf16 a[36:39], a[172:175], v[36:39], a[36:39]
    buffer_load_dwordx4 v20, s[72:75], s36 offen offset:0 lds
    v_mfma_f32_16x16x32_bf16 a[36:39], a[176:179], v[52:55], a[36:39]
    v_add_f32 v120, v120, v119
    v_fmac_f32 v121, v119, v119
    v_mfma_f32_16x16x32_bf16 a[40:43], a[172:175], v[40:43], a[40:43]
    ds_read_b64_tr_b16 a[168:169], v2 offset:24576
    v_add_f32 v120, v120, v117
    v_mfma_f32_16x16x32_bf16 a[40:43], a[176:179], v[56:59], a[40:43]
    ds_read_b64_tr_b16 a[170:171], v2 offset:25600
    v_fmac_f32 v121, v117, v117
    v_mfma_f32_16x16x32_bf16 a[44:47], a[172:175], v[44:47], a[44:47]
    buffer_load_dwordx4 v21, s[72:75], s36 offen offset:1024 lds
    v_mfma_f32_16x16x32_bf16 a[44:47], a[176:179], v[60:63], a[44:47]
    s_waitcnt lgkmcnt(4)
    v_accvgpr_read_b32 v116, a204
    v_lshlrev_b32 v118, 16, v116
    v_mfma_f32_16x16x32_bf16 a[48:51], a[180:183], v[32:35], a[48:51]
    s_waitcnt vmcnt(18)
    ds_read_b64_tr_b16 a[172:173], v3 offset:8192
    v_and_b32 v116, 0xffff0000, v116
    v_mfma_f32_16x16x32_bf16 a[48:51], a[184:187], v[48:51], a[48:51]
    ds_read_b64_tr_b16 a[174:175], v3 offset:9216
    v_add_f32 v120, v120, v118
    v_mfma_f32_16x16x32_bf16 a[52:55], a[180:183], v[36:39], a[52:55]
    ds_read_b128 v[64:67], v26 offset:0
    v_fmac_f32 v121, v118, v118
    v_mfma_f32_16x16x32_bf16 a[52:55], a[184:187], v[52:55], a[52:55]
    ds_read_b128 v[80:83], v27 offset:0
    v_add_f32 v120, v120, v116
    v_mfma_f32_16x16x32_bf16 a[56:59], a[180:183], v[40:43], a[56:59]
    ds_read_b64_tr_b16 a[176:177], v3 offset:24576
    v_fmac_f32 v121, v116, v116
    v_mfma_f32_16x16x32_bf16 a[56:59], a[184:187], v[56:59], a[56:59]
    ds_read_b64_tr_b16 a[178:179], v3 offset:25600
    v_accvgpr_read_b32 v117, a205
    v_mfma_f32_16x16x32_bf16 a[60:63], a[180:183], v[44:47], a[60:63]
    ds_read_b128 v[68:71], v26 offset:2048
    v_lshlrev_b32 v119, 16, v117
    v_mfma_f32_16x16x32_bf16 a[60:63], a[184:187], v[60:63], a[60:63]
    s_waitcnt lgkmcnt(7)
    ds_read_b128 v[84:87], v27 offset:2048
    v_and_b32 v117, 0xffff0000, v117
    v_mfma_f32_16x16x32_bf16 a[64:67], a[164:167], v[32:35], a[64:67]
    ds_read_b64_tr_b16 a[180:181], v4 offset:8192
    v_add_f32 v120, v120, v119
    v_mfma_f32_16x16x32_bf16 a[64:67], a[168:171], v[48:51], a[64:67]
    ds_read_b64_tr_b16 a[182:183], v4 offset:9216
    v_fmac_f32 v121, v119, v119
    v_mfma_f32_16x16x32_bf16 a[68:71], a[164:167], v[36:39], a[68:71]
    ds_read_b64_tr_b16 a[184:185], v4 offset:24576
    v_add_f32 v120, v120, v117
    v_mfma_f32_16x16x32_bf16 a[68:71], a[168:171], v[52:55], a[68:71]
    ds_read_b64_tr_b16 a[186:187], v4 offset:25600
    v_fmac_f32 v121, v117, v117
    v_mfma_f32_16x16x32_bf16 a[72:75], a[164:167], v[40:43], a[72:75]
    ds_read_b128 v[72:75], v26 offset:4096
    v_accvgpr_read_b32 v116, a206
    v_mfma_f32_16x16x32_bf16 a[72:75], a[168:171], v[56:59], a[72:75]
    ds_read_b128 v[88:91], v27 offset:4096
    v_lshlrev_b32 v118, 16, v116
    v_mfma_f32_16x16x32_bf16 a[76:79], a[164:167], v[44:47], a[76:79]
    ds_read_b128 v[76:79], v26 offset:6144
    v_and_b32 v116, 0xffff0000, v116
    v_mfma_f32_16x16x32_bf16 a[76:79], a[168:171], v[60:63], a[76:79]
    s_waitcnt lgkmcnt(9)
    v_add_f32 v120, v120, v118
    v_fmac_f32 v121, v118, v118
    v_mfma_f32_16x16x32_bf16 a[80:83], a[172:175], v[32:35], a[80:83]
    ds_read_b128 v[92:95], v27 offset:6144
    v_add_f32 v120, v120, v116
    v_mfma_f32_16x16x32_bf16 a[80:83], a[176:179], v[48:51], a[80:83]
    s_waitcnt vmcnt(10)
    s_waitcnt lgkmcnt(0)
    s_barrier
    v_fmac_f32 v121, v116, v116
    v_mfma_f32_16x16x32_bf16 a[84:87], a[172:175], v[36:39], a[84:87]
    ds_read_b64_tr_b16 a[164:165], v8 offset:32768
    v_accvgpr_read_b32 v117, a207
    v_mfma_f32_16x16x32_bf16 a[84:87], a[176:179], v[52:55], a[84:87]
    ds_read_b64_tr_b16 a[166:167], v8 offset:33792
    v_lshlrev_b32 v119, 16, v117
    v_mfma_f32_16x16x32_bf16 a[88:91], a[172:175], v[40:43], a[88:91]
    ds_read_b64_tr_b16 a[168:169], v8 offset:49152
    v_and_b32 v117, 0xffff0000, v117
    v_mfma_f32_16x16x32_bf16 a[88:91], a[176:179], v[56:59], a[88:91]
    s_add_u32 m0, s41, 0
    ds_read_b64_tr_b16 a[170:171], v8 offset:50176
    v_add_f32 v120, v120, v119
    v_mfma_f32_16x16x32_bf16 a[92:95], a[172:175], v[44:47], a[92:95]
    buffer_load_dwordx4 v16, s[12:15], s37 offen lds
    v_mfma_f32_16x16x32_bf16 a[92:95], a[176:179], v[60:63], a[92:95]
    s_lshl_b32 s9, s39, 7
    v_fmac_f32 v121, v119, v119
    v_add_f32 v120, v120, v117
    v_mfma_f32_16x16x32_bf16 a[96:99], a[180:183], v[32:35], a[96:99]
    s_cmp_lt_u32 s33, 16
    ds_read_b64_tr_b16 a[172:173], v8 offset:32776
    v_fmac_f32 v121, v117, v117
    v_mfma_f32_16x16x32_bf16 a[96:99], a[184:187], v[48:51], a[96:99]
    s_cselect_b32 s9, s9, 0x40000000
    ds_read_b64_tr_b16 a[174:175], v8 offset:33800
    v_mfma_f32_16x16x32_bf16 a[100:103], a[180:183], v[36:39], a[100:103]
    s_add_u32 m0, s41, 1024
    v_mfma_f32_16x16x32_bf16 a[100:103], a[184:187], v[52:55], a[100:103]
    buffer_load_dwordx4 v17, s[12:15], s37 offen lds
    v_mfma_f32_16x16x32_bf16 a[104:107], a[180:183], v[40:43], a[104:107]
    ds_read_b64_tr_b16 a[176:177], v8 offset:49160
    v_mfma_f32_16x16x32_bf16 a[104:107], a[184:187], v[56:59], a[104:107]
    ds_read_b64_tr_b16 a[178:179], v8 offset:50184
    v_mfma_f32_16x16x32_bf16 a[108:111], a[180:183], v[44:47], a[108:111]
    v_mfma_f32_16x16x32_bf16 a[108:111], a[184:187], v[60:63], a[108:111]
    s_waitcnt lgkmcnt(4)
    v_mfma_f32_16x16x32_bf16 v[128:131], a[164:167], v[64:67], v[128:131]
    s_add_u32 s33, s33, 2
    ds_read_b64_tr_b16 a[180:181], v9 offset:32768
    v_mfma_f32_16x16x32_bf16 v[128:131], a[168:171], v[80:83], v[128:131]
    s_add_u32 m0, s41, 8192
    ds_read_b64_tr_b16 a[182:183], v9 offset:33792
    v_mfma_f32_16x16x32_bf16 v[132:135], a[164:167], v[68:71], v[132:135]
    buffer_load_dwordx4 v18, s[16:19], s38 offen lds
    v_mfma_f32_16x16x32_bf16 v[132:135], a[168:171], v[84:87], v[132:135]
    s_lshr_b32 s4, s33, 1
    s_xor_b32 s4, s4, s33
    v_add_f32_dpp v120, v120, v120 row_shr:1 row_mask:0xf bank_mask:0xf bound_ctrl:0
    v_mfma_f32_16x16x32_bf16 v[136:139], a[164:167], v[72:75], v[136:139]
    s_lshr_b32 s5, s33, 2
    ds_read_b64_tr_b16 a[184:185], v9 offset:49152
    v_add_f32_dpp v121, v121, v121 row_shr:1 row_mask:0xf bank_mask:0xf bound_ctrl:0
    v_mfma_f32_16x16x32_bf16 v[136:139], a[168:171], v[88:91], v[136:139]
    s_add_u32 m0, s41, 9216
    ds_read_b64_tr_b16 a[186:187], v9 offset:50176
    v_add_f32_dpp v120, v120, v120 row_shr:2 row_mask:0xf bank_mask:0xf bound_ctrl:0
    v_mfma_f32_16x16x32_bf16 v[140:143], a[164:167], v[76:79], v[140:143]
    buffer_load_dwordx4 v19, s[16:19], s38 offen lds
    v_mfma_f32_16x16x32_bf16 v[140:143], a[168:171], v[92:95], v[140:143]
    s_waitcnt lgkmcnt(4)
    v_add_f32_dpp v121, v121, v121 row_shr:2 row_mask:0xf bank_mask:0xf bound_ctrl:0
    v_mfma_f32_16x16x32_bf16 v[144:147], a[172:175], v[64:67], v[144:147]
    s_and_b32 s4, s4, s5
    ds_read_b64_tr_b16 a[164:165], v9 offset:32776
    v_add_f32_dpp v120, v120, v120 row_shr:4 row_mask:0xf bank_mask:0xf bound_ctrl:0
    v_mfma_f32_16x16x32_bf16 v[144:147], a[176:179], v[80:83], v[144:147]
    s_and_b32 s4, s4, 4
    ds_read_b64_tr_b16 a[166:167], v9 offset:33800
    v_add_f32_dpp v121, v121, v121 row_shr:4 row_mask:0xf bank_mask:0xf bound_ctrl:0
    v_mfma_f32_16x16x32_bf16 v[148:151], a[172:175], v[68:71], v[148:151]
    s_add_u32 m0, s41, 16384
    s_mul_i32 s4, s4, 3
    v_add_f32_dpp v120, v120, v120 row_shr:8 row_mask:0xf bank_mask:0xf bound_ctrl:0
    v_mfma_f32_16x16x32_bf16 v[148:151], a[176:179], v[84:87], v[148:151]
    buffer_load_dwordx4 v16, s[12:15], s100 offen lds
    v_mfma_f32_16x16x32_bf16 v[152:155], a[172:175], v[72:75], v[152:155]
    s_xor_b32 s4, s4, s33
    ds_read_b64_tr_b16 a[168:169], v9 offset:49160
    v_add_f32_dpp v121, v121, v121 row_shr:8 row_mask:0xf bank_mask:0xf bound_ctrl:0
    v_mfma_f32_16x16x32_bf16 v[152:155], a[176:179], v[88:91], v[152:155]
    s_add_u32 s5, s4, s35
    ds_read_b64_tr_b16 a[170:171], v9 offset:50184
    v_add_f32_dpp v120, v120, v120 row_bcast:15 row_mask:0xa bank_mask:0xf
    v_mfma_f32_16x16x32_bf16 v[156:159], a[172:175], v[76:79], v[156:159]
    s_and_b32 s5, s5, 24
    s_add_u32 s4, s4, s34
    v_add_f32_dpp v121, v121, v121 row_bcast:15 row_mask:0xa bank_mask:0xf
    v_mfma_f32_16x16x32_bf16 v[156:159], a[176:179], v[92:95], v[156:159]
    s_waitcnt lgkmcnt(4)
    v_mul_f32 v120, 0xba800000, v120
    v_mul_f32 v121, 0x3a800000, v121
    v_mfma_f32_16x16x32_bf16 v[160:163], a[180:183], v[64:67], v[160:163]
    s_and_b32 s4, s4, 6
    ds_read_b64_tr_b16 a[172:173], v10 offset:32768
    v_fma_f32 v121, -v120, v120, v121
    v_mfma_f32_16x16x32_bf16 v[160:163], a[184:187], v[80:83], v[160:163]
    s_add_u32 m0, s41, 17408
    ds_read_b64_tr_b16 a[174:175], v10 offset:33792
    v_max_f32 v121, 0, v121
    v_mfma_f32_16x16x32_bf16 v[164:167], a[180:183], v[68:71], v[164:167]
    buffer_load_dwordx4 v17, s[12:15], s100 offen lds
    v_mfma_f32_16x16x32_bf16 v[164:167], a[184:187], v[84:87], v[164:167]
    s_or_b32 s32, s4, s5
    s_lshl_b32 s4, s32, 6
    v_mul_f32 v120, 0.5, v120
    v_mfma_f32_16x16x32_bf16 v[168:171], a[180:183], v[72:75], v[168:171]
    s_or_b32 s40, s4, s11
    ds_read_b64_tr_b16 a[176:177], v10 offset:49152
    v_cvt_pk_bf16_f32 v116, v120, v120
    v_mfma_f32_16x16x32_bf16 v[168:171], a[184:187], v[88:91], v[168:171]
    s_add_u32 m0, s41, 24576
    ds_read_b64_tr_b16 a[178:179], v10 offset:50176
    v_cvt_pk_bf16_f32 v117, v120, v120
    v_mfma_f32_16x16x32_bf16 v[172:175], a[180:183], v[76:79], v[172:175]
    buffer_load_dwordx4 v18, s[16:19], s101 offen lds
    v_mfma_f32_16x16x32_bf16 v[172:175], a[184:187], v[92:95], v[172:175]
    s_waitcnt lgkmcnt(4)
    v_cvt_pk_bf16_f32 v118, v120, v120
    v_cvt_pk_bf16_f32 v119, v120, v120
    v_mfma_f32_16x16x32_bf16 v[176:179], a[164:167], v[64:67], v[176:179]
    ds_read_b64_tr_b16 a[180:181], v10 offset:32776
    v_cvt_pk_bf16_f32 v121, v121, v121
    v_mfma_f32_16x16x32_bf16 v[176:179], a[168:171], v[80:83], v[176:179]
    ds_read_b64_tr_b16 a[182:183], v10 offset:33800
    v_lshlrev_b32 v121, 16, v121
    v_mfma_f32_16x16x32_bf16 v[180:183], a[164:167], v[68:71], v[180:183]
    s_add_u32 m0, s41, 25600
    v_add_f32 v121, 0x3727c5ac, v121
    v_cvt_pk_bf16_f32 v121, v121, v121
    v_mfma_f32_16x16x32_bf16 v[180:183], a[168:171], v[84:87], v[180:183]
    buffer_load_dwordx4 v19, s[16:19], s101 offen lds
    v_mfma_f32_16x16x32_bf16 v[184:187], a[164:167], v[72:75], v[184:187]
    s_and_b32 s4, s43, 0x6000
    ds_read_b64_tr_b16 a[184:185], v10 offset:49160
    v_lshlrev_b32 v121, 16, v121
    v_mfma_f32_16x16x32_bf16 v[184:187], a[168:171], v[88:91], v[184:187]
    s_lshl1_add_u32 s7, s33, -10
    ds_read_b64_tr_b16 a[186:187], v10 offset:50184
    v_sqrt_f32 v121, v121
    v_mfma_f32_16x16x32_bf16 v[188:191], a[164:167], v[76:79], v[188:191]
    buffer_load_dwordx4 a[192:195], v22, s[72:75], s9 offen offset:0
    v_mfma_f32_16x16x32_bf16 v[188:191], a[168:171], v[92:95], v[188:191]
    s_waitcnt lgkmcnt(4)
    v_lshrrev_b32 v120, 2, v31
    v_cvt_pk_bf16_f32 v121, v121, v121
    v_mfma_f32_16x16x32_bf16 v[192:195], a[172:175], v[64:67], v[192:195]
    s_and_b32 s7, s7, 24
    ds_read_b64_tr_b16 a[164:165], v11 offset:32768
    v_lshlrev_b32 v121, 16, v121
    v_mfma_f32_16x16x32_bf16 v[192:195], a[176:179], v[80:83], v[192:195]
    s_add_u32 m0, s42, s4
    ds_read_b64_tr_b16 a[166:167], v11 offset:33792
    v_rcp_f32 v121, v121
    v_mfma_f32_16x16x32_bf16 v[196:199], a[172:175], v[68:71], v[196:199]
    buffer_load_dwordx4 v112, s[20:23], s43 offen offset:0 lds
    v_mfma_f32_16x16x32_bf16 v[196:199], a[176:179], v[84:87], v[196:199]
    s_max_u32 s7, s7, 8
    s_add_u32 s7, s7, s35
    v_mfma_f32_16x16x32_bf16 v[200:203], a[172:175], v[72:75], v[200:203]
    s_and_b32 s7, s7, 24
    ds_read_b64_tr_b16 a[168:169], v11 offset:49152
    v_mfma_f32_16x16x32_bf16 v[200:203], a[176:179], v[88:91], v[200:203]
    s_or_b32 s7, s7, s45
    ds_read_b64_tr_b16 a[170:171], v11 offset:50176
    v_mfma_f32_16x16x32_bf16 v[204:207], a[172:175], v[76:79], v[204:207]
    buffer_load_dwordx4 v113, s[20:23], s43 offen offset:1024 lds
    v_mfma_f32_16x16x32_bf16 v[204:207], a[176:179], v[92:95], v[204:207]
    s_waitcnt lgkmcnt(4)
    v_mfma_f32_16x16x32_bf16 v[208:211], a[180:183], v[64:67], v[208:211]
    s_mul_i32 s7, s7, s50
    ds_read_b64_tr_b16 a[172:173], v11 offset:32776
    v_mfma_f32_16x16x32_bf16 v[208:211], a[184:187], v[80:83], v[208:211]
    s_bitcmp1_b32 s51, s33
    ds_read_b64_tr_b16 a[174:175], v11 offset:33800
    v_mfma_f32_16x16x32_bf16 v[212:215], a[180:183], v[68:71], v[212:215]
    s_cselect_b32 s7, s7, 0x40000000
    v_mfma_f32_16x16x32_bf16 v[212:215], a[184:187], v[84:87], v[212:215]
    buffer_load_dword v124, v126, s[84:87], s7 offen
    v_mfma_f32_16x16x32_bf16 v[216:219], a[180:183], v[72:75], v[216:219]
    ds_read_b64_tr_b16 a[176:177], v11 offset:49160
    v_mfma_f32_16x16x32_bf16 v[216:219], a[184:187], v[88:91], v[216:219]
    ds_read_b64_tr_b16 a[178:179], v11 offset:50184
    v_mfma_f32_16x16x32_bf16 v[220:223], a[180:183], v[76:79], v[220:223]
    buffer_load_dwordx4 a[196:199], v22, s[72:75], s9 offen offset:512
    v_mfma_f32_16x16x32_bf16 v[220:223], a[184:187], v[92:95], v[220:223]
    s_waitcnt lgkmcnt(4)
    v_mfma_f32_16x16x32_bf16 v[224:227], a[164:167], v[64:67], v[224:227]
    ds_read_b64_tr_b16 a[180:181], v12 offset:40960
    v_mfma_f32_16x16x32_bf16 v[224:227], a[168:171], v[80:83], v[224:227]
    s_xor_b32 m0, s68, 0x28000
    ds_read_b64_tr_b16 a[182:183], v12 offset:41984
    v_mfma_f32_16x16x32_bf16 v[228:231], a[164:167], v[68:71], v[228:231]
    buffer_load_dwordx4 v20, s[72:75], s40 offen offset:0 lds
    v_mfma_f32_16x16x32_bf16 v[228:231], a[168:171], v[84:87], v[228:231]
    buffer_load_dwordx4 a[200:203], v22, s[72:75], s9 offen offset:1024
    v_mfma_f32_16x16x32_bf16 v[232:235], a[164:167], v[72:75], v[232:235]
    s_cmp_lt_u32 s33, 16
    ds_read_b64_tr_b16 a[184:185], v12 offset:57344
    v_mfma_f32_16x16x32_bf16 v[232:235], a[168:171], v[88:91], v[232:235]
    s_cselect_b32 s7, 0x40000000, s39
    ds_read_b64_tr_b16 a[186:187], v12 offset:58368
    v_mfma_f32_16x16x32_bf16 v[236:239], a[164:167], v[76:79], v[236:239]
    buffer_load_dwordx4 v21, s[72:75], s40 offen offset:1024 lds
    v_mfma_f32_16x16x32_bf16 v[236:239], a[168:171], v[92:95], v[236:239]
    s_waitcnt lgkmcnt(4)
    v_mfma_f32_16x16x32_bf16 v[240:243], a[172:175], v[64:67], v[240:243]
    ds_read_b64_tr_b16 a[164:165], v13 offset:40960
    v_mfma_f32_16x16x32_bf16 v[240:243], a[176:179], v[80:83], v[240:243]
    s_xor_b32 s36, s40, 0x8000
    ds_read_b64_tr_b16 a[166:167], v13 offset:41984
    v_mfma_f32_16x16x32_bf16 v[244:247], a[172:175], v[68:71], v[244:247]
    s_xor_b32 m0, s68, 0x28800
    v_mfma_f32_16x16x32_bf16 v[244:247], a[176:179], v[84:87], v[244:247]
    buffer_load_dwordx4 v20, s[72:75], s36 offen offset:0 lds
    v_mfma_f32_16x16x32_bf16 v[248:251], a[172:175], v[72:75], v[248:251]
    s_lshl_b32 s37, s32, 18
    ds_read_b64_tr_b16 a[168:169], v13 offset:57344
    v_mfma_f32_16x16x32_bf16 v[248:251], a[176:179], v[88:91], v[248:251]
    s_add_u32 s100, s37, 0x40000
    ds_read_b64_tr_b16 a[170:171], v13 offset:58368
    v_mfma_f32_16x16x32_bf16 v[252:255], a[172:175], v[76:79], v[252:255]
    buffer_load_dwordx4 a[204:207], v22, s[72:75], s9 offen offset:1536
    v_mfma_f32_16x16x32_bf16 v[252:255], a[176:179], v[92:95], v[252:255]
    s_waitcnt lgkmcnt(4)
    v_mfma_f32_16x16x32_bf16 a[0:3], a[180:183], v[64:67], a[0:3]
    s_mul_i32 s38, s32, 229376
    ds_read_b64_tr_b16 a[172:173], v14 offset:40960
    v_mfma_f32_16x16x32_bf16 a[0:3], a[184:187], v[80:83], a[0:3]
    s_add_u32 s101, s38, 229376
    ds_read_b64_tr_b16 a[174:175], v14 offset:41984
    v_mfma_f32_16x16x32_bf16 a[4:7], a[180:183], v[68:71], a[4:7]
    buffer_load_dwordx4 v21, s[72:75], s36 offen offset:1024 lds
    v_mfma_f32_16x16x32_bf16 a[4:7], a[184:187], v[84:87], a[4:7]
    buffer_store_dwordx4 v[116:119], v31, s[28:31], s7 offen offset:0 sc1
    v_mfma_f32_16x16x32_bf16 a[8:11], a[180:183], v[72:75], a[8:11]
    s_xor_b32 s36, s40, 0x10000
    ds_read_b64_tr_b16 a[176:177], v14 offset:57344
    v_mfma_f32_16x16x32_bf16 a[8:11], a[184:187], v[88:91], a[8:11]
    s_xor_b32 m0, s68, 0x29000
    ds_read_b64_tr_b16 a[178:179], v14 offset:58368
    v_mfma_f32_16x16x32_bf16 a[12:15], a[180:183], v[76:79], a[12:15]
    buffer_load_dwordx4 v20, s[72:75], s36 offen offset:0 lds
    v_mfma_f32_16x16x32_bf16 a[12:15], a[184:187], v[92:95], a[12:15]
    s_waitcnt lgkmcnt(4)
    v_mfma_f32_16x16x32_bf16 a[16:19], a[164:167], v[64:67], a[16:19]
    s_add_u32 s43, s43, 8192
    ds_read_b64_tr_b16 a[180:181], v15 offset:40960
    v_mfma_f32_16x16x32_bf16 a[16:19], a[168:171], v[80:83], a[16:19]
    s_and_b32 s43, s43, 0x7fffffff
    ds_read_b64_tr_b16 a[182:183], v15 offset:41984
    v_mfma_f32_16x16x32_bf16 a[20:23], a[164:167], v[68:71], a[20:23]
    v_mfma_f32_16x16x32_bf16 a[20:23], a[168:171], v[84:87], a[20:23]
    buffer_load_dwordx4 v21, s[72:75], s36 offen offset:1024 lds
    v_mfma_f32_16x16x32_bf16 a[24:27], a[164:167], v[72:75], a[24:27]
    s_lshr_b32 s7, s7, 2
    ds_read_b64_tr_b16 a[184:185], v15 offset:57344
    v_mfma_f32_16x16x32_bf16 a[24:27], a[168:171], v[88:91], a[24:27]
    s_add_u32 s7, s7, 0x10000
    ds_read_b64_tr_b16 a[186:187], v15 offset:58368
    v_mfma_f32_16x16x32_bf16 a[28:31], a[164:167], v[76:79], a[28:31]
    buffer_store_dword v121, v120, s[28:31], s7 offen sc1
    v_mfma_f32_16x16x32_bf16 a[28:31], a[168:171], v[92:95], a[28:31]
    s_waitcnt lgkmcnt(4)
    v_mfma_f32_16x16x32_bf16 a[32:35], a[172:175], v[64:67], a[32:35]
    s_xor_b32 s36, s40, 0x18000
    ds_read_b64_tr_b16 a[164:165], v2 offset:40960
    v_mfma_f32_16x16x32_bf16 a[32:35], a[176:179], v[80:83], a[32:35]
    s_xor_b32 m0, s68, 0x29800
    ds_read_b64_tr_b16 a[166:167], v2 offset:41984
    v_mfma_f32_16x16x32_bf16 a[36:39], a[172:175], v[68:71], a[36:39]
    buffer_load_dwordx4 v20, s[72:75], s36 offen offset:0 lds
    v_mfma_f32_16x16x32_bf16 a[36:39], a[176:179], v[84:87], a[36:39]
    v_mfma_f32_16x16x32_bf16 a[40:43], a[172:175], v[72:75], a[40:43]
    ds_read_b64_tr_b16 a[168:169], v2 offset:57344
    v_mfma_f32_16x16x32_bf16 a[40:43], a[176:179], v[88:91], a[40:43]
    ds_read_b64_tr_b16 a[170:171], v2 offset:58368
    v_mfma_f32_16x16x32_bf16 a[44:47], a[172:175], v[76:79], a[44:47]
    buffer_load_dwordx4 v21, s[72:75], s36 offen offset:1024 lds
    v_mfma_f32_16x16x32_bf16 a[44:47], a[176:179], v[92:95], a[44:47]
    s_waitcnt lgkmcnt(4)
    v_mfma_f32_16x16x32_bf16 a[48:51], a[180:183], v[64:67], a[48:51]
    s_waitcnt vmcnt(25)
    ds_read_b64_tr_b16 a[172:173], v3 offset:40960
    v_mfma_f32_16x16x32_bf16 a[48:51], a[184:187], v[80:83], a[48:51]
    ds_read_b64_tr_b16 a[174:175], v3 offset:41984
    v_mfma_f32_16x16x32_bf16 a[52:55], a[180:183], v[68:71], a[52:55]
    ds_read_b128 v[32:35], v24 offset:0
    v_mfma_f32_16x16x32_bf16 a[52:55], a[184:187], v[84:87], a[52:55]
    ds_read_b128 v[48:51], v25 offset:0
    v_mfma_f32_16x16x32_bf16 a[56:59], a[180:183], v[72:75], a[56:59]
    ds_read_b64_tr_b16 a[176:177], v3 offset:57344
    v_mfma_f32_16x16x32_bf16 a[56:59], a[184:187], v[88:91], a[56:59]
    ds_read_b64_tr_b16 a[178:179], v3 offset:58368
    v_mfma_f32_16x16x32_bf16 a[60:63], a[180:183], v[76:79], a[60:63]
    ds_read_b128 v[36:39], v24 offset:2048
    v_mfma_f32_16x16x32_bf16 a[60:63], a[184:187], v[92:95], a[60:63]
    s_waitcnt lgkmcnt(7)
    ds_read_b128 v[52:55], v25 offset:2048
    v_mfma_f32_16x16x32_bf16 a[64:67], a[164:167], v[64:67], a[64:67]
    ds_read_b64_tr_b16 a[180:181], v4 offset:40960
    v_mfma_f32_16x16x32_bf16 a[64:67], a[168:171], v[80:83], a[64:67]
    ds_read_b64_tr_b16 a[182:183], v4 offset:41984
    v_mfma_f32_16x16x32_bf16 a[68:71], a[164:167], v[68:71], a[68:71]
    ds_read_b64_tr_b16 a[184:185], v4 offset:57344
    v_mfma_f32_16x16x32_bf16 a[68:71], a[168:171], v[84:87], a[68:71]
    ds_read_b64_tr_b16 a[186:187], v4 offset:58368
    v_mfma_f32_16x16x32_bf16 a[72:75], a[164:167], v[72:75], a[72:75]
    ds_read_b128 v[40:43], v24 offset:4096
    v_mfma_f32_16x16x32_bf16 a[72:75], a[168:171], v[88:91], a[72:75]
    ds_read_b128 v[56:59], v25 offset:4096
    v_mfma_f32_16x16x32_bf16 a[76:79], a[164:167], v[76:79], a[76:79]
    ds_read_b128 v[44:47], v24 offset:6144
    v_mfma_f32_16x16x32_bf16 a[76:79], a[168:171], v[92:95], a[76:79]
    s_waitcnt lgkmcnt(9)
    v_mfma_f32_16x16x32_bf16 a[80:83], a[172:175], v[64:67], a[80:83]
    ds_read_b128 v[60:63], v25 offset:6144
    v_mfma_f32_16x16x32_bf16 a[80:83], a[176:179], v[80:83], a[80:83]
    s_waitcnt vmcnt(17)
    s_waitcnt lgkmcnt(0)
    s_barrier
    v_mfma_f32_16x16x32_bf16 a[84:87], a[172:175], v[68:71], a[84:87]
    ds_read_b64_tr_b16 a[164:165], v8 offset:0
    ds_read_b64_tr_b16 a[224:225], v28 offset:0
    v_mfma_f32_16x16x32_bf16 a[84:87], a[176:179], v[84:87], a[84:87]
    ds_read_b64_tr_b16 a[166:167], v8 offset:1024
    ds_read_b64_tr_b16 a[226:227], v28 offset:1024
    v_mfma_f32_16x16x32_bf16 a[88:91], a[172:175], v[72:75], a[88:91]
    ds_read_b64_tr_b16 a[168:169], v8 offset:16384
    ds_read_b64_tr_b16 a[228:229], v28 offset:8
    v_mfma_f32_16x16x32_bf16 a[88:91], a[176:179], v[88:91], a[88:91]
    s_add_u32 m0, s41, 32768
    ds_read_b64_tr_b16 a[170:171], v8 offset:17408
    ds_read_b64_tr_b16 a[230:231], v28 offset:1032
    v_mfma_f32_16x16x32_bf16 a[92:95], a[172:175], v[76:79], a[92:95]
    buffer_load_dwordx4 v16, s[12:15], s37 offen lds
    v_mfma_f32_16x16x32_bf16 a[92:95], a[176:179], v[92:95], a[92:95]
    ds_read_b64_tr_b16 a[232:233], v29 offset:8192
    ds_read_b64_tr_b16 a[234:235], v29 offset:9216
    v_mfma_f32_16x16x32_bf16 a[96:99], a[180:183], v[64:67], a[96:99]
    ds_read_b64_tr_b16 a[172:173], v8 offset:8
    v_mfma_f32_16x16x32_bf16 a[96:99], a[184:187], v[80:83], a[96:99]
    ds_read_b64_tr_b16 a[174:175], v8 offset:1032
    v_mfma_f32_16x16x32_bf16 a[100:103], a[180:183], v[68:71], a[100:103]
    s_add_u32 m0, s41, 33792
    ds_read_b64_tr_b16 a[236:237], v30 offset:8192
    v_mfma_f32_16x16x32_bf16 a[100:103], a[184:187], v[84:87], a[100:103]
    buffer_load_dwordx4 v17, s[12:15], s37 offen lds
    v_mfma_f32_16x16x32_bf16 a[104:107], a[180:183], v[72:75], a[104:107]
    ds_read_b64_tr_b16 a[176:177], v8 offset:16392
    v_mfma_f32_16x16x32_bf16 a[104:107], a[184:187], v[88:91], a[104:107]
    ds_read_b64_tr_b16 a[178:179], v8 offset:17416
    v_mfma_f32_16x16x32_bf16 a[108:111], a[180:183], v[76:79], a[108:111]
    s_cmp_lt_u32 s33, 16
    ds_read_b64_tr_b16 a[238:239], v30 offset:9216
    v_mfma_f32_16x16x32_bf16 a[108:111], a[184:187], v[92:95], a[108:111]
    s_waitcnt lgkmcnt(9)
    s_waitcnt lgkmcnt(0)
    v_mfma_f32_16x16x32_bf16 a[144:147], a[208:211], a[224:227], a[144:147]
    v_mfma_f32_16x16x32_bf16 a[144:147], a[212:215], a[228:231], a[144:147]
    v_mfma_f32_16x16x32_bf16 a[144:147], a[216:219], a[232:235], a[144:147]
    v_mfma_f32_16x16x32_bf16 a[144:147], a[220:223], a[236:239], a[144:147]
    s_cbranch_scc1 L_ph1
    s_bitcmp0_b32 s3, 0
    s_cselect_b64 s[84:85], s[24:25], s[20:21]
    s_cselect_b32 s4, 8, 8
    v_cmp_gt_u32 vcc, 32, v6
    v_lshlrev_b32 v126, 7, v6
    s_mov_b32 s86, 0x80000
    s_lshr_b32 s5, s3, 1
    s_lshl3_add_u32 s5, s5, s46
    s_add_u32 s4, s4, s5
    s_lshl_b32 s4, s4, 12
    v_cndmask_b32 v126, v127, v126, vcc
    s_mov_b32 s50, 0
    v_add_u32 v126, s4, v126
    s_lshl_b32 s5, s3, 1
    s_lshl_b32 s51, 0x8000000, s5
    s_and_b32 s51, s51, 0x7fffffff
    v_accvgpr_read_b32 v116, a144
    v_and_b32 v117, 0xffff0000, v116
    v_sub_f32 v116, v116, v117
    v_cvt_pk_bf16_f32 v116, v117, v116
    buffer_store_dword v116, v1, s[28:31], s10 offen sc1
    s_branch L_ph1
L_r1:
    v_mfma_f32_16x16x32_bf16 v[128:131], a[164:167], v[32:35], v[128:131]
    s_and_b32 s10, s10, 0xffffe000
    ds_read_b64_tr_b16 a[180:181], v9 offset:0
    v_mov_b32 v116, -1
    v_mfma_f32_16x16x32_bf16 v[128:131], a[168:171], v[48:51], v[128:131]
    s_add_u32 m0, s41, 40960
    ds_read_b64_tr_b16 a[182:183], v9 offset:1024
    v_mfma_f32_16x16x32_bf16 v[132:135], a[164:167], v[36:39], v[132:135]
    buffer_load_dwordx4 v18, s[16:19], s38 offen lds
    v_mfma_f32_16x16x32_bf16 v[132:135], a[168:171], v[52:55], v[132:135]
    v_mfma_f32_16x16x32_bf16 v[136:139], a[164:167], v[40:43], v[136:139]
    s_add_u32 s10, s10, s42
    ds_read_b64_tr_b16 a[184:185], v9 offset:16384
    v_mov_b32 v117, -1
    v_mfma_f32_16x16x32_bf16 v[136:139], a[168:171], v[56:59], v[136:139]
    s_add_u32 m0, s41, 41984
    ds_read_b64_tr_b16 a[186:187], v9 offset:17408
    v_mfma_f32_16x16x32_bf16 v[140:143], a[164:167], v[44:47], v[140:143]
    buffer_load_dwordx4 v19, s[16:19], s38 offen lds
    v_mfma_f32_16x16x32_bf16 v[140:143], a[168:171], v[60:63], v[140:143]
    s_waitcnt lgkmcnt(4)
    v_mfma_f32_16x16x32_bf16 v[144:147], a[172:175], v[32:35], v[144:147]
    s_lshl2_add_u32 s4, s46, s3
    ds_read_b64_tr_b16 a[164:165], v9 offset:8
    v_mov_b32 v118, -1
    v_mfma_f32_16x16x32_bf16 v[144:147], a[176:179], v[48:51], v[144:147]
    s_lshl_b32 s11, s4, 10
    ds_read_b64_tr_b16 a[166:167], v9 offset:1032
    v_mov_b32 v119, -1
    v_mfma_f32_16x16x32_bf16 v[148:151], a[172:175], v[36:39], v[148:151]
    s_add_u32 m0, s41, 49152
    v_mfma_f32_16x16x32_bf16 v[148:151], a[176:179], v[52:55], v[148:151]
    buffer_load_dwordx4 v16, s[12:15], s100 offen lds
    v_mfma_f32_16x16x32_bf16 v[152:155], a[172:175], v[40:43], v[152:155]
    s_lshr_b32 s9, s11, 2
    ds_read_b64_tr_b16 a[168:169], v9 offset:16392
    v_cmp_eq_u32 vcc, 0, v6
    v_mfma_f32_16x16x32_bf16 v[152:155], a[176:179], v[56:59], v[152:155]
    s_add_u32 s9, s9, 0xfc00
    ds_read_b64_tr_b16 a[170:171], v9 offset:17416
    v_mov_b32 v121, 0x40000000
    v_mfma_f32_16x16x32_bf16 v[156:159], a[172:175], v[44:47], v[156:159]
    buffer_load_dword v7, v127, s[80:83], 0 offen sc1
    v_mfma_f32_16x16x32_bf16 v[156:159], a[176:179], v[60:63], v[156:159]
    s_waitcnt lgkmcnt(4)
    v_mfma_f32_16x16x32_bf16 v[160:163], a[180:183], v[32:35], v[160:163]
    ds_read_b64_tr_b16 a[172:173], v10 offset:0
    v_mov_b32 v120, 0
    v_mfma_f32_16x16x32_bf16 v[160:163], a[184:187], v[48:51], v[160:163]
    s_add_u32 m0, s41, 50176
    ds_read_b64_tr_b16 a[174:175], v10 offset:1024
    v_mfma_f32_16x16x32_bf16 v[164:167], a[180:183], v[36:39], v[164:167]
    buffer_load_dwordx4 v17, s[12:15], s100 offen lds
    v_mfma_f32_16x16x32_bf16 v[164:167], a[184:187], v[52:55], v[164:167]
    v_mfma_f32_16x16x32_bf16 v[168:171], a[180:183], v[40:43], v[168:171]
    ds_read_b64_tr_b16 a[176:177], v10 offset:16384
    v_cndmask_b32 v121, v121, 0, vcc
    v_mfma_f32_16x16x32_bf16 v[168:171], a[184:187], v[56:59], v[168:171]
    s_add_u32 m0, s41, 57344
    ds_read_b64_tr_b16 a[178:179], v10 offset:17408
    v_and_b32 v1, 0x1f0, v115
    v_mfma_f32_16x16x32_bf16 v[172:175], a[180:183], v[44:47], v[172:175]
    buffer_load_dwordx4 v18, s[16:19], s101 offen lds
    v_mfma_f32_16x16x32_bf16 v[172:175], a[184:187], v[60:63], v[172:175]
    s_waitcnt lgkmcnt(4)
    v_mfma_f32_16x16x32_bf16 v[176:179], a[164:167], v[32:35], v[176:179]
    ds_read_b64_tr_b16 a[180:181], v10 offset:8
    v_and_b32 v126, 0xf0, v115
    v_mfma_f32_16x16x32_bf16 v[176:179], a[168:171], v[48:51], v[176:179]
    ds_read_b64_tr_b16 a[182:183], v10 offset:1032
    v_lshrrev_b32 v23, 2, v115
    v_mfma_f32_16x16x32_bf16 v[180:183], a[164:167], v[36:39], v[180:183]
    s_add_u32 m0, s41, 58368
    v_mfma_f32_16x16x32_bf16 v[180:183], a[168:171], v[52:55], v[180:183]
    buffer_load_dwordx4 v19, s[16:19], s101 offen lds
    v_mfma_f32_16x16x32_bf16 v[184:187], a[164:167], v[40:43], v[184:187]
    ds_read_b64_tr_b16 a[184:185], v10 offset:16392
    v_mul_u32_u24 v5, v5, v5
    v_mfma_f32_16x16x32_bf16 v[184:187], a[168:171], v[56:59], v[184:187]
    ds_read_b64_tr_b16 a[186:187], v10 offset:17416
    v_mfma_f32_16x16x32_bf16 v[188:191], a[164:167], v[44:47], v[188:191]
    buffer_store_short v120, v121, s[28:31], s71 offen sc1
    v_mfma_f32_16x16x32_bf16 v[188:191], a[168:171], v[60:63], v[188:191]
    s_waitcnt lgkmcnt(4)
    v_mfma_f32_16x16x32_bf16 v[192:195], a[172:175], v[32:35], v[192:195]
    ds_read_b64_tr_b16 a[164:165], v11 offset:0
    v_mfma_f32_16x16x32_bf16 v[192:195], a[176:179], v[48:51], v[192:195]
    ds_read_b64_tr_b16 a[166:167], v11 offset:1024
    v_mfma_f32_16x16x32_bf16 v[196:199], a[172:175], v[36:39], v[196:199]
    buffer_store_dwordx4 v[116:119], v115, s[28:31], s69 offen offset:0 sc1
    v_mfma_f32_16x16x32_bf16 v[196:199], a[176:179], v[52:55], v[196:199]
    v_mfma_f32_16x16x32_bf16 v[200:203], a[172:175], v[40:43], v[200:203]
    ds_read_b64_tr_b16 a[168:169], v11 offset:16384
    v_mfma_f32_16x16x32_bf16 v[200:203], a[176:179], v[56:59], v[200:203]
    ds_read_b64_tr_b16 a[170:171], v11 offset:17408
    v_mfma_f32_16x16x32_bf16 v[204:207], a[172:175], v[44:47], v[204:207]
    buffer_store_dwordx4 v[116:119], v115, s[28:31], s69 offen offset:1024 sc1
    v_mfma_f32_16x16x32_bf16 v[204:207], a[176:179], v[60:63], v[204:207]
    s_waitcnt lgkmcnt(4)
    v_mfma_f32_16x16x32_bf16 v[208:211], a[180:183], v[32:35], v[208:211]
    ds_read_b64_tr_b16 a[172:173], v11 offset:8
    v_mfma_f32_16x16x32_bf16 v[208:211], a[184:187], v[48:51], v[208:211]
    ds_read_b64_tr_b16 a[174:175], v11 offset:1032
    v_mfma_f32_16x16x32_bf16 v[212:215], a[180:183], v[36:39], v[212:215]
    buffer_store_dwordx4 v[116:119], v115, s[28:31], s69 offen offset:2048 sc1
    v_mfma_f32_16x16x32_bf16 v[212:215], a[184:187], v[52:55], v[212:215]
    v_mfma_f32_16x16x32_bf16 v[216:219], a[180:183], v[40:43], v[216:219]
    ds_read_b64_tr_b16 a[176:177], v11 offset:16392
    v_mfma_f32_16x16x32_bf16 v[216:219], a[184:187], v[56:59], v[216:219]
    ds_read_b64_tr_b16 a[178:179], v11 offset:17416
    v_mfma_f32_16x16x32_bf16 v[220:223], a[180:183], v[44:47], v[220:223]
    buffer_store_dwordx4 v[116:119], v115, s[28:31], s69 offen offset:3072 sc1
    v_mfma_f32_16x16x32_bf16 v[220:223], a[184:187], v[60:63], v[220:223]
    s_waitcnt lgkmcnt(4)
    v_mfma_f32_16x16x32_bf16 v[224:227], a[164:167], v[32:35], v[224:227]
    ds_read_b64_tr_b16 a[180:181], v12 offset:8192
    v_mfma_f32_16x16x32_bf16 v[224:227], a[168:171], v[48:51], v[224:227]
    ds_read_b64_tr_b16 a[182:183], v12 offset:9216
    v_mfma_f32_16x16x32_bf16 v[228:231], a[164:167], v[36:39], v[228:231]
    v_mfma_f32_16x16x32_bf16 v[228:231], a[168:171], v[52:55], v[228:231]
    v_mfma_f32_16x16x32_bf16 v[232:235], a[164:167], v[40:43], v[232:235]
    ds_read_b64_tr_b16 a[184:185], v12 offset:24576
    v_mfma_f32_16x16x32_bf16 v[232:235], a[168:171], v[56:59], v[232:235]
    ds_read_b64_tr_b16 a[186:187], v12 offset:25600
    v_mfma_f32_16x16x32_bf16 v[236:239], a[164:167], v[44:47], v[236:239]
    v_mfma_f32_16x16x32_bf16 v[236:239], a[168:171], v[60:63], v[236:239]
    s_waitcnt lgkmcnt(4)
    v_mfma_f32_16x16x32_bf16 v[240:243], a[172:175], v[32:35], v[240:243]
    ds_read_b64_tr_b16 a[164:165], v13 offset:8192
    v_mfma_f32_16x16x32_bf16 v[240:243], a[176:179], v[48:51], v[240:243]
    ds_read_b64_tr_b16 a[166:167], v13 offset:9216
    v_mfma_f32_16x16x32_bf16 v[244:247], a[172:175], v[36:39], v[244:247]
    s_waitcnt vmcnt(8)
    v_cmp_ne_u32 vcc, v7, v5
    v_mfma_f32_16x16x32_bf16 v[244:247], a[176:179], v[52:55], v[244:247]
    s_cbranch_vccnz L_st_wait
L_st_ok:
    v_mfma_f32_16x16x32_bf16 v[248:251], a[172:175], v[40:43], v[248:251]
    ds_read_b64_tr_b16 a[168:169], v13 offset:24576
    v_mfma_f32_16x16x32_bf16 v[248:251], a[176:179], v[56:59], v[248:251]
    s_add_u32 m0, s42, 0xe000
    ds_read_b64_tr_b16 a[170:171], v13 offset:25600
    v_mfma_f32_16x16x32_bf16 v[252:255], a[172:175], v[44:47], v[252:255]
    buffer_load_dwordx4 v115, s[28:31], s10 offen offset:0 sc1 lds
    v_mfma_f32_16x16x32_bf16 v[252:255], a[176:179], v[60:63], v[252:255]
    s_waitcnt lgkmcnt(4)
    v_mfma_f32_16x16x32_bf16 a[0:3], a[180:183], v[32:35], a[0:3]
    ds_read_b64_tr_b16 a[172:173], v14 offset:8192
    v_mfma_f32_16x16x32_bf16 a[0:3], a[184:187], v[48:51], a[0:3]
    ds_read_b64_tr_b16 a[174:175], v14 offset:9216
    v_mfma_f32_16x16x32_bf16 a[4:7], a[180:183], v[36:39], a[4:7]
    buffer_load_dwordx4 v115, s[28:31], s10 offen offset:1024 sc1 lds
    v_mfma_f32_16x16x32_bf16 a[4:7], a[184:187], v[52:55], a[4:7]
    v_mfma_f32_16x16x32_bf16 a[8:11], a[180:183], v[40:43], a[8:11]
    ds_read_b64_tr_b16 a[176:177], v14 offset:24576
    v_mfma_f32_16x16x32_bf16 a[8:11], a[184:187], v[56:59], a[8:11]
    s_add_u32 m0, s42, 0xc000
    ds_read_b64_tr_b16 a[178:179], v14 offset:25600
    v_mfma_f32_16x16x32_bf16 a[12:15], a[180:183], v[44:47], a[12:15]
    buffer_load_dwordx4 v115, s[28:31], s11 offen sc1 lds
    v_mfma_f32_16x16x32_bf16 a[12:15], a[184:187], v[60:63], a[12:15]
    s_waitcnt lgkmcnt(4)
    v_mfma_f32_16x16x32_bf16 a[16:19], a[164:167], v[32:35], a[16:19]
    ds_read_b64_tr_b16 a[180:181], v15 offset:8192
    v_mfma_f32_16x16x32_bf16 a[16:19], a[168:171], v[48:51], a[16:19]
    ds_read_b64_tr_b16 a[182:183], v15 offset:9216
    v_mfma_f32_16x16x32_bf16 a[20:23], a[164:167], v[36:39], a[20:23]
    buffer_load_dword v23, s[28:31], s9 offen offset:1024 sc1 lds
    v_mfma_f32_16x16x32_bf16 a[20:23], a[168:171], v[52:55], a[20:23]
    v_mfma_f32_16x16x32_bf16 a[24:27], a[164:167], v[40:43], a[24:27]
    s_getpc_b64 s[0:1]
L_pc2:
    ds_read_b64_tr_b16 a[184:185], v15 offset:24576
    v_mfma_f32_16x16x32_bf16 a[24:27], a[168:171], v[56:59], a[24:27]
    s_lshr_b32 s4, s2, 1
    ds_read_b64_tr_b16 a[186:187], v15 offset:25600
    v_mfma_f32_16x16x32_bf16 a[28:31], a[164:167], v[44:47], a[28:31]
    s_and_b32 s4, s4, 28
    v_mfma_f32_16x16x32_bf16 a[28:31], a[168:171], v[60:63], a[28:31]
    s_waitcnt lgkmcnt(4)
    v_mfma_f32_16x16x32_bf16 a[32:35], a[172:175], v[32:35], a[32:35]
    s_add_u32 s4, s4, s3
    ds_read_b64_tr_b16 a[164:165], v2 offset:8192
    v_mfma_f32_16x16x32_bf16 a[32:35], a[176:179], v[48:51], a[32:35]
    s_min_u32 s4, s4, (L_rare_0-L_r2)/1024
    ds_read_b64_tr_b16 a[166:167], v2 offset:9216
    v_mfma_f32_16x16x32_bf16 a[36:39], a[172:175], v[36:39], a[36:39]
    v_mfma_f32_16x16x32_bf16 a[36:39], a[176:179], v[52:55], a[36:39]
    s_lshl_b32 s4, s4, 10
    v_mfma_f32_16x16x32_bf16 a[40:43], a[172:175], v[40:43], a[40:43]
    s_add_u32 s4, s4, L_r2-L_pc2
    ds_read_b64_tr_b16 a[168:169], v2 offset:24576
    v_mfma_f32_16x16x32_bf16 a[40:43], a[176:179], v[56:59], a[40:43]
    ds_read_b64_tr_b16 a[170:171], v2 offset:25600
    v_mfma_f32_16x16x32_bf16 a[44:47], a[172:175], v[44:47], a[44:47]
    s_add_u32 s0, s0, s4
    s_addc_u32 s1, s1, 0
    v_mfma_f32_16x16x32_bf16 a[44:47], a[176:179], v[60:63], a[44:47]
    s_waitcnt lgkmcnt(4)
    v_mfma_f32_16x16x32_bf16 a[48:51], a[180:183], v[32:35], a[48:51]
    s_waitcnt vmcnt(18)
    ds_read_b64_tr_b16 a[172:173], v3 offset:8192
    v_mfma_f32_16x16x32_bf16 a[48:51], a[184:187], v[48:51], a[48:51]
    ds_read_b64_tr_b16 a[174:175], v3 offset:9216
    v_mfma_f32_16x16x32_bf16 a[52:55], a[180:183], v[36:39], a[52:55]
    ds_read_b128 v[64:67], v26 offset:0
    v_mfma_f32_16x16x32_bf16 a[52:55], a[184:187], v[52:55], a[52:55]
    ds_read_b128 v[80:83], v27 offset:0
    v_mfma_f32_16x16x32_bf16 a[56:59], a[180:183], v[40:43], a[56:59]
    ds_read_b64_tr_b16 a[176:177], v3 offset:24576
    v_mfma_f32_16x16x32_bf16 a[56:59], a[184:187], v[56:59], a[56:59]
    ds_read_b64_tr_b16 a[178:179], v3 offset:25600
    v_mfma_f32_16x16x32_bf16 a[60:63], a[180:183], v[44:47], a[60:63]
    ds_read_b128 v[68:71], v26 offset:2048
    v_mfma_f32_16x16x32_bf16 a[60:63], a[184:187], v[60:63], a[60:63]
    s_waitcnt lgkmcnt(7)
    ds_read_b128 v[84:87], v27 offset:2048
    v_mfma_f32_16x16x32_bf16 a[64:67], a[164:167], v[32:35], a[64:67]
    ds_read_b64_tr_b16 a[180:181], v4 offset:8192
    v_mfma_f32_16x16x32_bf16 a[64:67], a[168:171], v[48:51], a[64:67]
    ds_read_b64_tr_b16 a[182:183], v4 offset:9216
    v_mfma_f32_16x16x32_bf16 a[68:71], a[164:167], v[36:39], a[68:71]
    ds_read_b64_tr_b16 a[184:185], v4 offset:24576
    v_mfma_f32_16x16x32_bf16 a[68:71], a[168:171], v[52:55], a[68:71]
    ds_read_b64_tr_b16 a[186:187], v4 offset:25600
    v_mfma_f32_16x16x32_bf16 a[72:75], a[164:167], v[40:43], a[72:75]
    ds_read_b128 v[72:75], v26 offset:4096
    v_mfma_f32_16x16x32_bf16 a[72:75], a[168:171], v[56:59], a[72:75]
    ds_read_b128 v[88:91], v27 offset:4096
    v_mfma_f32_16x16x32_bf16 a[76:79], a[164:167], v[44:47], a[76:79]
    ds_read_b128 v[76:79], v26 offset:6144
    v_mfma_f32_16x16x32_bf16 a[76:79], a[168:171], v[60:63], a[76:79]
    s_waitcnt lgkmcnt(9)
    v_mfma_f32_16x16x32_bf16 a[80:83], a[172:175], v[32:35], a[80:83]
    ds_read_b128 v[92:95], v27 offset:6144
    v_mfma_f32_16x16x32_bf16 a[80:83], a[176:179], v[48:51], a[80:83]
    s_waitcnt vmcnt(9)
    s_waitcnt lgkmcnt(0)
    s_barrier
    v_mfma_f32_16x16x32_bf16 a[84:87], a[172:175], v[36:39], a[84:87]
    ds_read_b64_tr_b16 a[164:165], v8 offset:32768
    v_mfma_f32_16x16x32_bf16 a[84:87], a[176:179], v[52:55], a[84:87]
    ds_read_b64_tr_b16 a[166:167], v8 offset:33792
    v_lshrrev_b32 v124, 2, v126
    v_mfma_f32_16x16x32_bf16 a[88:91], a[172:175], v[40:43], a[88:91]
    s_mov_b32 s50, 0
    ds_read_b64_tr_b16 a[168:169], v8 offset:49152
    v_add_u32 v126, s42, v126
    v_mfma_f32_16x16x32_bf16 a[88:91], a[176:179], v[56:59], a[88:91]
    s_add_u32 m0, s42, 65536
    ds_read_b64_tr_b16 a[170:171], v8 offset:50176
    v_add_u32 v124, s42, v124
    v_mfma_f32_16x16x32_bf16 a[92:95], a[172:175], v[44:47], a[92:95]
    buffer_load_dwordx4 v114, s[24:27], s50 offen offset:0 lds
    v_mfma_f32_16x16x32_bf16 a[92:95], a[176:179], v[60:63], a[92:95]
    v_mfma_f32_16x16x32_bf16 a[96:99], a[180:183], v[32:35], a[96:99]
    ds_read_b64_tr_b16 a[172:173], v8 offset:32776
    v_mfma_f32_16x16x32_bf16 a[96:99], a[184:187], v[48:51], a[96:99]
    ds_read_b64_tr_b16 a[174:175], v8 offset:33800
    v_mfma_f32_16x16x32_bf16 a[100:103], a[180:183], v[36:39], a[100:103]
    buffer_load_dwordx4 v125, s[24:27], s50 offen offset:1024 lds
    v_mfma_f32_16x16x32_bf16 a[100:103], a[184:187], v[52:55], a[100:103]
    s_mov_b32 s50, 8192
    v_mfma_f32_16x16x32_bf16 a[104:107], a[180:183], v[40:43], a[104:107]
    ds_read_b64_tr_b16 a[176:177], v8 offset:49160
    v_mfma_f32_16x16x32_bf16 a[104:107], a[184:187], v[56:59], a[104:107]
    s_add_u32 m0, s42, 73728
    ds_read_b64_tr_b16 a[178:179], v8 offset:50184
    v_mfma_f32_16x16x32_bf16 a[108:111], a[180:183], v[44:47], a[108:111]
    buffer_load_dwordx4 v114, s[24:27], s50 offen offset:0 lds
    v_mfma_f32_16x16x32_bf16 a[108:111], a[184:187], v[60:63], a[108:111]
    s_waitcnt lgkmcnt(4)
    v_mfma_f32_16x16x32_bf16 v[128:131], a[164:167], v[64:67], v[128:131]
    ds_read_b64_tr_b16 a[180:181], v9 offset:32768
    v_mfma_f32_16x16x32_bf16 v[128:131], a[168:171], v[80:83], v[128:131]
    ds_read_b64_tr_b16 a[182:183], v9 offset:33792
    v_mfma_f32_16x16x32_bf16 v[132:135], a[164:167], v[68:71], v[132:135]
    buffer_load_dwordx4 v125, s[24:27], s50 offen offset:1024 lds
    v_mfma_f32_16x16x32_bf16 v[132:135], a[168:171], v[84:87], v[132:135]
    v_mfma_f32_16x16x32_bf16 v[136:139], a[164:167], v[72:75], v[136:139]
    ds_read_b64_tr_b16 a[184:185], v9 offset:49152
    v_mfma_f32_16x16x32_bf16 v[136:139], a[168:171], v[88:91], v[136:139]
    ds_read_b64_tr_b16 a[186:187], v9 offset:50176
    v_mfma_f32_16x16x32_bf16 v[140:143], a[164:167], v[76:79], v[140:143]
    v_mfma_f32_16x16x32_bf16 v[140:143], a[168:171], v[92:95], v[140:143]
    s_waitcnt lgkmcnt(4)
    v_mfma_f32_16x16x32_bf16 v[144:147], a[172:175], v[64:67], v[144:147]
    s_mov_b32 s50, 16384
    ds_read_b64_tr_b16 a[164:165], v9 offset:32776
    v_mfma_f32_16x16x32_bf16 v[144:147], a[176:179], v[80:83], v[144:147]
    s_add_u32 m0, s42, 81920
    ds_read_b64_tr_b16 a[166:167], v9 offset:33800
    v_mfma_f32_16x16x32_bf16 v[148:151], a[172:175], v[68:71], v[148:151]
    buffer_load_dwordx4 v114, s[24:27], s50 offen offset:0 lds
    v_mfma_f32_16x16x32_bf16 v[148:151], a[176:179], v[84:87], v[148:151]
    v_mfma_f32_16x16x32_bf16 v[152:155], a[172:175], v[72:75], v[152:155]
    ds_read_b64_tr_b16 a[168:169], v9 offset:49160
    v_mfma_f32_16x16x32_bf16 v[152:155], a[176:179], v[88:91], v[152:155]
    ds_read_b64_tr_b16 a[170:171], v9 offset:50184
    v_mfma_f32_16x16x32_bf16 v[156:159], a[172:175], v[76:79], v[156:159]
    buffer_load_dwordx4 v125, s[24:27], s50 offen offset:1024 lds
    v_mfma_f32_16x16x32_bf16 v[156:159], a[176:179], v[92:95], v[156:159]
    s_waitcnt lgkmcnt(4)
    v_mfma_f32_16x16x32_bf16 v[160:163], a[180:183], v[64:67], v[160:163]
    ds_read_b64_tr_b16 a[172:173], v10 offset:32768
    v_mfma_f32_16x16x32_bf16 v[160:163], a[184:187], v[80:83], v[160:163]
    ds_read_b64_tr_b16 a[174:175], v10 offset:33792
    v_mfma_f32_16x16x32_bf16 v[164:167], a[180:183], v[68:71], v[164:167]
    v_mfma_f32_16x16x32_bf16 v[164:167], a[184:187], v[84:87], v[164:167]
    v_mfma_f32_16x16x32_bf16 v[168:171], a[180:183], v[72:75], v[168:171]
    s_mov_b32 s50, 24576
    ds_read_b64_tr_b16 a[176:177], v10 offset:49152
    v_mfma_f32_16x16x32_bf16 v[168:171], a[184:187], v[88:91], v[168:171]
    s_add_u32 m0, s42, 90112
    ds_read_b64_tr_b16 a[178:179], v10 offset:50176
    v_mfma_f32_16x16x32_bf16 v[172:175], a[180:183], v[76:79], v[172:175]
    buffer_load_dwordx4 v114, s[24:27], s50 offen offset:0 lds
    v_mfma_f32_16x16x32_bf16 v[172:175], a[184:187], v[92:95], v[172:175]
    s_waitcnt lgkmcnt(4)
    v_mfma_f32_16x16x32_bf16 v[176:179], a[164:167], v[64:67], v[176:179]
    ds_read_b64_tr_b16 a[180:181], v10 offset:32776
    v_mfma_f32_16x16x32_bf16 v[176:179], a[168:171], v[80:83], v[176:179]
    ds_read_b64_tr_b16 a[182:183], v10 offset:33800
    v_mfma_f32_16x16x32_bf16 v[180:183], a[164:167], v[68:71], v[180:183]
    buffer_load_dwordx4 v125, s[24:27], s50 offen offset:1024 lds
    v_mfma_f32_16x16x32_bf16 v[180:183], a[168:171], v[84:87], v[180:183]
    v_mfma_f32_16x16x32_bf16 v[184:187], a[164:167], v[72:75], v[184:187]
    ds_read_b64_tr_b16 a[184:185], v10 offset:49160
    v_mfma_f32_16x16x32_bf16 v[184:187], a[168:171], v[88:91], v[184:187]
    ds_read_b64_tr_b16 a[186:187], v10 offset:50184
    v_mfma_f32_16x16x32_bf16 v[188:191], a[164:167], v[76:79], v[188:191]
    v_mfma_f32_16x16x32_bf16 v[188:191], a[168:171], v[92:95], v[188:191]
    s_waitcnt lgkmcnt(4)
    v_mfma_f32_16x16x32_bf16 v[192:195], a[172:175], v[64:67], v[192:195]
    ds_read_b64_tr_b16 a[164:165], v11 offset:32768
    v_mfma_f32_16x16x32_bf16 v[192:195], a[176:179], v[80:83], v[192:195]
    ds_read_b64_tr_b16 a[166:167], v11 offset:33792
    v_mfma_f32_16x16x32_bf16 v[196:199], a[172:175], v[68:71], v[196:199]
    v_mfma_f32_16x16x32_bf16 v[196:199], a[176:179], v[84:87], v[196:199]
    v_mfma_f32_16x16x32_bf16 v[200:203], a[172:175], v[72:75], v[200:203]
    ds_read_b64_tr_b16 a[168:169], v11 offset:49152
    v_mfma_f32_16x16x32_bf16 v[200:203], a[176:179], v[88:91], v[200:203]
    ds_read_b64_tr_b16 a[170:171], v11 offset:50176
    v_mfma_f32_16x16x32_bf16 v[204:207], a[172:175], v[76:79], v[204:207]
    v_mfma_f32_16x16x32_bf16 v[204:207], a[176:179], v[92:95], v[204:207]
    s_waitcnt lgkmcnt(4)
    v_mfma_f32_16x16x32_bf16 v[208:211], a[180:183], v[64:67], v[208:211]
    ds_read_b64_tr_b16 a[172:173], v11 offset:32776
    v_mfma_f32_16x16x32_bf16 v[208:211], a[184:187], v[80:83], v[208:211]
    ds_read_b64_tr_b16 a[174:175], v11 offset:33800
    v_mfma_f32_16x16x32_bf16 v[212:215], a[180:183], v[68:71], v[212:215]
    s_waitcnt vmcnt(8)
    s_barrier
    v_mfma_f32_16x16x32_bf16 v[212:215], a[184:187], v[84:87], v[212:215]
    ds_read_b128 v[16:19], v126 offset:49152
    v_mfma_f32_16x16x32_bf16 v[216:219], a[180:183], v[72:75], v[216:219]
    ds_read_b64_tr_b16 a[176:177], v11 offset:49160
    v_mfma_f32_16x16x32_bf16 v[216:219], a[184:187], v[88:91], v[216:219]
    ds_read_b64_tr_b16 a[178:179], v11 offset:50184
    v_mfma_f32_16x16x32_bf16 v[220:223], a[180:183], v[76:79], v[220:223]
    ds_read_b128 v[20:23], v126 offset:49408
    v_mfma_f32_16x16x32_bf16 v[220:223], a[184:187], v[92:95], v[220:223]
    s_waitcnt lgkmcnt(6)
    ds_read_b128 v[24:27], v126 offset:49664
    v_mfma_f32_16x16x32_bf16 v[224:227], a[164:167], v[64:67], v[224:227]
    ds_read_b64_tr_b16 a[180:181], v12 offset:40960
    v_mfma_f32_16x16x32_bf16 v[224:227], a[168:171], v[80:83], v[224:227]
    ds_read_b64_tr_b16 a[182:183], v12 offset:41984
    v_mfma_f32_16x16x32_bf16 v[228:231], a[164:167], v[68:71], v[228:231]
    ds_read_b128 v[28:31], v126 offset:49920
    v_mfma_f32_16x16x32_bf16 v[228:231], a[168:171], v[84:87], v[228:231]
    ds_read_b32 v116, v124 offset:50176
    v_mfma_f32_16x16x32_bf16 v[232:235], a[164:167], v[72:75], v[232:235]
    ds_read_b64_tr_b16 a[184:185], v12 offset:57344
    v_mfma_f32_16x16x32_bf16 v[232:235], a[168:171], v[88:91], v[232:235]
    ds_read_b64_tr_b16 a[186:187], v12 offset:58368
    v_mfma_f32_16x16x32_bf16 v[236:239], a[164:167], v[76:79], v[236:239]
    ds_read_b32 v117, v124 offset:50240
    v_mfma_f32_16x16x32_bf16 v[236:239], a[168:171], v[92:95], v[236:239]
    s_waitcnt lgkmcnt(9)
    ds_read_b32 v118, v124 offset:50304
    v_mfma_f32_16x16x32_bf16 v[240:243], a[172:175], v[64:67], v[240:243]
    ds_read_b64_tr_b16 a[164:165], v13 offset:40960
    v_mfma_f32_16x16x32_bf16 v[240:243], a[176:179], v[80:83], v[240:243]
    ds_read_b64_tr_b16 a[166:167], v13 offset:41984
    v_mfma_f32_16x16x32_bf16 v[244:247], a[172:175], v[68:71], v[244:247]
    ds_read_b32 v119, v124 offset:50368
    v_mfma_f32_16x16x32_bf16 v[244:247], a[176:179], v[84:87], v[244:247]
    ds_read_b128 a[224:227], v1 offset:57344
    v_mfma_f32_16x16x32_bf16 v[248:251], a[172:175], v[72:75], v[248:251]
    ds_read_b64_tr_b16 a[168:169], v13 offset:57344
    v_mfma_f32_16x16x32_bf16 v[248:251], a[176:179], v[88:91], v[248:251]
    ds_read_b64_tr_b16 a[170:171], v13 offset:58368
    v_mfma_f32_16x16x32_bf16 v[252:255], a[172:175], v[76:79], v[252:255]
    ds_read_b128 a[228:231], v1 offset:57856
    v_mfma_f32_16x16x32_bf16 v[252:255], a[176:179], v[92:95], v[252:255]
    s_waitcnt lgkmcnt(9)
    ds_read_b128 a[232:235], v1 offset:58368
    v_mfma_f32_16x16x32_bf16 a[0:3], a[180:183], v[64:67], a[0:3]
    ds_read_b64_tr_b16 a[172:173], v14 offset:40960
    v_mfma_f32_16x16x32_bf16 a[0:3], a[184:187], v[80:83], a[0:3]
    ds_read_b64_tr_b16 a[174:175], v14 offset:41984
    v_mfma_f32_16x16x32_bf16 a[4:7], a[180:183], v[68:71], a[4:7]
    ds_read_b128 a[236:239], v1 offset:58880
    v_mfma_f32_16x16x32_bf16 a[4:7], a[184:187], v[84:87], a[4:7]
    ds_read_b128 a[240:243], v1 offset:59392
    v_mfma_f32_16x16x32_bf16 a[8:11], a[180:183], v[72:75], a[8:11]
    ds_read_b64_tr_b16 a[176:177], v14 offset:57344
    v_mfma_f32_16x16x32_bf16 a[8:11], a[184:187], v[88:91], a[8:11]
    ds_read_b64_tr_b16 a[178:179], v14 offset:58368
    v_mfma_f32_16x16x32_bf16 a[12:15], a[180:183], v[76:79], a[12:15]
    ds_read_b128 a[244:247], v1 offset:59904
    v_mfma_f32_16x16x32_bf16 a[12:15], a[184:187], v[92:95], a[12:15]
    s_waitcnt lgkmcnt(9)
    ds_read_b128 a[248:251], v1 offset:60416
    v_mfma_f32_16x16x32_bf16 a[16:19], a[164:167], v[64:67], a[16:19]
    ds_read_b64_tr_b16 a[180:181], v15 offset:40960
    v_mfma_f32_16x16x32_bf16 a[16:19], a[168:171], v[80:83], a[16:19]
    ds_read_b64_tr_b16 a[182:183], v15 offset:41984
    v_mfma_f32_16x16x32_bf16 a[20:23], a[164:167], v[68:71], a[20:23]
    ds_read_b128 a[252:255], v1 offset:60928
    v_mfma_f32_16x16x32_bf16 a[20:23], a[168:171], v[84:87], a[20:23]
    ds_read_b128 a[112:115], v1 offset:61440
    v_mfma_f32_16x16x32_bf16 a[24:27], a[164:167], v[72:75], a[24:27]
    ds_read_b64_tr_b16 a[184:185], v15 offset:57344
    v_mfma_f32_16x16x32_bf16 a[24:27], a[168:171], v[88:91], a[24:27]
    ds_read_b64_tr_b16 a[186:187], v15 offset:58368
    v_mfma_f32_16x16x32_bf16 a[28:31], a[164:167], v[76:79], a[28:31]
    ds_read_b128 a[116:119], v1 offset:61952
    v_mfma_f32_16x16x32_bf16 a[28:31], a[168:171], v[92:95], a[28:31]
    s_waitcnt lgkmcnt(9)
    ds_read_b128 a[120:123], v1 offset:62464
    v_mfma_f32_16x16x32_bf16 a[32:35], a[172:175], v[64:67], a[32:35]
    ds_read_b64_tr_b16 a[164:165], v2 offset:40960
    v_mfma_f32_16x16x32_bf16 a[32:35], a[176:179], v[80:83], a[32:35]
    ds_read_b64_tr_b16 a[166:167], v2 offset:41984
    v_mfma_f32_16x16x32_bf16 a[36:39], a[172:175], v[68:71], a[36:39]
    ds_read_b128 a[124:127], v1 offset:62976
    v_mfma_f32_16x16x32_bf16 a[36:39], a[176:179], v[84:87], a[36:39]
    ds_read_b128 a[144:147], v1 offset:63488
    v_mfma_f32_16x16x32_bf16 a[40:43], a[172:175], v[72:75], a[40:43]
    ds_read_b64_tr_b16 a[168:169], v2 offset:57344
    v_mfma_f32_16x16x32_bf16 a[40:43], a[176:179], v[88:91], a[40:43]
    ds_read_b64_tr_b16 a[170:171], v2 offset:58368
    v_mfma_f32_16x16x32_bf16 a[44:47], a[172:175], v[76:79], a[44:47]
    ds_read_b128 a[148:151], v1 offset:64000
    v_mfma_f32_16x16x32_bf16 a[44:47], a[176:179], v[92:95], a[44:47]
    s_waitcnt lgkmcnt(9)
    ds_read_b128 a[152:155], v1 offset:64512
    v_mfma_f32_16x16x32_bf16 a[48:51], a[180:183], v[64:67], a[48:51]
    s_mov_b32 s84, s62
    ds_read_b64_tr_b16 a[172:173], v3 offset:40960
    v_mfma_f32_16x16x32_bf16 a[48:51], a[184:187], v[80:83], a[48:51]
    s_and_b32 s85, s63, 0xffff
    ds_read_b64_tr_b16 a[174:175], v3 offset:41984
    v_mfma_f32_16x16x32_bf16 a[52:55], a[180:183], v[68:71], a[52:55]
    v_mfma_f32_16x16x32_bf16 a[52:55], a[184:187], v[84:87], a[52:55]
    v_mfma_f32_16x16x32_bf16 a[56:59], a[180:183], v[72:75], a[56:59]
    s_mov_b32 s86, 0x800000
    ds_read_b64_tr_b16 a[176:177], v3 offset:57344
    v_mfma_f32_16x16x32_bf16 a[56:59], a[184:187], v[88:91], a[56:59]
    s_mov_b32 s87, 0x20000
    ds_read_b64_tr_b16 a[178:179], v3 offset:58368
    v_mfma_f32_16x16x32_bf16 a[60:63], a[180:183], v[76:79], a[60:63]
    v_mfma_f32_16x16x32_bf16 a[60:63], a[184:187], v[92:95], a[60:63]
    s_waitcnt lgkmcnt(6)
    v_mfma_f32_16x16x32_bf16 a[64:67], a[164:167], v[64:67], a[64:67]
    ds_read_b64_tr_b16 a[180:181], v4 offset:40960
    v_mfma_f32_16x16x32_bf16 a[64:67], a[168:171], v[80:83], a[64:67]
    ds_read_b64_tr_b16 a[182:183], v4 offset:41984
    v_mfma_f32_16x16x32_bf16 a[68:71], a[164:167], v[68:71], a[68:71]
    ds_read_b64_tr_b16 a[184:185], v4 offset:57344
    v_mfma_f32_16x16x32_bf16 a[68:71], a[168:171], v[84:87], a[68:71]
    ds_read_b64_tr_b16 a[186:187], v4 offset:58368
    v_mfma_f32_16x16x32_bf16 a[72:75], a[164:167], v[72:75], a[72:75]
    v_mfma_f32_16x16x32_bf16 a[72:75], a[168:171], v[88:91], a[72:75]
    v_mfma_f32_16x16x32_bf16 a[76:79], a[164:167], v[76:79], a[76:79]
    v_mfma_f32_16x16x32_bf16 a[76:79], a[168:171], v[92:95], a[76:79]
    s_waitcnt lgkmcnt(4)
    v_mfma_f32_16x16x32_bf16 a[80:83], a[172:175], v[64:67], a[80:83]
    ds_read_b128 a[192:195], v100 offset:0
    v_mfma_f32_16x16x32_bf16 a[80:83], a[176:179], v[80:83], a[80:83]
    ds_read_b128 a[196:199], v101 offset:0
    v_mfma_f32_16x16x32_bf16 a[84:87], a[172:175], v[68:71], a[84:87]
    ds_read_b128 a[200:203], v102 offset:0
    v_mov_b32 v10, v121
    v_mfma_f32_16x16x32_bf16 a[84:87], a[176:179], v[84:87], a[84:87]
    ds_read_b128 a[204:207], v103 offset:0
    v_mov_b32 v11, 1
    v_mfma_f32_16x16x32_bf16 a[88:91], a[172:175], v[72:75], a[88:91]
    ds_read_b128 a[208:211], v100 offset:4096
    v_lshlrev_b32 v9, 2, v6
    v_mfma_f32_16x16x32_bf16 a[88:91], a[176:179], v[88:91], a[88:91]
    ds_read_b128 a[212:215], v101 offset:4096
    v_mov_b32 v14, v115
    v_mfma_f32_16x16x32_bf16 a[92:95], a[172:175], v[76:79], a[92:95]
    ds_read_b128 a[216:219], v102 offset:4096
    v_mfma_f32_16x16x32_bf16 a[92:95], a[176:179], v[92:95], a[92:95]
    s_waitcnt lgkmcnt(7)
    ds_read_b128 a[220:223], v103 offset:4096
    v_mfma_f32_16x16x32_bf16 a[96:99], a[180:183], v[64:67], a[96:99]
    v_mfma_f32_16x16x32_bf16 a[96:99], a[184:187], v[80:83], a[96:99]
    v_mfma_f32_16x16x32_bf16 a[100:103], a[180:183], v[68:71], a[100:103]
    v_mfma_f32_16x16x32_bf16 a[100:103], a[184:187], v[84:87], a[100:103]
    v_mfma_f32_16x16x32_bf16 a[104:107], a[180:183], v[72:75], a[104:107]
    v_mfma_f32_16x16x32_bf16 a[104:107], a[184:187], v[88:91], a[104:107]
    v_mfma_f32_16x16x32_bf16 a[108:111], a[180:183], v[76:79], a[108:111]
    v_mfma_f32_16x16x32_bf16 a[108:111], a[184:187], v[92:95], a[108:111]
    s_waitcnt lgkmcnt(15)
    v_mfma_f32_16x16x32_bf16 v[128:131], a[224:227], v[16:19], v[128:131]
    v_mul_f32 v116, 0x3e0293ee, v116
    v_mul_f32 v117, 0x3e0293ee, v117
    v_mfma_f32_16x16x32_bf16 v[144:147], a[228:231], v[16:19], v[144:147]
    v_mul_f32 v118, 0x3e0293ee, v118
    v_mul_f32 v119, 0x3e0293ee, v119
    v_mfma_f32_16x16x32_bf16 v[132:135], a[224:227], v[20:23], v[132:135]
    s_mov_b32 s40, 32768
    s_add_u32 m0, s42, 32768
    v_mfma_f32_16x16x32_bf16 v[148:151], a[228:231], v[20:23], v[148:151]
    buffer_load_dwordx4 v112, s[20:23], s40 offen offset:0 lds
    v_mfma_f32_16x16x32_bf16 v[136:139], a[224:227], v[24:27], v[136:139]
    v_mfma_f32_16x16x32_bf16 v[152:155], a[228:231], v[24:27], v[152:155]
    buffer_load_dwordx4 v113, s[20:23], s40 offen offset:1024 lds
    v_mfma_f32_16x16x32_bf16 v[140:143], a[224:227], v[28:31], v[140:143]
    v_mul_f32 v128, v128, v116
    v_mul_f32 v129, v129, v116
    v_mfma_f32_16x16x32_bf16 v[156:159], a[228:231], v[28:31], v[156:159]
    s_mov_b32 s40, 40960
    v_mul_f32 v130, v130, v116
    v_mul_f32 v131, v131, v116
    v_mfma_f32_16x16x32_bf16 v[160:163], a[232:235], v[16:19], v[160:163]
    s_add_u32 m0, s42, 40960
    v_mul_f32 v144, v144, v116
    v_mul_f32 v145, v145, v116
    v_mfma_f32_16x16x32_bf16 v[176:179], a[236:239], v[16:19], v[176:179]
    v_mul_f32 v146, v146, v116
    v_mul_f32 v147, v147, v116
    v_mfma_f32_16x16x32_bf16 v[164:167], a[232:235], v[20:23], v[164:167]
    buffer_load_dwordx4 v112, s[20:23], s40 offen offset:0 lds
    v_mfma_f32_16x16x32_bf16 v[180:183], a[236:239], v[20:23], v[180:183]
    v_cvt_pk_bf16_f32 v32, v128, v129
    v_cvt_pk_bf16_f32 v33, v130, v131
    v_mfma_f32_16x16x32_bf16 v[168:171], a[232:235], v[24:27], v[168:171]
    v_cvt_pk_bf16_f32 v34, v144, v145
    v_cvt_pk_bf16_f32 v35, v146, v147
    v_mfma_f32_16x16x32_bf16 v[184:187], a[236:239], v[24:27], v[184:187]
    v_mul_f32 v132, v132, v117
    v_mul_f32 v133, v133, v117
    v_mfma_f32_16x16x32_bf16 v[172:175], a[232:235], v[28:31], v[172:175]
    buffer_load_dwordx4 v113, s[20:23], s40 offen offset:1024 lds
    v_mfma_f32_16x16x32_bf16 v[188:191], a[236:239], v[28:31], v[188:191]
    v_mul_f32 v134, v134, v117
    v_mul_f32 v135, v135, v117
    v_mfma_f32_16x16x32_bf16 v[192:195], a[240:243], v[16:19], v[192:195]
    v_mul_f32 v148, v148, v117
    v_mul_f32 v149, v149, v117
    v_mfma_f32_16x16x32_bf16 v[208:211], a[244:247], v[16:19], v[208:211]
    v_mul_f32 v150, v150, v117
    v_mul_f32 v151, v151, v117
    v_mfma_f32_16x16x32_bf16 v[196:199], a[240:243], v[20:23], v[196:199]
    v_cvt_pk_bf16_f32 v48, v132, v133
    v_cvt_pk_bf16_f32 v49, v134, v135
    v_mfma_f32_16x16x32_bf16 v[212:215], a[244:247], v[20:23], v[212:215]
    v_cvt_pk_bf16_f32 v50, v148, v149
    v_cvt_pk_bf16_f32 v51, v150, v151
    v_mfma_f32_16x16x32_bf16 v[200:203], a[240:243], v[24:27], v[200:203]
    v_mul_f32 v136, v136, v118
    v_mul_f32 v137, v137, v118
    v_mfma_f32_16x16x32_bf16 v[216:219], a[244:247], v[24:27], v[216:219]
    v_mul_f32 v138, v138, v118
    v_mul_f32 v139, v139, v118
    v_mfma_f32_16x16x32_bf16 v[204:207], a[240:243], v[28:31], v[204:207]
    v_mul_f32 v152, v152, v118
    v_mul_f32 v153, v153, v118
    v_mfma_f32_16x16x32_bf16 v[220:223], a[244:247], v[28:31], v[220:223]
    v_mul_f32 v154, v154, v118
    v_mul_f32 v155, v155, v118
    v_mfma_f32_16x16x32_bf16 v[224:227], a[248:251], v[16:19], v[224:227]
    v_cvt_pk_bf16_f32 v64, v136, v137
    v_cvt_pk_bf16_f32 v65, v138, v139
    v_mfma_f32_16x16x32_bf16 v[240:243], a[252:255], v[16:19], v[240:243]
    v_cvt_pk_bf16_f32 v66, v152, v153
    v_cvt_pk_bf16_f32 v67, v154, v155
    v_mfma_f32_16x16x32_bf16 v[228:231], a[248:251], v[20:23], v[228:231]
    v_mul_f32 v140, v140, v119
    v_mul_f32 v141, v141, v119
    v_mfma_f32_16x16x32_bf16 v[244:247], a[252:255], v[20:23], v[244:247]
    v_mul_f32 v142, v142, v119
    v_mul_f32 v143, v143, v119
    v_mfma_f32_16x16x32_bf16 v[232:235], a[248:251], v[24:27], v[232:235]
    v_mul_f32 v156, v156, v119
    v_mul_f32 v157, v157, v119
    v_mfma_f32_16x16x32_bf16 v[248:251], a[252:255], v[24:27], v[248:251]
    v_mul_f32 v158, v158, v119
    v_mul_f32 v159, v159, v119
    v_mfma_f32_16x16x32_bf16 v[236:239], a[248:251], v[28:31], v[236:239]
    v_cvt_pk_bf16_f32 v80, v140, v141
    v_cvt_pk_bf16_f32 v81, v142, v143
    v_mfma_f32_16x16x32_bf16 v[252:255], a[252:255], v[28:31], v[252:255]
    v_cvt_pk_bf16_f32 v82, v156, v157
    v_cvt_pk_bf16_f32 v83, v158, v159
    v_mfma_f32_16x16x32_bf16 a[0:3], a[112:115], v[16:19], a[0:3]
    v_mul_f32 v160, v160, v116
    v_mul_f32 v161, v161, v116
    v_mfma_f32_16x16x32_bf16 a[4:7], a[112:115], v[20:23], a[4:7]
    v_mul_f32 v162, v162, v116
    v_mul_f32 v163, v163, v116
    v_mfma_f32_16x16x32_bf16 a[8:11], a[112:115], v[24:27], a[8:11]
    v_mul_f32 v176, v176, v116
    v_mul_f32 v177, v177, v116
    v_mfma_f32_16x16x32_bf16 a[12:15], a[112:115], v[28:31], a[12:15]
    v_mul_f32 v178, v178, v116
    v_mul_f32 v179, v179, v116
    v_mfma_f32_16x16x32_bf16 a[16:19], a[116:119], v[16:19], a[16:19]
    v_cvt_pk_bf16_f32 v36, v160, v161
    v_cvt_pk_bf16_f32 v37, v162, v163
    v_mfma_f32_16x16x32_bf16 a[20:23], a[116:119], v[20:23], a[20:23]
    v_cvt_pk_bf16_f32 v38, v176, v177
    v_cvt_pk_bf16_f32 v39, v178, v179
    v_mfma_f32_16x16x32_bf16 a[24:27], a[116:119], v[24:27], a[24:27]
    v_mul_f32 v164, v164, v117
    v_mul_f32 v165, v165, v117
    v_mfma_f32_16x16x32_bf16 a[28:31], a[116:119], v[28:31], a[28:31]
    v_mul_f32 v166, v166, v117
    v_mul_f32 v167, v167, v117
    v_mfma_f32_16x16x32_bf16 a[32:35], a[120:123], v[16:19], a[32:35]
    v_mul_f32 v180, v180, v117
    v_mul_f32 v181, v181, v117
    v_mfma_f32_16x16x32_bf16 a[36:39], a[120:123], v[20:23], a[36:39]
    v_mul_f32 v182, v182, v117
    v_mul_f32 v183, v183, v117
    v_mfma_f32_16x16x32_bf16 a[40:43], a[120:123], v[24:27], a[40:43]
    v_cvt_pk_bf16_f32 v52, v164, v165
    v_cvt_pk_bf16_f32 v53, v166, v167
    v_mfma_f32_16x16x32_bf16 a[44:47], a[120:123], v[28:31], a[44:47]
    v_cvt_pk_bf16_f32 v54, v180, v181
    v_cvt_pk_bf16_f32 v55, v182, v183
    v_mfma_f32_16x16x32_bf16 a[48:51], a[124:127], v[16:19], a[48:51]
    v_mul_f32 v168, v168, v118
    v_mul_f32 v169, v169, v118
    v_mfma_f32_16x16x32_bf16 a[52:55], a[124:127], v[20:23], a[52:55]
    v_mul_f32 v170, v170, v118
    v_mul_f32 v171, v171, v118
    v_mfma_f32_16x16x32_bf16 a[56:59], a[124:127], v[24:27], a[56:59]
    v_mul_f32 v184, v184, v118
    v_mul_f32 v185, v185, v118
    v_mfma_f32_16x16x32_bf16 a[60:63], a[124:127], v[28:31], a[60:63]
    v_mul_f32 v186, v186, v118
    v_mul_f32 v187, v187, v118
    v_mfma_f32_16x16x32_bf16 a[64:67], a[144:147], v[16:19], a[64:67]
    v_cvt_pk_bf16_f32 v68, v168, v169
    v_cvt_pk_bf16_f32 v69, v170, v171
    v_mfma_f32_16x16x32_bf16 a[68:71], a[144:147], v[20:23], a[68:71]
    v_cvt_pk_bf16_f32 v70, v184, v185
    v_cvt_pk_bf16_f32 v71, v186, v187
    v_mfma_f32_16x16x32_bf16 a[72:75], a[144:147], v[24:27], a[72:75]
    v_mul_f32 v172, v172, v119
    v_mul_f32 v173, v173, v119
    v_mfma_f32_16x16x32_bf16 a[76:79], a[144:147], v[28:31], a[76:79]
    v_mul_f32 v174, v174, v119
    v_mul_f32 v175, v175, v119
    v_mfma_f32_16x16x32_bf16 a[80:83], a[148:151], v[16:19], a[80:83]
    v_mul_f32 v188, v188, v119
    v_mul_f32 v189, v189, v119
    v_mfma_f32_16x16x32_bf16 a[84:87], a[148:151], v[20:23], a[84:87]
    v_mul_f32 v190, v190, v119
    v_mul_f32 v191, v191, v119
    v_mfma_f32_16x16x32_bf16 a[88:91], a[148:151], v[24:27], a[88:91]
    v_cvt_pk_bf16_f32 v84, v172, v173
    v_cvt_pk_bf16_f32 v85, v174, v175
    v_mfma_f32_16x16x32_bf16 a[92:95], a[148:151], v[28:31], a[92:95]
    v_cvt_pk_bf16_f32 v86, v188, v189
    v_cvt_pk_bf16_f32 v87, v190, v191
    v_mfma_f32_16x16x32_bf16 a[96:99], a[152:155], v[16:19], a[96:99]
    v_mul_f32 v192, v192, v116
    v_mul_f32 v193, v193, v116
    v_mfma_f32_16x16x32_bf16 a[100:103], a[152:155], v[20:23], a[100:103]
    v_mul_f32 v194, v194, v116
    v_mul_f32 v195, v195, v116
    v_mfma_f32_16x16x32_bf16 a[104:107], a[152:155], v[24:27], a[104:107]
    v_mul_f32 v208, v208, v116
    v_mul_f32 v209, v209, v116
    v_mfma_f32_16x16x32_bf16 a[108:111], a[152:155], v[28:31], a[108:111]
    v_mul_f32 v210, v210, v116
    v_mul_f32 v211, v211, v116
    v_cvt_pk_bf16_f32 v40, v192, v193
    v_cvt_pk_bf16_f32 v41, v194, v195
    v_cvt_pk_bf16_f32 v42, v208, v209
    v_cvt_pk_bf16_f32 v43, v210, v211
    v_pk_mul_f32 v[196:197], v[196:197], v[116:117] op_sel:[0,1] op_sel_hi:[1,1]
    v_pk_mul_f32 v[198:199], v[198:199], v[116:117] op_sel:[0,1] op_sel_hi:[1,1]
    v_pk_mul_f32 v[212:213], v[212:213], v[116:117] op_sel:[0,1] op_sel_hi:[1,1]
    v_pk_mul_f32 v[214:215], v[214:215], v[116:117] op_sel:[0,1] op_sel_hi:[1,1]
    v_cvt_pk_bf16_f32 v56, v196, v197
    v_cvt_pk_bf16_f32 v57, v198, v199
    v_cvt_pk_bf16_f32 v58, v212, v213
    v_cvt_pk_bf16_f32 v59, v214, v215
    v_pk_mul_f32 v[200:201], v[200:201], v[118:119] op_sel:[0,0] op_sel_hi:[1,0]
    v_pk_mul_f32 v[202:203], v[202:203], v[118:119] op_sel:[0,0] op_sel_hi:[1,0]
    v_pk_mul_f32 v[216:217], v[216:217], v[118:119] op_sel:[0,0] op_sel_hi:[1,0]
    v_pk_mul_f32 v[218:219], v[218:219], v[118:119] op_sel:[0,0] op_sel_hi:[1,0]
    v_cvt_pk_bf16_f32 v72, v200, v201
    v_cvt_pk_bf16_f32 v73, v202, v203
    v_cvt_pk_bf16_f32 v74, v216, v217
    v_cvt_pk_bf16_f32 v75, v218, v219
    v_pk_mul_f32 v[204:205], v[204:205], v[118:119] op_sel:[0,1] op_sel_hi:[1,1]
    v_pk_mul_f32 v[206:207], v[206:207], v[118:119] op_sel:[0,1] op_sel_hi:[1,1]
    v_pk_mul_f32 v[220:221], v[220:221], v[118:119] op_sel:[0,1] op_sel_hi:[1,1]
    v_pk_mul_f32 v[222:223], v[222:223], v[118:119] op_sel:[0,1] op_sel_hi:[1,1]
    v_cvt_pk_bf16_f32 v88, v204, v205
    v_cvt_pk_bf16_f32 v89, v206, v207
    v_cvt_pk_bf16_f32 v90, v220, v221
    v_cvt_pk_bf16_f32 v91, v222, v223
    v_pk_mul_f32 v[224:225], v[224:225], v[116:117] op_sel:[0,0] op_sel_hi:[1,0]
    v_pk_mul_f32 v[226:227], v[226:227], v[116:117] op_sel:[0,0] op_sel_hi:[1,0]
    v_pk_mul_f32 v[240:241], v[240:241], v[116:117] op_sel:[0,0] op_sel_hi:[1,0]
    v_pk_mul_f32 v[242:243], v[242:243], v[116:117] op_sel:[0,0] op_sel_hi:[1,0]
    v_cvt_pk_bf16_f32 v44, v224, v225
    v_cvt_pk_bf16_f32 v45, v226, v227
    v_cvt_pk_bf16_f32 v46, v240, v241
    v_cvt_pk_bf16_f32 v47, v242, v243
    v_pk_mul_f32 v[228:229], v[228:229], v[116:117] op_sel:[0,1] op_sel_hi:[1,1]
    v_pk_mul_f32 v[230:231], v[230:231], v[116:117] op_sel:[0,1] op_sel_hi:[1,1]
    v_pk_mul_f32 v[244:245], v[244:245], v[116:117] op_sel:[0,1] op_sel_hi:[1,1]
    v_pk_mul_f32 v[246:247], v[246:247], v[116:117] op_sel:[0,1] op_sel_hi:[1,1]
    v_cvt_pk_bf16_f32 v60, v228, v229
    v_cvt_pk_bf16_f32 v61, v230, v231
    v_cvt_pk_bf16_f32 v62, v244, v245
    v_cvt_pk_bf16_f32 v63, v246, v247
    v_pk_mul_f32 v[232:233], v[232:233], v[118:119] op_sel:[0,0] op_sel_hi:[1,0]
    v_pk_mul_f32 v[234:235], v[234:235], v[118:119] op_sel:[0,0] op_sel_hi:[1,0]
    v_pk_mul_f32 v[248:249], v[248:249], v[118:119] op_sel:[0,0] op_sel_hi:[1,0]
    v_pk_mul_f32 v[250:251], v[250:251], v[118:119] op_sel:[0,0] op_sel_hi:[1,0]
    v_cvt_pk_bf16_f32 v76, v232, v233
    v_cvt_pk_bf16_f32 v77, v234, v235
    v_cvt_pk_bf16_f32 v78, v248, v249
    v_cvt_pk_bf16_f32 v79, v250, v251
    v_pk_mul_f32 v[236:237], v[236:237], v[118:119] op_sel:[0,1] op_sel_hi:[1,1]
    v_pk_mul_f32 v[238:239], v[238:239], v[118:119] op_sel:[0,1] op_sel_hi:[1,1]
    v_pk_mul_f32 v[252:253], v[252:253], v[118:119] op_sel:[0,1] op_sel_hi:[1,1]
    v_pk_mul_f32 v[254:255], v[254:255], v[118:119] op_sel:[0,1] op_sel_hi:[1,1]
    v_cvt_pk_bf16_f32 v92, v236, v237
    v_cvt_pk_bf16_f32 v93, v238, v239
    v_cvt_pk_bf16_f32 v94, v252, v253
    v_cvt_pk_bf16_f32 v95, v254, v255
    s_waitcnt lgkmcnt(0)
    v_mfma_f32_16x16x32_bf16 v[128:131], a[192:195], v[32:35], 0
    v_accvgpr_read_b32 v208, a0
    v_accvgpr_read_b32 v209, a1
    v_mfma_f32_16x16x32_bf16 v[128:131], a[196:199], v[36:39], v[128:131]
    v_accvgpr_read_b32 v210, a2
    v_accvgpr_read_b32 v211, a3
    v_mfma_f32_16x16x32_bf16 v[128:131], a[200:203], v[40:43], v[128:131]
    v_accvgpr_read_b32 v212, a16
    v_accvgpr_read_b32 v213, a17
    v_mfma_f32_16x16x32_bf16 v[128:131], a[204:207], v[44:47], v[128:131]
    v_accvgpr_read_b32 v214, a18
    v_accvgpr_read_b32 v215, a19
    v_mfma_f32_16x16x32_bf16 v[132:135], a[192:195], v[48:51], 0
    v_cvt_pk_bf16_f32 v208, v208, v209
    v_cvt_pk_bf16_f32 v209, v210, v211
    v_mfma_f32_16x16x32_bf16 v[132:135], a[196:199], v[52:55], v[132:135]
    v_cvt_pk_bf16_f32 v210, v212, v213
    v_cvt_pk_bf16_f32 v211, v214, v215
    v_mfma_f32_16x16x32_bf16 v[132:135], a[200:203], v[56:59], v[132:135]
    v_pk_max_i16 v208, v208, 0
    v_pk_max_i16 v209, v209, 0
    v_mfma_f32_16x16x32_bf16 v[132:135], a[204:207], v[60:63], v[132:135]
    v_pk_max_i16 v210, v210, 0
    v_pk_max_i16 v211, v211, 0
    v_mfma_f32_16x16x32_bf16 v[136:139], a[192:195], v[64:67], 0
    buffer_store_dwordx4 v[208:211], v115, s[28:31], s47 offen offset:0 sc1
    v_mfma_f32_16x16x32_bf16 v[136:139], a[196:199], v[68:71], v[136:139]
    v_accvgpr_read_b32 v216, a4
    v_accvgpr_read_b32 v217, a5
    v_mfma_f32_16x16x32_bf16 v[136:139], a[200:203], v[72:75], v[136:139]
    v_accvgpr_read_b32 v218, a6
    v_accvgpr_read_b32 v219, a7
    v_mfma_f32_16x16x32_bf16 v[136:139], a[204:207], v[76:79], v[136:139]
    v_accvgpr_read_b32 v220, a20
    v_accvgpr_read_b32 v221, a21
    v_mfma_f32_16x16x32_bf16 v[140:143], a[192:195], v[80:83], 0
    v_accvgpr_read_b32 v222, a22
    v_accvgpr_read_b32 v223, a23
    v_mfma_f32_16x16x32_bf16 v[140:143], a[196:199], v[84:87], v[140:143]
    v_cvt_pk_bf16_f32 v216, v216, v217
    v_cvt_pk_bf16_f32 v217, v218, v219
    v_mfma_f32_16x16x32_bf16 v[140:143], a[200:203], v[88:91], v[140:143]
    v_cvt_pk_bf16_f32 v218, v220, v221
    v_cvt_pk_bf16_f32 v219, v222, v223
    v_mfma_f32_16x16x32_bf16 v[140:143], a[204:207], v[92:95], v[140:143]
    v_pk_max_i16 v216, v216, 0
    v_pk_max_i16 v217, v217, 0
    v_mfma_f32_16x16x32_bf16 v[144:147], a[208:211], v[32:35], 0
    v_pk_max_i16 v218, v218, 0
    v_pk_max_i16 v219, v219, 0
    v_mfma_f32_16x16x32_bf16 v[144:147], a[212:215], v[36:39], v[144:147]
    ds_read_b128 a[192:195], v100 offset:8192
    v_mfma_f32_16x16x32_bf16 v[144:147], a[216:219], v[40:43], v[144:147]
    buffer_store_dwordx4 v[216:219], v115, s[28:31], s47 offen offset:1024 sc1
    v_mfma_f32_16x16x32_bf16 v[144:147], a[220:223], v[44:47], v[144:147]
    v_accvgpr_read_b32 v208, a8
    v_accvgpr_read_b32 v209, a9
    v_mfma_f32_16x16x32_bf16 v[148:151], a[208:211], v[48:51], 0
    v_accvgpr_read_b32 v210, a10
    v_accvgpr_read_b32 v211, a11
    v_mfma_f32_16x16x32_bf16 v[148:151], a[212:215], v[52:55], v[148:151]
    ds_read_b128 a[196:199], v101 offset:8192
    v_accvgpr_read_b32 v212, a24
    v_mfma_f32_16x16x32_bf16 v[148:151], a[216:219], v[56:59], v[148:151]
    v_accvgpr_read_b32 v213, a25
    v_accvgpr_read_b32 v214, a26
    v_mfma_f32_16x16x32_bf16 v[148:151], a[220:223], v[60:63], v[148:151]
    v_accvgpr_read_b32 v215, a27
    v_cvt_pk_bf16_f32 v208, v208, v209
    v_mfma_f32_16x16x32_bf16 v[152:155], a[208:211], v[64:67], 0
    v_cvt_pk_bf16_f32 v209, v210, v211
    v_cvt_pk_bf16_f32 v210, v212, v213
    v_mfma_f32_16x16x32_bf16 v[152:155], a[212:215], v[68:71], v[152:155]
    ds_read_b128 a[200:203], v102 offset:8192
    v_cvt_pk_bf16_f32 v211, v214, v215
    v_mfma_f32_16x16x32_bf16 v[152:155], a[216:219], v[72:75], v[152:155]
    v_pk_max_i16 v208, v208, 0
    v_pk_max_i16 v209, v209, 0
    v_mfma_f32_16x16x32_bf16 v[152:155], a[220:223], v[76:79], v[152:155]
    v_pk_max_i16 v210, v210, 0
    v_pk_max_i16 v211, v211, 0
    v_mfma_f32_16x16x32_bf16 v[156:159], a[208:211], v[80:83], 0
    buffer_store_dwordx4 v[208:211], v115, s[28:31], s47 offen offset:2048 sc1
    v_mfma_f32_16x16x32_bf16 v[156:159], a[212:215], v[84:87], v[156:159]
    ds_read_b128 a[204:207], v103 offset:8192
    v_accvgpr_read_b32 v216, a12
    v_mfma_f32_16x16x32_bf16 v[156:159], a[216:219], v[88:91], v[156:159]
    v_accvgpr_read_b32 v217, a13
    v_accvgpr_read_b32 v218, a14
    v_mfma_f32_16x16x32_bf16 v[156:159], a[220:223], v[92:95], v[156:159]
    v_accvgpr_read_b32 v219, a15
    v_accvgpr_read_b32 v220, a28
    ds_read_b128 a[208:211], v100 offset:12288
    ds_read_b128 a[212:215], v101 offset:12288
    ds_read_b128 a[216:219], v102 offset:12288
    ds_read_b128 a[220:223], v103 offset:12288
    v_max3_f32 v116, v128, v129, v130
    v_max3_f32 v117, v132, v133, v134
    v_max3_f32 v118, v136, v137, v138
    v_max3_f32 v119, v140, v141, v142
    v_max3_f32 v116, v116, v131, v144
    v_max3_f32 v117, v117, v135, v148
    v_max3_f32 v118, v118, v139, v152
    v_max3_f32 v119, v119, v143, v156
    v_max3_f32 v116, v116, v145, v146
    v_max3_f32 v117, v117, v149, v150
    v_max3_f32 v118, v118, v153, v154
    v_max3_f32 v119, v119, v157, v158
    v_max_f32 v116, v116, v147
    v_max_f32 v117, v117, v151
    v_max_f32 v118, v118, v155
    v_max_f32 v119, v119, v159
    v_mov_b32 v120, v116
    v_mov_b32 v121, v117
    v_mov_b32 v122, v118
    v_mov_b32 v123, v119
    v_permlane32_swap_b32 v116, v120
    v_permlane32_swap_b32 v117, v121
    v_permlane32_swap_b32 v118, v122
    v_permlane32_swap_b32 v119, v123
    v_max_f32 v116, v116, v120
    v_max_f32 v117, v117, v121
    v_max_f32 v118, v118, v122
    v_max_f32 v119, v119, v123
    v_mov_b32 v120, v116
    v_mov_b32 v121, v117
    v_mov_b32 v122, v118
    v_mov_b32 v123, v119
    v_permlane16_swap_b32 v116, v120
    v_permlane16_swap_b32 v117, v121
    v_permlane16_swap_b32 v118, v122
    v_permlane16_swap_b32 v119, v123
    v_max_f32 v116, v116, v120
    v_max_f32 v117, v117, v121
    v_max_f32 v118, v118, v122
    v_max_f32 v119, v119, v123
    v_sub_f32 v16, 0xc1300000, v116
    v_sub_f32 v20, 0xc1300000, v117
    v_sub_f32 v24, 0xc1300000, v118
    v_sub_f32 v28, 0xc1300000, v119
    v_mov_b32 v17, v16
    v_mov_b32 v21, v20
    v_mov_b32 v25, v24
    v_mov_b32 v29, v28
    v_pk_add_f32 v[128:129], v[128:129], v[16:17]
    v_pk_add_f32 v[130:131], v[130:131], v[16:17]
    v_pk_add_f32 v[144:145], v[144:145], v[16:17]
    v_pk_add_f32 v[146:147], v[146:147], v[16:17]
    v_pk_mov_b32 v[18:19], v[16:17], v[16:17]
    v_pk_add_f32 v[132:133], v[132:133], v[20:21]
    v_pk_add_f32 v[134:135], v[134:135], v[20:21]
    v_pk_add_f32 v[148:149], v[148:149], v[20:21]
    v_pk_add_f32 v[150:151], v[150:151], v[20:21]
    v_pk_mov_b32 v[22:23], v[20:21], v[20:21]
    v_pk_add_f32 v[136:137], v[136:137], v[24:25]
    v_pk_add_f32 v[138:139], v[138:139], v[24:25]
    v_pk_add_f32 v[152:153], v[152:153], v[24:25]
    v_pk_add_f32 v[154:155], v[154:155], v[24:25]
    v_pk_mov_b32 v[26:27], v[24:25], v[24:25]
    v_pk_add_f32 v[140:141], v[140:141], v[28:29]
    v_pk_add_f32 v[142:143], v[142:143], v[28:29]
    v_pk_add_f32 v[156:157], v[156:157], v[28:29]
    v_pk_add_f32 v[158:159], v[158:159], v[28:29]
    v_pk_mov_b32 v[30:31], v[28:29], v[28:29]
    s_mov_b32 s40, 49152
    s_mov_b32 s50, 32768
    s_waitcnt lgkmcnt(0)
    v_exp_f32 v116, v128
    v_exp_f32 v117, v129
    s_nop 0
    v_cvt_pk_bf16_f32 v224, v116, v117
    v_exp_f32 v118, v130
    v_mfma_f32_16x16x32_bf16 v[160:163], a[192:195], v[32:35], v[16:19]
    s_mov_b32 s8, s60
    v_exp_f32 v119, v131
    v_mfma_f32_16x16x32_bf16 v[160:163], a[196:199], v[36:39], v[160:163]
    s_and_b32 s9, s61, 0xffff
    s_mov_b32 s11, 0x20000
    v_cvt_pk_bf16_f32 v225, v118, v119
    v_mfma_f32_16x16x32_bf16 v[160:163], a[200:203], v[40:43], v[160:163]
    s_add_u32 m0, s42, 49152
    v_exp_f32 v120, v144
    v_mfma_f32_16x16x32_bf16 v[160:163], a[204:207], v[44:47], v[160:163]
    buffer_load_dwordx4 v112, s[20:23], s40 offen offset:0 lds
    v_mfma_f32_16x16x32_bf16 v[164:167], a[192:195], v[48:51], v[20:23]
    s_mov_b32 s15, 0x20000
    v_exp_f32 v121, v145
    v_mfma_f32_16x16x32_bf16 v[164:167], a[196:199], v[52:55], v[164:167]
    v_cvt_pk_bf16_f32 v226, v120, v121
    v_accvgpr_read_b32 v4, a128
    v_mfma_f32_16x16x32_bf16 v[164:167], a[200:203], v[56:59], v[164:167]
    v_exp_f32 v122, v146
    v_mfma_f32_16x16x32_bf16 v[164:167], a[204:207], v[60:63], v[164:167]
    buffer_load_dwordx4 v113, s[20:23], s40 offen offset:1024 lds
    v_mfma_f32_16x16x32_bf16 v[168:171], a[192:195], v[64:67], v[24:27]
    s_add_u32 s40, s40, 8192
    v_exp_f32 v123, v147
    v_mfma_f32_16x16x32_bf16 v[168:171], a[196:199], v[68:71], v[168:171]
    v_cvt_pk_bf16_f32 v227, v122, v123
    v_accvgpr_read_b32 v5, a129
    v_mfma_f32_16x16x32_bf16 v[168:171], a[200:203], v[72:75], v[168:171]
    v_exp_f32 v116, v132
    v_mfma_f32_16x16x32_bf16 v[168:171], a[204:207], v[76:79], v[168:171]
    v_accvgpr_read_b32 v1, a130
    v_accvgpr_read_b32 v13, a131
    v_mfma_f32_16x16x32_bf16 v[172:175], a[192:195], v[80:83], v[28:31]
    s_bfe_u32 s17, s2, 0x10002
    v_exp_f32 v117, v133
    v_mfma_f32_16x16x32_bf16 v[172:175], a[196:199], v[84:87], v[172:175]
    s_bfe_u32 s5, s2, 0x30003
    s_lshl3_add_u32 s17, s17, s5
    v_cvt_pk_bf16_f32 v232, v116, v117
    v_mfma_f32_16x16x32_bf16 v[172:175], a[200:203], v[88:91], v[172:175]
    s_bfe_u32 s18, s2, 0x10001
    v_exp_f32 v118, v134
    v_mfma_f32_16x16x32_bf16 v[172:175], a[204:207], v[92:95], v[172:175]
    v_accvgpr_read_b32 v221, a29
    v_accvgpr_read_b32 v222, a30
    v_mfma_f32_16x16x32_bf16 v[176:179], a[208:211], v[32:35], v[16:19]
    s_lshr_b32 s5, s2, 6
    v_exp_f32 v119, v135
    v_mfma_f32_16x16x32_bf16 v[176:179], a[212:215], v[36:39], v[176:179]
    v_cvt_pk_bf16_f32 v233, v118, v119
    v_accvgpr_read_b32 v223, a31
    v_mfma_f32_16x16x32_bf16 v[176:179], a[216:219], v[40:43], v[176:179]
    s_lshl2_add_u32 s18, s18, s5
    v_exp_f32 v120, v148
    v_mfma_f32_16x16x32_bf16 v[176:179], a[220:223], v[44:47], v[176:179]
    v_bfe_u32 v3, v6, 0, 2
    v_cvt_pk_bf16_f32 v216, v216, v217
    v_mfma_f32_16x16x32_bf16 v[180:183], a[208:211], v[48:51], v[20:23]
    v_exp_f32 v121, v149
    v_mfma_f32_16x16x32_bf16 v[180:183], a[212:215], v[52:55], v[180:183]
    v_cvt_pk_bf16_f32 v234, v120, v121
    v_bfe_u32 v8, v6, 3, 1
    v_mfma_f32_16x16x32_bf16 v[180:183], a[216:219], v[56:59], v[180:183]
    v_exp_f32 v122, v150
    v_mfma_f32_16x16x32_bf16 v[180:183], a[220:223], v[60:63], v[180:183]
    v_lshl_add_u32 v3, v3, 1, v8
    v_cvt_pk_bf16_f32 v217, v218, v219
    v_mfma_f32_16x16x32_bf16 v[184:187], a[208:211], v[64:67], v[24:27]
    v_exp_f32 v123, v151
    v_mfma_f32_16x16x32_bf16 v[184:187], a[212:215], v[68:71], v[184:187]
    v_cvt_pk_bf16_f32 v235, v122, v123
    v_add_u32 v3, s2, v3
    v_mfma_f32_16x16x32_bf16 v[184:187], a[216:219], v[72:75], v[184:187]
    s_waitcnt vmcnt(13)
    s_barrier
    v_mfma_f32_16x16x32_bf16 v[184:187], a[220:223], v[76:79], v[184:187]
    v_exp_f32 v116, v136
    v_mfma_f32_16x16x32_bf16 v[188:191], a[208:211], v[80:83], v[28:31]
    ds_read_b128 a[192:195], v100 offset:16384
    v_and_b32 v3, 7, v3
    v_mfma_f32_16x16x32_bf16 v[188:191], a[212:215], v[84:87], v[188:191]
    s_add_u32 m0, s42, 98304
    v_exp_f32 v117, v137
    v_mfma_f32_16x16x32_bf16 v[188:191], a[216:219], v[88:91], v[188:191]
    ds_read_b128 a[196:199], v101 offset:16384
    v_cvt_pk_bf16_f32 v240, v116, v117
    v_mfma_f32_16x16x32_bf16 v[188:191], a[220:223], v[92:95], v[188:191]
    v_exp_f32 v118, v138
    buffer_load_dwordx4 v114, s[24:27], s50 offen offset:0 lds
    v_cvt_pk_bf16_f32 v218, v220, v221
    v_cvt_pk_bf16_f32 v219, v222, v223
    v_pk_max_i16 v216, v216, 0
    ds_read_b128 a[200:203], v102 offset:16384
    v_pk_max_i16 v217, v217, 0
    v_pk_max_i16 v218, v218, 0
    v_pk_max_i16 v219, v219, 0
    buffer_store_dwordx4 v[216:219], v115, s[28:31], s47 offen offset:3072 sc1
    v_exp_f32 v119, v139
    s_add_u32 s47, s47, 8192
    ds_read_b128 a[204:207], v103 offset:16384
    v_accvgpr_read_b32 v208, a32
    v_accvgpr_read_b32 v209, a33
    v_accvgpr_read_b32 v210, a34
    v_accvgpr_read_b32 v211, a35
    v_cvt_pk_bf16_f32 v241, v118, v119
    v_accvgpr_read_b32 v212, a48
    v_accvgpr_read_b32 v213, a49
    v_accvgpr_read_b32 v214, a50
    v_exp_f32 v120, v152
    buffer_load_dwordx4 v125, s[24:27], s50 offen offset:1024 lds
    v_accvgpr_read_b32 v215, a51
    v_cvt_pk_bf16_f32 v208, v208, v209
    v_cvt_pk_bf16_f32 v209, v210, v211
    s_add_u32 s50, s50, 8192
    v_cvt_pk_bf16_f32 v210, v212, v213
    v_cvt_pk_bf16_f32 v211, v214, v215
    v_pk_max_i16 v208, v208, 0
    v_exp_f32 v121, v153
    ds_read_b128 a[208:211], v100 offset:20480
    v_pk_max_i16 v209, v209, 0
    v_pk_max_i16 v210, v210, 0
    v_pk_max_i16 v211, v211, 0
    v_cvt_pk_bf16_f32 v242, v120, v121
    buffer_store_dwordx4 v[208:211], v115, s[28:31], s47 offen offset:0 sc1
    v_accvgpr_read_b32 v216, a36
    v_accvgpr_read_b32 v217, a37
    v_exp_f32 v122, v154
    ds_read_b128 a[212:215], v101 offset:20480
    v_accvgpr_read_b32 v218, a38
    v_accvgpr_read_b32 v219, a39
    v_accvgpr_read_b32 v220, a52
    v_accvgpr_read_b32 v221, a53
    v_accvgpr_read_b32 v222, a54
    v_accvgpr_read_b32 v223, a55
    v_exp_f32 v123, v155
    ds_read_b128 a[216:219], v102 offset:20480
    v_cvt_pk_bf16_f32 v216, v216, v217
    v_cvt_pk_bf16_f32 v217, v218, v219
    v_cvt_pk_bf16_f32 v218, v220, v221
    v_cvt_pk_bf16_f32 v243, v122, v123
    v_cvt_pk_bf16_f32 v219, v222, v223
    v_pk_max_i16 v216, v216, 0
    v_pk_max_i16 v217, v217, 0
    v_exp_f32 v116, v140
    ds_read_b128 a[220:223], v103 offset:20480
    v_pk_max_i16 v218, v218, 0
    v_pk_max_i16 v219, v219, 0
    buffer_store_dwordx4 v[216:219], v115, s[28:31], s47 offen offset:1024 sc1
    v_accvgpr_read_b32 v208, a40
    v_accvgpr_read_b32 v209, a41
    v_accvgpr_read_b32 v210, a42
    v_exp_f32 v117, v141
    v_accvgpr_read_b32 v211, a43
    v_accvgpr_read_b32 v212, a56
    v_cvt_pk_bf16_f32 v248, v116, v117
    v_accvgpr_read_b32 v213, a57
    v_accvgpr_read_b32 v214, a58
    v_accvgpr_read_b32 v215, a59
    v_exp_f32 v118, v142
    v_cvt_pk_bf16_f32 v208, v208, v209
    v_cvt_pk_bf16_f32 v209, v210, v211
    v_cvt_pk_bf16_f32 v210, v212, v213
    v_cvt_pk_bf16_f32 v211, v214, v215
    v_pk_max_i16 v208, v208, 0
    v_pk_max_i16 v209, v209, 0
    v_exp_f32 v119, v143
    v_pk_max_i16 v210, v210, 0
    v_pk_max_i16 v211, v211, 0
    v_cvt_pk_bf16_f32 v249, v118, v119
    buffer_store_dwordx4 v[208:211], v115, s[28:31], s47 offen offset:2048 sc1
    v_accvgpr_read_b32 v216, a44
    v_accvgpr_read_b32 v217, a45
    v_accvgpr_read_b32 v218, a46
    v_exp_f32 v120, v156
    v_accvgpr_read_b32 v219, a47
    v_accvgpr_read_b32 v220, a60
    v_accvgpr_read_b32 v221, a61
    v_accvgpr_read_b32 v222, a62
    v_accvgpr_read_b32 v223, a63
    v_cvt_pk_bf16_f32 v216, v216, v217
    v_exp_f32 v121, v157
    v_cvt_pk_bf16_f32 v217, v218, v219
    v_cvt_pk_bf16_f32 v218, v220, v221
    v_cvt_pk_bf16_f32 v219, v222, v223
    v_cvt_pk_bf16_f32 v250, v120, v121
    v_pk_max_i16 v216, v216, 0
    v_pk_max_i16 v217, v217, 0
    v_pk_max_i16 v218, v218, 0
    v_exp_f32 v122, v158
    v_pk_max_i16 v219, v219, 0
    buffer_store_dwordx4 v[216:219], v115, s[28:31], s47 offen offset:3072 sc1
    v_exp_f32 v123, v159
    s_add_u32 s47, s47, 8192
    v_accvgpr_read_b32 v208, a64
    v_accvgpr_read_b32 v209, a65
    v_accvgpr_read_b32 v210, a66
    v_accvgpr_read_b32 v211, a67
    v_accvgpr_read_b32 v212, a80
    v_accvgpr_read_b32 v213, a81
    v_cvt_pk_bf16_f32 v251, v122, v123
    v_accvgpr_read_b32 v214, a82
    v_accvgpr_read_b32 v215, a83
    v_cvt_pk_bf16_f32 v208, v208, v209
    v_exp_f32 v116, v160
    v_cvt_pk_bf16_f32 v209, v210, v211
    v_cvt_pk_bf16_f32 v210, v212, v213
    v_cvt_pk_bf16_f32 v211, v214, v215
    v_pk_max_i16 v208, v208, 0
    v_pk_max_i16 v209, v209, 0
    v_pk_max_i16 v210, v210, 0
    v_exp_f32 v117, v161
    v_pk_max_i16 v211, v211, 0
    v_cvt_pk_bf16_f32 v228, v116, v117
    buffer_store_dwordx4 v[208:211], v115, s[28:31], s47 offen offset:0 sc1
    v_exp_f32 v118, v162
    s_waitcnt lgkmcnt(0)
    v_mfma_f32_16x16x32_bf16 v[128:131], a[192:195], v[32:35], v[16:19]
    v_exp_f32 v119, v163
    v_mfma_f32_16x16x32_bf16 v[128:131], a[196:199], v[36:39], v[128:131]
    v_cvt_pk_bf16_f32 v229, v118, v119
    v_bfe_u32 v8, v6, 2, 1
    v_lshl_add_u32 v3, v3, 1, v8
    v_mfma_f32_16x16x32_bf16 v[128:131], a[200:203], v[40:43], v[128:131]
    s_add_u32 m0, s42, 57344
    v_exp_f32 v120, v176
    v_mfma_f32_16x16x32_bf16 v[128:131], a[204:207], v[44:47], v[128:131]
    buffer_load_dwordx4 v112, s[20:23], s40 offen offset:0 lds
    v_mfma_f32_16x16x32_bf16 v[132:135], a[192:195], v[48:51], v[20:23]
    s_lshl3_add_u32 s5, s17, s18
    v_exp_f32 v121, v177
    v_mfma_f32_16x16x32_bf16 v[132:135], a[196:199], v[52:55], v[132:135]
    s_lshl_b32 s5, s5, 15
    s_lshl1_add_u32 s38, s52, s5
    v_cvt_pk_bf16_f32 v230, v120, v121
    v_mfma_f32_16x16x32_bf16 v[132:135], a[200:203], v[56:59], v[132:135]
    s_add_u32 s38, s38, 0x2200000
    v_exp_f32 v122, v178
    v_mfma_f32_16x16x32_bf16 v[132:135], a[204:207], v[60:63], v[132:135]
    buffer_load_dwordx4 v113, s[20:23], s40 offen offset:1024 lds
    v_mfma_f32_16x16x32_bf16 v[136:139], a[192:195], v[64:67], v[24:27]
    s_add_u32 s40, s40, 8192
    v_exp_f32 v123, v179
    v_mfma_f32_16x16x32_bf16 v[136:139], a[196:199], v[68:71], v[136:139]
    s_lshl_b32 s5, s17, 18
    s_lshl_b32 s6, s18, 8
    v_cvt_pk_bf16_f32 v231, v122, v123
    v_mfma_f32_16x16x32_bf16 v[136:139], a[200:203], v[72:75], v[136:139]
    s_add_u32 s101, s5, s6
    v_exp_f32 v116, v164
    v_mfma_f32_16x16x32_bf16 v[136:139], a[204:207], v[76:79], v[136:139]
    v_accvgpr_read_b32 v216, a68
    v_accvgpr_read_b32 v217, a69
    v_mfma_f32_16x16x32_bf16 v[140:143], a[192:195], v[80:83], v[28:31]
    s_lshl1_add_u32 s5, s18, s17
    v_exp_f32 v117, v165
    v_mfma_f32_16x16x32_bf16 v[140:143], a[196:199], v[84:87], v[140:143]
    v_cvt_pk_bf16_f32 v236, v116, v117
    v_accvgpr_read_b32 v218, a70
    v_mfma_f32_16x16x32_bf16 v[140:143], a[200:203], v[88:91], v[140:143]
    s_and_b32 s5, s5, 7
    v_exp_f32 v118, v166
    v_mfma_f32_16x16x32_bf16 v[140:143], a[204:207], v[92:95], v[140:143]
    s_lshl_b32 s36, s5, 13
    v_accvgpr_read_b32 v219, a71
    v_accvgpr_read_b32 v220, a84
    v_mfma_f32_16x16x32_bf16 v[144:147], a[208:211], v[32:35], v[16:19]
    v_exp_f32 v119, v167
    v_mfma_f32_16x16x32_bf16 v[144:147], a[212:215], v[36:39], v[144:147]
    s_mov_b32 s16, s36
    ds_read_b128 a[192:195], v100 offset:24576
    v_cvt_pk_bf16_f32 v237, v118, v119
    v_mfma_f32_16x16x32_bf16 v[144:147], a[216:219], v[40:43], v[144:147]
    v_exp_f32 v120, v180
    v_mfma_f32_16x16x32_bf16 v[144:147], a[220:223], v[44:47], v[144:147]
    s_lshl_b32 s7, s17, 7
    ds_read_b128 a[196:199], v101 offset:24576
    v_accvgpr_read_b32 v221, a85
    v_mfma_f32_16x16x32_bf16 v[148:151], a[208:211], v[48:51], v[20:23]
    v_exp_f32 v121, v181
    v_mfma_f32_16x16x32_bf16 v[148:151], a[212:215], v[52:55], v[148:151]
    s_add_u32 s7, s7, 0x2600000
    ds_read_b128 a[200:203], v102 offset:24576
    v_cvt_pk_bf16_f32 v238, v120, v121
    v_mfma_f32_16x16x32_bf16 v[148:151], a[216:219], v[56:59], v[148:151]
    s_mov_b32 s19, 0x40000000
    v_exp_f32 v122, v182
    v_mfma_f32_16x16x32_bf16 v[148:151], a[220:223], v[60:63], v[148:151]
    ds_read_b128 a[204:207], v103 offset:24576
    v_accvgpr_read_b32 v222, a86
    v_mfma_f32_16x16x32_bf16 v[152:155], a[208:211], v[64:67], v[24:27]
    s_mov_b32 s69, 0x3ff800
    v_exp_f32 v123, v183
    v_mfma_f32_16x16x32_bf16 v[152:155], a[212:215], v[68:71], v[152:155]
    v_cvt_pk_bf16_f32 v239, v122, v123
    v_accvgpr_read_b32 v223, a87
    v_mfma_f32_16x16x32_bf16 v[152:155], a[216:219], v[72:75], v[152:155]
    s_mov_b32 s68, 0
    v_cvt_pk_bf16_f32 v216, v216, v217
    v_cvt_pk_bf16_f32 v217, v218, v219
    v_mfma_f32_16x16x32_bf16 v[152:155], a[220:223], v[76:79], v[152:155]
    v_exp_f32 v116, v168
    v_mfma_f32_16x16x32_bf16 v[156:159], a[208:211], v[80:83], v[28:31]
    v_cvt_pk_bf16_f32 v218, v220, v221
    v_cvt_pk_bf16_f32 v219, v222, v223
    v_mfma_f32_16x16x32_bf16 v[156:159], a[212:215], v[84:87], v[156:159]
    s_add_u32 m0, s42, 106496
    v_exp_f32 v117, v169
    v_mfma_f32_16x16x32_bf16 v[156:159], a[216:219], v[88:91], v[156:159]
    v_cvt_pk_bf16_f32 v244, v116, v117
    v_pk_max_i16 v216, v216, 0
    v_mfma_f32_16x16x32_bf16 v[156:159], a[220:223], v[92:95], v[156:159]
    v_exp_f32 v118, v170
    buffer_load_dwordx4 v114, s[24:27], s50 offen offset:0 lds
    v_pk_max_i16 v217, v217, 0
    v_pk_max_i16 v218, v218, 0
    v_pk_max_i16 v219, v219, 0
    ds_read_b128 a[208:211], v100 offset:28672
    buffer_store_dwordx4 v[216:219], v115, s[28:31], s47 offen offset:1024 sc1
    v_accvgpr_read_b32 v208, a72
    v_accvgpr_read_b32 v209, a73
    v_accvgpr_read_b32 v210, a74
    v_exp_f32 v119, v171
    ds_read_b128 a[212:215], v101 offset:28672
    v_accvgpr_read_b32 v211, a75
    v_accvgpr_read_b32 v212, a88
    v_accvgpr_read_b32 v213, a89
    v_cvt_pk_bf16_f32 v245, v118, v119
    v_accvgpr_read_b32 v214, a90
    v_accvgpr_read_b32 v215, a91
    v_exp_f32 v120, v184
    buffer_load_dwordx4 v125, s[24:27], s50 offen offset:1024 lds
    v_cvt_pk_bf16_f32 v208, v208, v209
    v_cvt_pk_bf16_f32 v209, v210, v211
    s_add_u32 s50, s50, 8192
    v_cvt_pk_bf16_f32 v210, v212, v213
    v_cvt_pk_bf16_f32 v211, v214, v215
    v_pk_max_i16 v208, v208, 0
    v_exp_f32 v121, v185
    ds_read_b128 a[216:219], v102 offset:28672
    v_pk_max_i16 v209, v209, 0
    v_pk_max_i16 v210, v210, 0
    v_cvt_pk_bf16_f32 v246, v120, v121
    v_pk_max_i16 v211, v211, 0
    v_exp_f32 v122, v186
    ds_read_b128 a[220:223], v103 offset:28672
    buffer_store_dwordx4 v[208:211], v115, s[28:31], s47 offen offset:2048 sc1
    v_accvgpr_read_b32 v216, a76
    v_accvgpr_read_b32 v217, a77
    v_accvgpr_read_b32 v218, a78
    v_accvgpr_read_b32 v219, a79
    v_accvgpr_read_b32 v220, a92
    v_exp_f32 v123, v187
    v_accvgpr_read_b32 v221, a93
    v_accvgpr_read_b32 v222, a94
    v_cvt_pk_bf16_f32 v247, v122, v123
    v_accvgpr_read_b32 v223, a95
    v_cvt_pk_bf16_f32 v216, v216, v217
    v_cvt_pk_bf16_f32 v217, v218, v219
    v_exp_f32 v116, v172
    v_cvt_pk_bf16_f32 v218, v220, v221
    v_cvt_pk_bf16_f32 v219, v222, v223
    v_pk_max_i16 v216, v216, 0
    v_pk_max_i16 v217, v217, 0
    v_exp_f32 v117, v173
    v_pk_max_i16 v218, v218, 0
    v_pk_max_i16 v219, v219, 0
    v_cvt_pk_bf16_f32 v252, v116, v117
    buffer_store_dwordx4 v[216:219], v115, s[28:31], s47 offen offset:3072 sc1
    v_accvgpr_read_b32 v208, a96
    v_accvgpr_read_b32 v209, a97
    v_exp_f32 v118, v174
    ds_read_b64_tr_b16 a[224:225], v104 offset:0
    v_accvgpr_read_b32 v210, a98
    v_accvgpr_read_b32 v211, a99
    v_cvt_pk_bf16_f32 v208, v208, v209
    v_cvt_pk_bf16_f32 v209, v210, v211
    v_exp_f32 v119, v175
    ds_read_b64_tr_b16 a[226:227], v104 offset:4096
    v_pk_max_i16 v208, v208, 0
    v_pk_max_i16 v209, v209, 0
    v_cvt_pk_bf16_f32 v253, v118, v119
    buffer_store_dwordx2 v[208:209], v115, s[28:31], s48 offen offset:0 sc1
    v_accvgpr_read_b32 v216, a100
    v_accvgpr_read_b32 v217, a101
    v_exp_f32 v120, v188
    ds_read_b64_tr_b16 a[228:229], v104 offset:8192
    v_accvgpr_read_b32 v218, a102
    v_accvgpr_read_b32 v219, a103
    v_cvt_pk_bf16_f32 v216, v216, v217
    v_cvt_pk_bf16_f32 v217, v218, v219
    v_pk_max_i16 v216, v216, 0
    v_exp_f32 v121, v189
    ds_read_b64_tr_b16 a[230:231], v104 offset:12288
    v_pk_max_i16 v217, v217, 0
    v_cvt_pk_bf16_f32 v254, v120, v121
    buffer_store_dwordx2 v[216:217], v115, s[28:31], s48 offen offset:1024 sc1
    v_accvgpr_read_b32 v208, a104
    v_accvgpr_read_b32 v209, a105
    v_exp_f32 v122, v190
    ds_read_b64_tr_b16 a[232:233], v105 offset:0
    v_accvgpr_read_b32 v210, a106
    v_accvgpr_read_b32 v211, a107
    v_cvt_pk_bf16_f32 v208, v208, v209
    v_cvt_pk_bf16_f32 v209, v210, v211
    v_pk_max_i16 v208, v208, 0
    v_exp_f32 v123, v191
    ds_read_b64_tr_b16 a[234:235], v105 offset:4096
    v_pk_max_i16 v209, v209, 0
    v_cvt_pk_bf16_f32 v255, v122, v123
    buffer_store_dwordx2 v[208:209], v115, s[28:31], s48 offen offset:2048 sc1
    v_accvgpr_read_b32 v216, a108
    v_accvgpr_read_b32 v217, a109
    v_accvgpr_read_b32 v218, a110
    v_exp_f32 v116, v128
    v_accvgpr_read_b32 v219, a111
    v_cvt_pk_bf16_f32 v216, v216, v217
    v_cvt_pk_bf16_f32 v217, v218, v219
    v_pk_max_i16 v216, v216, 0
    v_exp_f32 v117, v129
    v_pk_max_i16 v217, v217, 0
    v_cvt_pk_bf16_f32 v192, v116, v117
    buffer_store_dwordx2 v[216:217], v115, s[28:31], s48 offen offset:3072 sc1
    v_exp_f32 v118, v130
    s_waitcnt lgkmcnt(6)
    v_mfma_f32_16x16x32_bf16 v[160:163], a[192:195], v[32:35], v[16:19]
    v_accvgpr_write_b32 a144, 0
    v_exp_f32 v119, v131
    v_mfma_f32_16x16x32_bf16 v[160:163], a[196:199], v[36:39], v[160:163]
    ds_read_b64_tr_b16 a[236:237], v105 offset:8192
    v_cvt_pk_bf16_f32 v193, v118, v119
    v_accvgpr_write_b32 a145, 0
    v_mfma_f32_16x16x32_bf16 v[160:163], a[200:203], v[40:43], v[160:163]
    s_add_u32 m0, s42, 0
    v_exp_f32 v120, v144
    v_mfma_f32_16x16x32_bf16 v[160:163], a[204:207], v[44:47], v[160:163]
    buffer_load_dwordx4 v112, s[20:23], s40 offen offset:0 lds
    v_mfma_f32_16x16x32_bf16 v[164:167], a[192:195], v[48:51], v[20:23]
    v_accvgpr_write_b32 a146, 0
    v_exp_f32 v121, v145
    v_mfma_f32_16x16x32_bf16 v[164:167], a[196:199], v[52:55], v[164:167]
    ds_read_b64_tr_b16 a[238:239], v105 offset:12288
    v_cvt_pk_bf16_f32 v194, v120, v121
    v_mfma_f32_16x16x32_bf16 v[164:167], a[200:203], v[56:59], v[164:167]
    v_exp_f32 v122, v146
    v_mfma_f32_16x16x32_bf16 v[164:167], a[204:207], v[60:63], v[164:167]
    buffer_load_dwordx4 v113, s[20:23], s40 offen offset:1024 lds
    v_mfma_f32_16x16x32_bf16 v[168:171], a[192:195], v[64:67], v[24:27]
    s_add_u32 s40, s40, 8192
    v_exp_f32 v123, v147
    v_mfma_f32_16x16x32_bf16 v[168:171], a[196:199], v[68:71], v[168:171]
    s_bitcmp0_b32 s2, 0
    ds_read_b64_tr_b16 a[240:241], v106 offset:0
    v_cvt_pk_bf16_f32 v195, v122, v123
    v_mfma_f32_16x16x32_bf16 v[168:171], a[200:203], v[72:75], v[168:171]
    s_cselect_b64 s[4:5], -1, 0
    v_exp_f32 v116, v132
    v_mfma_f32_16x16x32_bf16 v[168:171], a[204:207], v[76:79], v[168:171]
    s_cselect_b32 s41, 1, 0
    ds_read_b64_tr_b16 a[242:243], v106 offset:4096
    v_accvgpr_write_b32 a147, 0
    v_mfma_f32_16x16x32_bf16 v[172:175], a[192:195], v[80:83], v[28:31]
    s_cselect_b32 s18, s101, s19
    v_exp_f32 v117, v133
    v_mfma_f32_16x16x32_bf16 v[172:175], a[196:199], v[84:87], v[172:175]
    s_cselect_b32 s12, s62, s64
    ds_read_b64_tr_b16 a[244:245], v106 offset:8192
    v_cvt_pk_bf16_f32 v200, v116, v117
    v_mfma_f32_16x16x32_bf16 v[172:175], a[200:203], v[88:91], v[172:175]
    s_cselect_b32 s13, s63, s65
    v_exp_f32 v118, v134
    v_mfma_f32_16x16x32_bf16 v[172:175], a[204:207], v[92:95], v[172:175]
    ds_read_b64_tr_b16 a[246:247], v106 offset:12288
    v_accvgpr_write_b32 a148, 0
    v_accvgpr_write_b32 a149, 0
    v_mfma_f32_16x16x32_bf16 v[176:179], a[208:211], v[32:35], v[16:19]
    v_cndmask_b32 v3, v6, v3, s[4:5]
    v_exp_f32 v119, v135
    v_mfma_f32_16x16x32_bf16 v[176:179], a[212:215], v[36:39], v[176:179]
    s_cselect_b32 s100, s7, s19
    ds_read_b64_tr_b16 a[248:249], v107 offset:0
    v_cvt_pk_bf16_f32 v201, v118, v119
    v_mfma_f32_16x16x32_bf16 v[176:179], a[216:219], v[40:43], v[176:179]
    s_cselect_b32 s47, s38, s19
    v_exp_f32 v120, v148
    v_mfma_f32_16x16x32_bf16 v[176:179], a[220:223], v[44:47], v[176:179]
    s_cselect_b32 s10, 0, 0x10000000
    ds_read_b64_tr_b16 a[250:251], v107 offset:4096
    v_accvgpr_write_b32 a150, 0
    v_mfma_f32_16x16x32_bf16 v[180:183], a[208:211], v[48:51], v[20:23]
    s_cselect_b32 s14, s86, s90
    v_exp_f32 v121, v149
    v_mfma_f32_16x16x32_bf16 v[180:183], a[212:215], v[52:55], v[180:183]
    s_cselect_b32 s4, 16, 14
    ds_read_b64_tr_b16 a[252:253], v107 offset:8192
    v_cvt_pk_bf16_f32 v202, v120, v121
    v_mfma_f32_16x16x32_bf16 v[180:183], a[216:219], v[56:59], v[180:183]
    s_cselect_b32 s5, 0x11ff800, s69
    v_exp_f32 v122, v150
    v_mfma_f32_16x16x32_bf16 v[180:183], a[220:223], v[60:63], v[180:183]
    s_cselect_b32 s7, 0, 28
    ds_read_b64_tr_b16 a[254:255], v107 offset:12288
    v_accvgpr_write_b32 a151, 0
    v_mfma_f32_16x16x32_bf16 v[184:187], a[208:211], v[64:67], v[24:27]
    v_exp_f32 v123, v151
    v_mfma_f32_16x16x32_bf16 v[184:187], a[212:215], v[68:71], v[184:187]
    v_cvt_pk_bf16_f32 v203, v122, v123
    v_mfma_f32_16x16x32_bf16 v[184:187], a[216:219], v[72:75], v[184:187]
    s_waitcnt vmcnt(26)
    s_barrier
    v_mfma_f32_16x16x32_bf16 v[184:187], a[220:223], v[76:79], v[184:187]
    v_exp_f32 v116, v136
    v_mfma_f32_16x16x32_bf16 v[188:191], a[208:211], v[80:83], v[28:31]
    ds_read_b128 a[192:195], v100 offset:32768
    v_mfma_f32_16x16x32_bf16 v[188:191], a[212:215], v[84:87], v[188:191]
    s_add_u32 m0, s42, 114688
    v_exp_f32 v117, v137
    v_mfma_f32_16x16x32_bf16 v[188:191], a[216:219], v[88:91], v[188:191]
    ds_read_b128 a[196:199], v101 offset:32768
    v_cvt_pk_bf16_f32 v208, v116, v117
    v_mfma_f32_16x16x32_bf16 v[188:191], a[220:223], v[92:95], v[188:191]
    v_exp_f32 v118, v138
    v_smfmac_f32_16x16x64_bf16 a[144:147], a[160:163], v[224:231], v0
    s_waitcnt lgkmcnt(10)
    ds_read_b128 a[200:203], v102 offset:32768
    v_smfmac_f32_16x16x64_bf16 a[148:151], a[160:163], v[232:239], v0
    ds_read_b128 a[204:207], v103 offset:32768
    v_mfma_f32_16x16x32_bf16 a[0:3], a[224:227], v[224:227], 0
    v_exp_f32 v119, v139
    v_mfma_f32_16x16x32_bf16 a[0:3], a[228:231], v[228:231], a[0:3]
    ds_read_b128 a[208:211], v100 offset:36864
    v_cvt_pk_bf16_f32 v209, v118, v119
    v_mfma_f32_16x16x32_bf16 a[4:7], a[224:227], v[232:235], 0
    v_exp_f32 v120, v152
    v_mfma_f32_16x16x32_bf16 a[4:7], a[228:231], v[236:239], a[4:7]
    buffer_load_dwordx4 v114, s[24:27], s50 offen offset:0 lds
    v_mfma_f32_16x16x32_bf16 a[8:11], a[224:227], v[240:243], 0
    v_exp_f32 v121, v153
    v_mfma_f32_16x16x32_bf16 a[8:11], a[228:231], v[244:247], a[8:11]
    ds_read_b128 a[212:215], v101 offset:36864
    v_cvt_pk_bf16_f32 v210, v120, v121
    v_mfma_f32_16x16x32_bf16 a[12:15], a[224:227], v[248:251], 0
    v_exp_f32 v122, v154
    v_mfma_f32_16x16x32_bf16 a[12:15], a[228:231], v[252:255], a[12:15]
    buffer_load_dwordx4 v125, s[24:27], s50 offen offset:1024 lds
    v_mfma_f32_16x16x32_bf16 a[16:19], a[232:235], v[224:227], 0
    s_add_u32 s50, s50, 8192
    v_exp_f32 v123, v155
    v_mfma_f32_16x16x32_bf16 a[16:19], a[236:239], v[228:231], a[16:19]
    ds_read_b128 a[216:219], v102 offset:36864
    v_cvt_pk_bf16_f32 v211, v122, v123
    v_mfma_f32_16x16x32_bf16 a[20:23], a[232:235], v[232:235], 0
    v_exp_f32 v116, v140
    v_mfma_f32_16x16x32_bf16 a[20:23], a[236:239], v[236:239], a[20:23]
    ds_read_b128 a[220:223], v103 offset:36864
    v_mfma_f32_16x16x32_bf16 a[24:27], a[232:235], v[240:243], 0
    v_exp_f32 v117, v141
    v_mfma_f32_16x16x32_bf16 a[24:27], a[236:239], v[244:247], a[24:27]
    s_waitcnt lgkmcnt(8)
    v_cvt_pk_bf16_f32 v216, v116, v117
    v_mfma_f32_16x16x32_bf16 a[28:31], a[232:235], v[248:251], 0
    v_exp_f32 v118, v142
    v_mfma_f32_16x16x32_bf16 a[28:31], a[236:239], v[252:255], a[28:31]
    ds_read_b64_tr_b16 a[224:225], v108 offset:0
    v_mfma_f32_16x16x32_bf16 a[32:35], a[240:243], v[224:227], 0
    v_exp_f32 v119, v143
    v_mfma_f32_16x16x32_bf16 a[32:35], a[244:247], v[228:231], a[32:35]
    ds_read_b64_tr_b16 a[226:227], v108 offset:4096
    v_cvt_pk_bf16_f32 v217, v118, v119
    v_mfma_f32_16x16x32_bf16 a[36:39], a[240:243], v[232:235], 0
    v_exp_f32 v120, v156
    v_mfma_f32_16x16x32_bf16 a[36:39], a[244:247], v[236:239], a[36:39]
    ds_read_b64_tr_b16 a[228:229], v108 offset:8192
    v_mfma_f32_16x16x32_bf16 a[40:43], a[240:243], v[240:243], 0
    v_exp_f32 v121, v157
    v_mfma_f32_16x16x32_bf16 a[40:43], a[244:247], v[244:247], a[40:43]
    ds_read_b64_tr_b16 a[230:231], v108 offset:12288
    v_cvt_pk_bf16_f32 v218, v120, v121
    v_mfma_f32_16x16x32_bf16 a[44:47], a[240:243], v[248:251], 0
    v_exp_f32 v122, v158
    v_mfma_f32_16x16x32_bf16 a[44:47], a[244:247], v[252:255], a[44:47]
    ds_read_b64_tr_b16 a[232:233], v109 offset:0
    v_mfma_f32_16x16x32_bf16 a[48:51], a[248:251], v[224:227], 0
    v_exp_f32 v123, v159
    v_mfma_f32_16x16x32_bf16 a[48:51], a[252:255], v[228:231], a[48:51]
    ds_read_b64_tr_b16 a[234:235], v109 offset:4096
    v_cvt_pk_bf16_f32 v219, v122, v123
    v_mfma_f32_16x16x32_bf16 a[52:55], a[248:251], v[232:235], 0
    v_exp_f32 v116, v160
    v_mfma_f32_16x16x32_bf16 a[52:55], a[252:255], v[236:239], a[52:55]
    v_mfma_f32_16x16x32_bf16 a[56:59], a[248:251], v[240:243], 0
    v_exp_f32 v117, v161
    v_mfma_f32_16x16x32_bf16 a[56:59], a[252:255], v[244:247], a[56:59]
    v_cvt_pk_bf16_f32 v196, v116, v117
    v_mfma_f32_16x16x32_bf16 a[60:63], a[248:251], v[248:251], 0
    s_waitcnt lgkmcnt(6)
    v_exp_f32 v118, v162
    v_mfma_f32_16x16x32_bf16 a[60:63], a[252:255], v[252:255], a[60:63]
    v_mfma_f32_16x16x32_bf16 v[128:131], a[192:195], v[32:35], v[16:19]
    s_mul_i32 s4, s4, s17
    v_accvgpr_write_b32 a152, 0
    v_exp_f32 v119, v163
    v_mfma_f32_16x16x32_bf16 v[128:131], a[196:199], v[36:39], v[128:131]
    s_lshl_b32 s4, s4, 16
    ds_read_b64_tr_b16 a[236:237], v109 offset:8192
    v_cvt_pk_bf16_f32 v197, v118, v119
    v_accvgpr_write_b32 a153, 0
    v_mfma_f32_16x16x32_bf16 v[128:131], a[200:203], v[40:43], v[128:131]
    s_add_u32 m0, s42, 8192
    v_exp_f32 v120, v176
    v_mfma_f32_16x16x32_bf16 v[128:131], a[204:207], v[44:47], v[128:131]
    buffer_load_dwordx4 v112, s[20:23], s40 offen offset:0 lds
    v_mfma_f32_16x16x32_bf16 v[132:135], a[192:195], v[48:51], v[20:23]
    s_add_u32 s69, s4, s5
    v_accvgpr_write_b32 a154, 0
    v_exp_f32 v121, v177
    v_mfma_f32_16x16x32_bf16 v[132:135], a[196:199], v[52:55], v[132:135]
    ds_read_b64_tr_b16 a[238:239], v109 offset:12288
    v_cvt_pk_bf16_f32 v198, v120, v121
    v_mfma_f32_16x16x32_bf16 v[132:135], a[200:203], v[56:59], v[132:135]
    s_and_b32 s13, s13, 0xffff
    v_exp_f32 v122, v178
    v_mfma_f32_16x16x32_bf16 v[132:135], a[204:207], v[60:63], v[132:135]
    buffer_load_dwordx4 v113, s[20:23], s40 offen offset:1024 lds
    v_mfma_f32_16x16x32_bf16 v[136:139], a[192:195], v[64:67], v[24:27]
    s_add_u32 s40, s40, 8192
    v_exp_f32 v123, v179
    v_mfma_f32_16x16x32_bf16 v[136:139], a[196:199], v[68:71], v[136:139]
    s_lshl_b32 s5, s69, 3
    ds_read_b64_tr_b16 a[240:241], v110 offset:0
    v_cvt_pk_bf16_f32 v199, v122, v123
    v_mfma_f32_16x16x32_bf16 v[136:139], a[200:203], v[72:75], v[136:139]
    v_exp_f32 v116, v164
    v_mfma_f32_16x16x32_bf16 v[136:139], a[204:207], v[76:79], v[136:139]
    ds_read_b64_tr_b16 a[242:243], v110 offset:4096
    v_accvgpr_write_b32 a155, 0
    v_mfma_f32_16x16x32_bf16 v[140:143], a[192:195], v[80:83], v[28:31]
    v_exp_f32 v117, v165
    v_mfma_f32_16x16x32_bf16 v[140:143], a[196:199], v[84:87], v[140:143]
    s_sub_u32 s35, s6, s5
    ds_read_b64_tr_b16 a[244:245], v110 offset:8192
    v_cvt_pk_bf16_f32 v204, v116, v117
    v_mfma_f32_16x16x32_bf16 v[140:143], a[200:203], v[88:91], v[140:143]
    v_exp_f32 v118, v166
    v_mfma_f32_16x16x32_bf16 v[140:143], a[204:207], v[92:95], v[140:143]
    ds_read_b64_tr_b16 a[246:247], v110 offset:12288
    v_accvgpr_write_b32 a156, 0
    v_accvgpr_write_b32 a157, 0
    v_mfma_f32_16x16x32_bf16 v[144:147], a[208:211], v[32:35], v[16:19]
    s_lshr_b32 s5, s3, 1
    v_exp_f32 v119, v167
    v_mfma_f32_16x16x32_bf16 v[144:147], a[212:215], v[36:39], v[144:147]
    ds_read_b64_tr_b16 a[248:249], v111 offset:0
    v_cvt_pk_bf16_f32 v205, v118, v119
    v_mfma_f32_16x16x32_bf16 v[144:147], a[216:219], v[40:43], v[144:147]
    v_exp_f32 v120, v180
    v_mfma_f32_16x16x32_bf16 v[144:147], a[220:223], v[44:47], v[144:147]
    s_lshl1_add_u32 s5, s17, s5
    ds_read_b64_tr_b16 a[250:251], v111 offset:4096
    v_accvgpr_write_b32 a158, 0
    v_mfma_f32_16x16x32_bf16 v[148:151], a[208:211], v[48:51], v[20:23]
    v_exp_f32 v121, v181
    v_mfma_f32_16x16x32_bf16 v[148:151], a[212:215], v[52:55], v[148:151]
    ds_read_b64_tr_b16 a[252:253], v111 offset:8192
    v_cvt_pk_bf16_f32 v206, v120, v121
    v_mfma_f32_16x16x32_bf16 v[148:151], a[216:219], v[56:59], v[148:151]
    s_lshl_b32 s5, s5, 8
    v_exp_f32 v122, v182
    v_mfma_f32_16x16x32_bf16 v[148:151], a[220:223], v[60:63], v[148:151]
    ds_read_b64_tr_b16 a[254:255], v111 offset:12288
    v_accvgpr_write_b32 a159, 0
    v_mfma_f32_16x16x32_bf16 v[152:155], a[208:211], v[64:67], v[24:27]
    v_exp_f32 v123, v183
    v_mfma_f32_16x16x32_bf16 v[152:155], a[212:215], v[68:71], v[152:155]
    ds_read_b128 a[192:195], v100 offset:40960
    v_cvt_pk_bf16_f32 v207, v122, v123
    v_mfma_f32_16x16x32_bf16 v[152:155], a[216:219], v[72:75], v[152:155]
    s_add_u32 s46, s5, 0x10000
    ds_read_b128 a[196:199], v101 offset:40960
    v_mfma_f32_16x16x32_bf16 v[152:155], a[220:223], v[76:79], v[152:155]
    v_exp_f32 v116, v168
    v_mfma_f32_16x16x32_bf16 v[156:159], a[208:211], v[80:83], v[28:31]
    ds_read_b128 a[200:203], v102 offset:40960
    v_mfma_f32_16x16x32_bf16 v[156:159], a[212:215], v[84:87], v[156:159]
    s_add_u32 m0, s42, 122880
    v_exp_f32 v117, v169
    v_mfma_f32_16x16x32_bf16 v[156:159], a[216:219], v[88:91], v[156:159]
    ds_read_b128 a[204:207], v103 offset:40960
    v_cvt_pk_bf16_f32 v212, v116, v117
    v_mfma_f32_16x16x32_bf16 v[156:159], a[220:223], v[92:95], v[156:159]
    v_exp_f32 v118, v170
    v_smfmac_f32_16x16x64_bf16 a[152:155], a[160:163], v[240:247], v0
    s_waitcnt lgkmcnt(12)
    ds_read_b128 a[208:211], v100 offset:45056
    v_cmp_gt_u32 vcc, s7, v6
    v_smfmac_f32_16x16x64_bf16 a[156:159], a[160:163], v[248:255], v0
    ds_read_b128 a[212:215], v101 offset:45056
    v_mov_b32 v12, 0x10001
    v_mfma_f32_16x16x32_bf16 a[64:67], a[224:227], v[224:227], 0
    v_exp_f32 v119, v171
    v_mfma_f32_16x16x32_bf16 a[64:67], a[228:231], v[228:231], a[64:67]
    ds_read_b128 a[216:219], v102 offset:45056
    v_cvt_pk_bf16_f32 v213, v118, v119
    v_lshrrev_b32 v8, 1, v6
    v_mfma_f32_16x16x32_bf16 a[68:71], a[224:227], v[232:235], 0
    v_exp_f32 v120, v184
    v_mfma_f32_16x16x32_bf16 a[68:71], a[228:231], v[236:239], a[68:71]
    buffer_load_dwordx4 v114, s[24:27], s50 offen offset:0 lds
    v_mfma_f32_16x16x32_bf16 a[72:75], a[224:227], v[240:243], 0
    v_cndmask_b32 v12, v12, 0, vcc
    v_exp_f32 v121, v185
    v_mfma_f32_16x16x32_bf16 a[72:75], a[228:231], v[244:247], a[72:75]
    ds_read_b128 a[220:223], v103 offset:45056
    v_cvt_pk_bf16_f32 v214, v120, v121
    v_mfma_f32_16x16x32_bf16 a[76:79], a[224:227], v[248:251], 0
    v_exp_f32 v122, v186
    v_mfma_f32_16x16x32_bf16 a[76:79], a[228:231], v[252:255], a[76:79]
    buffer_load_dwordx4 v125, s[24:27], s50 offen offset:1024 lds
    v_mfma_f32_16x16x32_bf16 a[80:83], a[232:235], v[224:227], 0
    s_add_u32 s50, s50, 8192
    v_exp_f32 v123, v187
    v_mfma_f32_16x16x32_bf16 a[80:83], a[236:239], v[228:231], a[80:83]
    v_cvt_pk_bf16_f32 v215, v122, v123
    v_lshlrev_b32 v8, 2, v8
    v_mfma_f32_16x16x32_bf16 a[84:87], a[232:235], v[232:235], 0
    v_exp_f32 v116, v172
    v_mfma_f32_16x16x32_bf16 a[84:87], a[236:239], v[236:239], a[84:87]
    ds_bpermute_b32 v8, v8, v3
    v_mfma_f32_16x16x32_bf16 a[88:91], a[232:235], v[240:243], 0
    v_exp_f32 v117, v173
    v_mfma_f32_16x16x32_bf16 a[88:91], a[236:239], v[244:247], a[88:91]
    s_waitcnt lgkmcnt(9)
    v_cvt_pk_bf16_f32 v220, v116, v117
    v_mfma_f32_16x16x32_bf16 a[92:95], a[232:235], v[248:251], 0
    v_exp_f32 v118, v174
    v_mfma_f32_16x16x32_bf16 a[92:95], a[236:239], v[252:255], a[92:95]
    ds_read_b64_tr_b16 a[224:225], v104 offset:16384
    v_lshlrev_b32 v3, 16, v3
    v_mfma_f32_16x16x32_bf16 a[96:99], a[240:243], v[224:227], 0
    v_exp_f32 v119, v175
    v_mfma_f32_16x16x32_bf16 a[96:99], a[244:247], v[228:231], a[96:99]
    ds_read_b64_tr_b16 a[226:227], v104 offset:20480
    v_cvt_pk_bf16_f32 v221, v118, v119
    v_mfma_f32_16x16x32_bf16 a[100:103], a[240:243], v[232:235], 0
    v_exp_f32 v120, v188
    v_mfma_f32_16x16x32_bf16 a[100:103], a[244:247], v[236:239], a[100:103]
    ds_read_b64_tr_b16 a[228:229], v104 offset:24576
    v_add_u32 v3, s69, v3
    v_mfma_f32_16x16x32_bf16 a[104:107], a[240:243], v[240:243], 0
    v_exp_f32 v121, v189
    v_mfma_f32_16x16x32_bf16 a[104:107], a[244:247], v[244:247], a[104:107]
    ds_read_b64_tr_b16 a[230:231], v104 offset:28672
    v_cvt_pk_bf16_f32 v222, v120, v121
    v_mfma_f32_16x16x32_bf16 a[108:111], a[240:243], v[248:251], 0
    v_exp_f32 v122, v190
    v_mfma_f32_16x16x32_bf16 a[108:111], a[244:247], v[252:255], a[108:111]
    ds_read_b64_tr_b16 a[232:233], v105 offset:16384
    v_mfma_f32_16x16x32_bf16 a[112:115], a[248:251], v[224:227], 0
    v_exp_f32 v123, v191
    v_mfma_f32_16x16x32_bf16 a[112:115], a[252:255], v[228:231], a[112:115]
    ds_read_b64_tr_b16 a[234:235], v105 offset:20480
    v_cvt_pk_bf16_f32 v223, v122, v123
    v_mfma_f32_16x16x32_bf16 a[116:119], a[248:251], v[232:235], 0
    v_exp_f32 v116, v128
    v_mfma_f32_16x16x32_bf16 a[116:119], a[252:255], v[236:239], a[116:119]
    v_mfma_f32_16x16x32_bf16 a[120:123], a[248:251], v[240:243], 0
    v_exp_f32 v117, v129
    v_mfma_f32_16x16x32_bf16 a[120:123], a[252:255], v[244:247], a[120:123]
    v_cvt_pk_bf16_f32 v224, v116, v117
    v_mfma_f32_16x16x32_bf16 a[124:127], a[248:251], v[248:251], 0
    s_waitcnt lgkmcnt(7)
    v_exp_f32 v118, v130
    v_mfma_f32_16x16x32_bf16 a[124:127], a[252:255], v[252:255], a[124:127]
    s_mov_b32 s39, 0
.p2align 6
L_att:
    v_mfma_f32_16x16x32_bf16 v[160:163], a[192:195], v[32:35], v[16:19]
    v_exp_f32 v119, v131
    v_mfma_f32_16x16x32_bf16 v[160:163], a[196:199], v[36:39], v[160:163]
    ds_read_b64_tr_b16 a[236:237], v105 offset:24576
    v_cvt_pk_bf16_f32 v225, v118, v119
    v_mfma_f32_16x16x32_bf16 v[160:163], a[200:203], v[40:43], v[160:163]
    s_add_u32 m0, s42, 16384
    v_exp_f32 v120, v144
    v_mfma_f32_16x16x32_bf16 v[160:163], a[204:207], v[44:47], v[160:163]
    buffer_load_dwordx4 v112, s[20:23], s40 offen offset:0 lds
    v_mfma_f32_16x16x32_bf16 v[164:167], a[192:195], v[48:51], v[20:23]
    v_exp_f32 v121, v145
    v_mfma_f32_16x16x32_bf16 v[164:167], a[196:199], v[52:55], v[164:167]
    ds_read_b64_tr_b16 a[238:239], v105 offset:28672
    v_cvt_pk_bf16_f32 v226, v120, v121
    v_mfma_f32_16x16x32_bf16 v[164:167], a[200:203], v[56:59], v[164:167]
    v_exp_f32 v122, v146
    v_mfma_f32_16x16x32_bf16 v[164:167], a[204:207], v[60:63], v[164:167]
    buffer_load_dwordx4 v113, s[20:23], s40 offen offset:1024 lds
    v_mfma_f32_16x16x32_bf16 v[168:171], a[192:195], v[64:67], v[24:27]
    s_add_u32 s40, s40, 8192
    v_exp_f32 v123, v147
    v_mfma_f32_16x16x32_bf16 v[168:171], a[196:199], v[68:71], v[168:171]
    ds_read_b64_tr_b16 a[240:241], v106 offset:16384
    v_cvt_pk_bf16_f32 v227, v122, v123
    v_mfma_f32_16x16x32_bf16 v[168:171], a[200:203], v[72:75], v[168:171]
    v_exp_f32 v116, v132
    v_mfma_f32_16x16x32_bf16 v[168:171], a[204:207], v[76:79], v[168:171]
    ds_read_b64_tr_b16 a[242:243], v106 offset:20480
    v_mfma_f32_16x16x32_bf16 v[172:175], a[192:195], v[80:83], v[28:31]
    v_exp_f32 v117, v133
    v_mfma_f32_16x16x32_bf16 v[172:175], a[196:199], v[84:87], v[172:175]
    ds_read_b64_tr_b16 a[244:245], v106 offset:24576
    v_cvt_pk_bf16_f32 v232, v116, v117
    v_mfma_f32_16x16x32_bf16 v[172:175], a[200:203], v[88:91], v[172:175]
    v_exp_f32 v118, v134
    v_mfma_f32_16x16x32_bf16 v[172:175], a[204:207], v[92:95], v[172:175]
    ds_read_b64_tr_b16 a[246:247], v106 offset:28672
    v_mfma_f32_16x16x32_bf16 v[176:179], a[208:211], v[32:35], v[16:19]
    v_exp_f32 v119, v135
    v_mfma_f32_16x16x32_bf16 v[176:179], a[212:215], v[36:39], v[176:179]
    ds_read_b64_tr_b16 a[248:249], v107 offset:16384
    v_cvt_pk_bf16_f32 v233, v118, v119
    v_mfma_f32_16x16x32_bf16 v[176:179], a[216:219], v[40:43], v[176:179]
    v_exp_f32 v120, v148
    v_mfma_f32_16x16x32_bf16 v[176:179], a[220:223], v[44:47], v[176:179]
    ds_read_b64_tr_b16 a[250:251], v107 offset:20480
    v_mfma_f32_16x16x32_bf16 v[180:183], a[208:211], v[48:51], v[20:23]
    v_exp_f32 v121, v149
    v_mfma_f32_16x16x32_bf16 v[180:183], a[212:215], v[52:55], v[180:183]
    ds_read_b64_tr_b16 a[252:253], v107 offset:24576
    v_cvt_pk_bf16_f32 v234, v120, v121
    v_mfma_f32_16x16x32_bf16 v[180:183], a[216:219], v[56:59], v[180:183]
    v_exp_f32 v122, v150
    v_mfma_f32_16x16x32_bf16 v[180:183], a[220:223], v[60:63], v[180:183]
    ds_read_b64_tr_b16 a[254:255], v107 offset:28672
    v_mfma_f32_16x16x32_bf16 v[184:187], a[208:211], v[64:67], v[24:27]
    v_exp_f32 v123, v151
    v_mfma_f32_16x16x32_bf16 v[184:187], a[212:215], v[68:71], v[184:187]
    v_cvt_pk_bf16_f32 v235, v122, v123
    v_mfma_f32_16x16x32_bf16 v[184:187], a[216:219], v[72:75], v[184:187]
    s_waitcnt vmcnt(12)
    s_barrier
    v_mfma_f32_16x16x32_bf16 v[184:187], a[220:223], v[76:79], v[184:187]
    v_exp_f32 v116, v136
    v_mfma_f32_16x16x32_bf16 v[188:191], a[208:211], v[80:83], v[28:31]
    ds_read_b128 a[192:195], v100 offset:49152
    v_mfma_f32_16x16x32_bf16 v[188:191], a[212:215], v[84:87], v[188:191]
    s_add_u32 m0, s42, 65536
    v_exp_f32 v117, v137
    v_mfma_f32_16x16x32_bf16 v[188:191], a[216:219], v[88:91], v[188:191]
    ds_read_b128 a[196:199], v101 offset:49152
    v_cvt_pk_bf16_f32 v240, v116, v117
    v_mfma_f32_16x16x32_bf16 v[188:191], a[220:223], v[92:95], v[188:191]
    v_exp_f32 v118, v138
    v_smfmac_f32_16x16x64_bf16 a[144:147], a[160:163], v[192:199], v0
    s_waitcnt lgkmcnt(10)
    ds_read_b128 a[200:203], v102 offset:49152
    v_smfmac_f32_16x16x64_bf16 a[148:151], a[160:163], v[200:207], v0
    ds_read_b128 a[204:207], v103 offset:49152
    v_mfma_f32_16x16x32_bf16 a[0:3], a[224:227], v[192:195], a[0:3]
    v_exp_f32 v119, v139
    v_mfma_f32_16x16x32_bf16 a[0:3], a[228:231], v[196:199], a[0:3]
    ds_read_b128 a[208:211], v100 offset:53248
    v_cvt_pk_bf16_f32 v241, v118, v119
    v_mfma_f32_16x16x32_bf16 a[4:7], a[224:227], v[200:203], a[4:7]
    v_exp_f32 v120, v152
    v_mfma_f32_16x16x32_bf16 a[4:7], a[228:231], v[204:207], a[4:7]
    buffer_load_dwordx4 v114, s[24:27], s50 offen offset:0 lds
    v_mfma_f32_16x16x32_bf16 a[8:11], a[224:227], v[208:211], a[8:11]
    v_exp_f32 v121, v153
    v_mfma_f32_16x16x32_bf16 a[8:11], a[228:231], v[212:215], a[8:11]
    ds_read_b128 a[212:215], v101 offset:53248
    v_cvt_pk_bf16_f32 v242, v120, v121
    v_mfma_f32_16x16x32_bf16 a[12:15], a[224:227], v[216:219], a[12:15]
    v_exp_f32 v122, v154
    v_mfma_f32_16x16x32_bf16 a[12:15], a[228:231], v[220:223], a[12:15]
    buffer_load_dwordx4 v125, s[24:27], s50 offen offset:1024 lds
    v_mfma_f32_16x16x32_bf16 a[16:19], a[232:235], v[192:195], a[16:19]
    s_add_u32 s50, s50, 8192
    v_exp_f32 v123, v155
    v_mfma_f32_16x16x32_bf16 a[16:19], a[236:239], v[196:199], a[16:19]
    ds_read_b128 a[216:219], v102 offset:53248
    v_cvt_pk_bf16_f32 v243, v122, v123
    v_mfma_f32_16x16x32_bf16 a[20:23], a[232:235], v[200:203], a[20:23]
    v_exp_f32 v116, v140
    v_mfma_f32_16x16x32_bf16 a[20:23], a[236:239], v[204:207], a[20:23]
    ds_read_b128 a[220:223], v103 offset:53248
    v_mfma_f32_16x16x32_bf16 a[24:27], a[232:235], v[208:211], a[24:27]
    v_exp_f32 v117, v141
    v_mfma_f32_16x16x32_bf16 a[24:27], a[236:239], v[212:215], a[24:27]
    s_waitcnt lgkmcnt(8)
    v_cvt_pk_bf16_f32 v248, v116, v117
    v_mfma_f32_16x16x32_bf16 a[28:31], a[232:235], v[216:219], a[28:31]
    v_exp_f32 v118, v142
    v_mfma_f32_16x16x32_bf16 a[28:31], a[236:239], v[220:223], a[28:31]
    ds_read_b64_tr_b16 a[224:225], v108 offset:16384
    v_mfma_f32_16x16x32_bf16 a[32:35], a[240:243], v[192:195], a[32:35]
    v_exp_f32 v119, v143
    v_mfma_f32_16x16x32_bf16 a[32:35], a[244:247], v[196:199], a[32:35]
    ds_read_b64_tr_b16 a[226:227], v108 offset:20480
    v_cvt_pk_bf16_f32 v249, v118, v119
    v_mfma_f32_16x16x32_bf16 a[36:39], a[240:243], v[200:203], a[36:39]
    v_exp_f32 v120, v156
    v_mfma_f32_16x16x32_bf16 a[36:39], a[244:247], v[204:207], a[36:39]
    buffer_load_dword v15, v115, s[84:87], s66 offen
    v_mfma_f32_16x16x32_bf16 a[40:43], a[240:243], v[208:211], a[40:43]
    s_add_u32 s66, s66, 640
    v_exp_f32 v121, v157
    v_mfma_f32_16x16x32_bf16 a[40:43], a[244:247], v[212:215], a[40:43]
    ds_read_b64_tr_b16 a[228:229], v108 offset:24576
    v_cvt_pk_bf16_f32 v250, v120, v121
    v_mfma_f32_16x16x32_bf16 a[44:47], a[240:243], v[216:219], a[44:47]
    v_exp_f32 v122, v158
    v_mfma_f32_16x16x32_bf16 a[44:47], a[244:247], v[220:223], a[44:47]
    ds_read_b64_tr_b16 a[230:231], v108 offset:28672
    v_mfma_f32_16x16x32_bf16 a[48:51], a[248:251], v[192:195], a[48:51]
    v_exp_f32 v123, v159
    v_mfma_f32_16x16x32_bf16 a[48:51], a[252:255], v[196:199], a[48:51]
    ds_read_b64_tr_b16 a[232:233], v109 offset:16384
    v_cvt_pk_bf16_f32 v251, v122, v123
    v_mfma_f32_16x16x32_bf16 a[52:55], a[248:251], v[200:203], a[52:55]
    v_exp_f32 v116, v160
    v_mfma_f32_16x16x32_bf16 a[52:55], a[252:255], v[204:207], a[52:55]
    ds_read_b64_tr_b16 a[234:235], v109 offset:20480
    v_mfma_f32_16x16x32_bf16 a[56:59], a[248:251], v[208:211], a[56:59]
    v_exp_f32 v117, v161
    v_mfma_f32_16x16x32_bf16 a[56:59], a[252:255], v[212:215], a[56:59]
    v_cvt_pk_bf16_f32 v228, v116, v117
    v_mfma_f32_16x16x32_bf16 a[60:63], a[248:251], v[216:219], a[60:63]
    s_waitcnt lgkmcnt(6)
    v_exp_f32 v118, v162
    v_mfma_f32_16x16x32_bf16 a[60:63], a[252:255], v[220:223], a[60:63]
    v_mfma_f32_16x16x32_bf16 v[128:131], a[192:195], v[32:35], v[16:19]
    v_exp_f32 v119, v163
    v_mfma_f32_16x16x32_bf16 v[128:131], a[196:199], v[36:39], v[128:131]
    ds_read_b64_tr_b16 a[236:237], v109 offset:24576
    v_cvt_pk_bf16_f32 v229, v118, v119
    v_mfma_f32_16x16x32_bf16 v[128:131], a[200:203], v[40:43], v[128:131]
    s_add_u32 m0, s42, 24576
    v_exp_f32 v120, v176
    v_mfma_f32_16x16x32_bf16 v[128:131], a[204:207], v[44:47], v[128:131]
    buffer_load_dwordx4 v112, s[20:23], s40 offen offset:0 lds
    v_mfma_f32_16x16x32_bf16 v[132:135], a[192:195], v[48:51], v[20:23]
    v_exp_f32 v121, v177
    v_mfma_f32_16x16x32_bf16 v[132:135], a[196:199], v[52:55], v[132:135]
    ds_read_b64_tr_b16 a[238:239], v109 offset:28672
    v_cvt_pk_bf16_f32 v230, v120, v121
    v_mfma_f32_16x16x32_bf16 v[132:135], a[200:203], v[56:59], v[132:135]
    v_exp_f32 v122, v178
    v_mfma_f32_16x16x32_bf16 v[132:135], a[204:207], v[60:63], v[132:135]
    buffer_load_dwordx4 v113, s[20:23], s40 offen offset:1024 lds
    v_mfma_f32_16x16x32_bf16 v[136:139], a[192:195], v[64:67], v[24:27]
    s_add_u32 s40, s40, 8192
    v_exp_f32 v123, v179
    v_mfma_f32_16x16x32_bf16 v[136:139], a[196:199], v[68:71], v[136:139]
    ds_read_b64_tr_b16 a[240:241], v110 offset:16384
    v_cvt_pk_bf16_f32 v231, v122, v123
    v_mfma_f32_16x16x32_bf16 v[136:139], a[200:203], v[72:75], v[136:139]
    v_exp_f32 v116, v164
    v_mfma_f32_16x16x32_bf16 v[136:139], a[204:207], v[76:79], v[136:139]
    ds_read_b64_tr_b16 a[242:243], v110 offset:20480
    v_mfma_f32_16x16x32_bf16 v[140:143], a[192:195], v[80:83], v[28:31]
    v_exp_f32 v117, v165
    v_mfma_f32_16x16x32_bf16 v[140:143], a[196:199], v[84:87], v[140:143]
    ds_read_b64_tr_b16 a[244:245], v110 offset:24576
    v_cvt_pk_bf16_f32 v236, v116, v117
    v_mfma_f32_16x16x32_bf16 v[140:143], a[200:203], v[88:91], v[140:143]
    v_exp_f32 v118, v166
    v_mfma_f32_16x16x32_bf16 v[140:143], a[204:207], v[92:95], v[140:143]
    ds_read_b64_tr_b16 a[246:247], v110 offset:28672
    v_mfma_f32_16x16x32_bf16 v[144:147], a[208:211], v[32:35], v[16:19]
    v_exp_f32 v119, v167
    v_mfma_f32_16x16x32_bf16 v[144:147], a[212:215], v[36:39], v[144:147]
    ds_read_b64_tr_b16 a[248:249], v111 offset:16384
    v_cvt_pk_bf16_f32 v237, v118, v119
    v_mfma_f32_16x16x32_bf16 v[144:147], a[216:219], v[40:43], v[144:147]
    v_exp_f32 v120, v180
    v_mfma_f32_16x16x32_bf16 v[144:147], a[220:223], v[44:47], v[144:147]
    ds_read_b64_tr_b16 a[250:251], v111 offset:20480
    v_mfma_f32_16x16x32_bf16 v[148:151], a[208:211], v[48:51], v[20:23]
    v_exp_f32 v121, v181
    v_mfma_f32_16x16x32_bf16 v[148:151], a[212:215], v[52:55], v[148:151]
    ds_read_b64_tr_b16 a[252:253], v111 offset:24576
    v_cvt_pk_bf16_f32 v238, v120, v121
    v_mfma_f32_16x16x32_bf16 v[148:151], a[216:219], v[56:59], v[148:151]
    v_exp_f32 v122, v182
    v_mfma_f32_16x16x32_bf16 v[148:151], a[220:223], v[60:63], v[148:151]
    ds_read_b64_tr_b16 a[254:255], v111 offset:28672
    v_mfma_f32_16x16x32_bf16 v[152:155], a[208:211], v[64:67], v[24:27]
    v_exp_f32 v123, v183
    v_mfma_f32_16x16x32_bf16 v[152:155], a[212:215], v[68:71], v[152:155]
    ds_read_b128 a[192:195], v100 offset:57344
    v_cvt_pk_bf16_f32 v239, v122, v123
    v_mfma_f32_16x16x32_bf16 v[152:155], a[216:219], v[72:75], v[152:155]
    ds_read_b128 a[196:199], v101 offset:57344
    v_mfma_f32_16x16x32_bf16 v[152:155], a[220:223], v[76:79], v[152:155]
    v_exp_f32 v116, v168
    v_mfma_f32_16x16x32_bf16 v[156:159], a[208:211], v[80:83], v[28:31]
    ds_read_b128 a[200:203], v102 offset:57344
    v_mfma_f32_16x16x32_bf16 v[156:159], a[212:215], v[84:87], v[156:159]
    s_add_u32 m0, s42, 73728
    v_exp_f32 v117, v169
    v_mfma_f32_16x16x32_bf16 v[156:159], a[216:219], v[88:91], v[156:159]
    ds_read_b128 a[204:207], v103 offset:57344
    v_cvt_pk_bf16_f32 v244, v116, v117
    v_mfma_f32_16x16x32_bf16 v[156:159], a[220:223], v[92:95], v[156:159]
    v_exp_f32 v118, v170
    v_smfmac_f32_16x16x64_bf16 a[152:155], a[160:163], v[208:215], v0
    s_waitcnt lgkmcnt(12)
    ds_read_b128 a[208:211], v100 offset:61440
    v_smfmac_f32_16x16x64_bf16 a[156:159], a[160:163], v[216:223], v0
    ds_read_b128 a[212:215], v101 offset:61440
    v_mfma_f32_16x16x32_bf16 a[64:67], a[224:227], v[192:195], a[64:67]
    v_exp_f32 v119, v171
    v_mfma_f32_16x16x32_bf16 a[64:67], a[228:231], v[196:199], a[64:67]
    ds_read_b128 a[216:219], v102 offset:61440
    v_cvt_pk_bf16_f32 v245, v118, v119
    v_mfma_f32_16x16x32_bf16 a[68:71], a[224:227], v[200:203], a[68:71]
    v_exp_f32 v120, v184
    v_mfma_f32_16x16x32_bf16 a[68:71], a[228:231], v[204:207], a[68:71]
    buffer_load_dwordx4 v114, s[24:27], s50 offen offset:0 lds
    v_mfma_f32_16x16x32_bf16 a[72:75], a[224:227], v[208:211], a[72:75]
    v_exp_f32 v121, v185
    v_mfma_f32_16x16x32_bf16 a[72:75], a[228:231], v[212:215], a[72:75]
    ds_read_b128 a[220:223], v103 offset:61440
    v_cvt_pk_bf16_f32 v246, v120, v121
    v_mfma_f32_16x16x32_bf16 a[76:79], a[224:227], v[216:219], a[76:79]
    v_exp_f32 v122, v186
    v_mfma_f32_16x16x32_bf16 a[76:79], a[228:231], v[220:223], a[76:79]
    buffer_load_dwordx4 v125, s[24:27], s50 offen offset:1024 lds
    v_mfma_f32_16x16x32_bf16 a[80:83], a[232:235], v[192:195], a[80:83]
    s_add_u32 s50, s50, 8192
    v_exp_f32 v123, v187
    v_mfma_f32_16x16x32_bf16 a[80:83], a[236:239], v[196:199], a[80:83]
    v_cvt_pk_bf16_f32 v247, v122, v123
    v_mfma_f32_16x16x32_bf16 a[84:87], a[232:235], v[200:203], a[84:87]
    v_exp_f32 v116, v172
    v_mfma_f32_16x16x32_bf16 a[84:87], a[236:239], v[204:207], a[84:87]
    v_mfma_f32_16x16x32_bf16 a[88:91], a[232:235], v[208:211], a[88:91]
    v_exp_f32 v117, v173
    v_mfma_f32_16x16x32_bf16 a[88:91], a[236:239], v[212:215], a[88:91]
    s_waitcnt lgkmcnt(8)
    v_cvt_pk_bf16_f32 v252, v116, v117
    v_mfma_f32_16x16x32_bf16 a[92:95], a[232:235], v[216:219], a[92:95]
    v_exp_f32 v118, v174
    v_mfma_f32_16x16x32_bf16 a[92:95], a[236:239], v[220:223], a[92:95]
    ds_read_b64_tr_b16 a[224:225], v104 offset:32768
    v_mfma_f32_16x16x32_bf16 a[96:99], a[240:243], v[192:195], a[96:99]
    v_exp_f32 v119, v175
    v_mfma_f32_16x16x32_bf16 a[96:99], a[244:247], v[196:199], a[96:99]
    ds_read_b64_tr_b16 a[226:227], v104 offset:36864
    v_cvt_pk_bf16_f32 v253, v118, v119
    v_mfma_f32_16x16x32_bf16 a[100:103], a[240:243], v[200:203], a[100:103]
    v_exp_f32 v120, v188
    v_mfma_f32_16x16x32_bf16 a[100:103], a[244:247], v[204:207], a[100:103]
    global_load_dword v15, v115, s[0:1]
    v_mfma_f32_16x16x32_bf16 a[104:107], a[240:243], v[208:211], a[104:107]
    v_exp_f32 v121, v189
    v_mfma_f32_16x16x32_bf16 a[104:107], a[244:247], v[212:215], a[104:107]
    ds_read_b64_tr_b16 a[228:229], v104 offset:40960
    v_cvt_pk_bf16_f32 v254, v120, v121
    v_mfma_f32_16x16x32_bf16 a[108:111], a[240:243], v[216:219], a[108:111]
    v_exp_f32 v122, v190
    v_mfma_f32_16x16x32_bf16 a[108:111], a[244:247], v[220:223], a[108:111]
    ds_read_b64_tr_b16 a[230:231], v104 offset:45056
    v_mfma_f32_16x16x32_bf16 a[112:115], a[248:251], v[192:195], a[112:115]
    v_exp_f32 v123, v191
    v_mfma_f32_16x16x32_bf16 a[112:115], a[252:255], v[196:199], a[112:115]
    ds_read_b64_tr_b16 a[232:233], v105 offset:32768
    v_cvt_pk_bf16_f32 v255, v122, v123
    v_mfma_f32_16x16x32_bf16 a[116:119], a[248:251], v[200:203], a[116:119]
    v_exp_f32 v116, v128
    v_mfma_f32_16x16x32_bf16 a[116:119], a[252:255], v[204:207], a[116:119]
    ds_read_b64_tr_b16 a[234:235], v105 offset:36864
    v_mfma_f32_16x16x32_bf16 a[120:123], a[248:251], v[208:211], a[120:123]
    v_exp_f32 v117, v129
    v_mfma_f32_16x16x32_bf16 a[120:123], a[252:255], v[212:215], a[120:123]
    v_cvt_pk_bf16_f32 v192, v116, v117
    v_mfma_f32_16x16x32_bf16 a[124:127], a[248:251], v[216:219], a[124:127]
    s_waitcnt lgkmcnt(6)
    v_exp_f32 v118, v130
    v_mfma_f32_16x16x32_bf16 a[124:127], a[252:255], v[220:223], a[124:127]
    v_mfma_f32_16x16x32_bf16 v[160:163], a[192:195], v[32:35], v[16:19]
    v_exp_f32 v119, v131
    v_mfma_f32_16x16x32_bf16 v[160:163], a[196:199], v[36:39], v[160:163]
    ds_read_b64_tr_b16 a[236:237], v105 offset:40960
    v_cvt_pk_bf16_f32 v193, v118, v119
    v_mfma_f32_16x16x32_bf16 v[160:163], a[200:203], v[40:43], v[160:163]
    s_add_u32 m0, s42, 32768
    v_exp_f32 v120, v144
    v_mfma_f32_16x16x32_bf16 v[160:163], a[204:207], v[44:47], v[160:163]
    buffer_load_dwordx4 v112, s[20:23], s40 offen offset:0 lds
    v_mfma_f32_16x16x32_bf16 v[164:167], a[192:195], v[48:51], v[20:23]
    v_exp_f32 v121, v145
    v_mfma_f32_16x16x32_bf16 v[164:167], a[196:199], v[52:55], v[164:167]
    ds_read_b64_tr_b16 a[238:239], v105 offset:45056
    v_cvt_pk_bf16_f32 v194, v120, v121
    v_mfma_f32_16x16x32_bf16 v[164:167], a[200:203], v[56:59], v[164:167]
    v_exp_f32 v122, v146
    v_mfma_f32_16x16x32_bf16 v[164:167], a[204:207], v[60:63], v[164:167]
    buffer_load_dwordx4 v113, s[20:23], s40 offen offset:1024 lds
    v_mfma_f32_16x16x32_bf16 v[168:171], a[192:195], v[64:67], v[24:27]
    s_add_u32 s40, s40, 8192
    v_exp_f32 v123, v147
    v_mfma_f32_16x16x32_bf16 v[168:171], a[196:199], v[68:71], v[168:171]
    ds_read_b64_tr_b16 a[240:241], v106 offset:32768
    v_cvt_pk_bf16_f32 v195, v122, v123
    v_mfma_f32_16x16x32_bf16 v[168:171], a[200:203], v[72:75], v[168:171]
    v_exp_f32 v116, v132
    v_mfma_f32_16x16x32_bf16 v[168:171], a[204:207], v[76:79], v[168:171]
    ds_read_b64_tr_b16 a[242:243], v106 offset:36864
    v_mfma_f32_16x16x32_bf16 v[172:175], a[192:195], v[80:83], v[28:31]
    v_exp_f32 v117, v133
    v_mfma_f32_16x16x32_bf16 v[172:175], a[196:199], v[84:87], v[172:175]
    ds_read_b64_tr_b16 a[244:245], v106 offset:40960
    v_cvt_pk_bf16_f32 v200, v116, v117
    v_mfma_f32_16x16x32_bf16 v[172:175], a[200:203], v[88:91], v[172:175]
    v_exp_f32 v118, v134
    v_mfma_f32_16x16x32_bf16 v[172:175], a[204:207], v[92:95], v[172:175]
    ds_read_b64_tr_b16 a[246:247], v106 offset:45056
    v_mfma_f32_16x16x32_bf16 v[176:179], a[208:211], v[32:35], v[16:19]
    v_exp_f32 v119, v135
    v_mfma_f32_16x16x32_bf16 v[176:179], a[212:215], v[36:39], v[176:179]
    ds_read_b64_tr_b16 a[248:249], v107 offset:32768
    v_cvt_pk_bf16_f32 v201, v118, v119
    v_mfma_f32_16x16x32_bf16 v[176:179], a[216:219], v[40:43], v[176:179]
    v_exp_f32 v120, v148
    v_mfma_f32_16x16x32_bf16 v[176:179], a[220:223], v[44:47], v[176:179]
    ds_read_b64_tr_b16 a[250:251], v107 offset:36864
    v_mfma_f32_16x16x32_bf16 v[180:183], a[208:211], v[48:51], v[20:23]
    v_exp_f32 v121, v149
    v_mfma_f32_16x16x32_bf16 v[180:183], a[212:215], v[52:55], v[180:183]
    ds_read_b64_tr_b16 a[252:253], v107 offset:40960
    v_cvt_pk_bf16_f32 v202, v120, v121
    v_mfma_f32_16x16x32_bf16 v[180:183], a[216:219], v[56:59], v[180:183]
    v_exp_f32 v122, v150
    v_mfma_f32_16x16x32_bf16 v[180:183], a[220:223], v[60:63], v[180:183]
    ds_read_b64_tr_b16 a[254:255], v107 offset:45056
    v_mfma_f32_16x16x32_bf16 v[184:187], a[208:211], v[64:67], v[24:27]
    v_exp_f32 v123, v151
    v_mfma_f32_16x16x32_bf16 v[184:187], a[212:215], v[68:71], v[184:187]
    v_cvt_pk_bf16_f32 v203, v122, v123
    v_mfma_f32_16x16x32_bf16 v[184:187], a[216:219], v[72:75], v[184:187]
    s_waitcnt vmcnt(12)
    s_barrier
    v_mfma_f32_16x16x32_bf16 v[184:187], a[220:223], v[76:79], v[184:187]
    v_exp_f32 v116, v136
    v_mfma_f32_16x16x32_bf16 v[188:191], a[208:211], v[80:83], v[28:31]
    ds_read_b128 a[192:195], v100 offset:0
    v_mfma_f32_16x16x32_bf16 v[188:191], a[212:215], v[84:87], v[188:191]
    s_add_u32 m0, s42, 81920
    v_exp_f32 v117, v137
    v_mfma_f32_16x16x32_bf16 v[188:191], a[216:219], v[88:91], v[188:191]
    ds_read_b128 a[196:199], v101 offset:0
    v_cvt_pk_bf16_f32 v208, v116, v117
    v_mfma_f32_16x16x32_bf16 v[188:191], a[220:223], v[92:95], v[188:191]
    v_exp_f32 v118, v138
    v_smfmac_f32_16x16x64_bf16 a[144:147], a[160:163], v[224:231], v0
    s_waitcnt lgkmcnt(10)
    ds_read_b128 a[200:203], v102 offset:0
    v_smfmac_f32_16x16x64_bf16 a[148:151], a[160:163], v[232:239], v0
    ds_read_b128 a[204:207], v103 offset:0
    v_mfma_f32_16x16x32_bf16 a[0:3], a[224:227], v[224:227], a[0:3]
    v_exp_f32 v119, v139
    v_mfma_f32_16x16x32_bf16 a[0:3], a[228:231], v[228:231], a[0:3]
    ds_read_b128 a[208:211], v100 offset:4096
    v_cvt_pk_bf16_f32 v209, v118, v119
    v_mfma_f32_16x16x32_bf16 a[4:7], a[224:227], v[232:235], a[4:7]
    v_exp_f32 v120, v152
    v_mfma_f32_16x16x32_bf16 a[4:7], a[228:231], v[236:239], a[4:7]
    buffer_load_dwordx4 v114, s[24:27], s50 offen offset:0 lds
    v_mfma_f32_16x16x32_bf16 a[8:11], a[224:227], v[240:243], a[8:11]
    v_exp_f32 v121, v153
    v_mfma_f32_16x16x32_bf16 a[8:11], a[228:231], v[244:247], a[8:11]
    ds_read_b128 a[212:215], v101 offset:4096
    v_cvt_pk_bf16_f32 v210, v120, v121
    v_mfma_f32_16x16x32_bf16 a[12:15], a[224:227], v[248:251], a[12:15]
    v_exp_f32 v122, v154
    v_mfma_f32_16x16x32_bf16 a[12:15], a[228:231], v[252:255], a[12:15]
    buffer_load_dwordx4 v125, s[24:27], s50 offen offset:1024 lds
    v_mfma_f32_16x16x32_bf16 a[16:19], a[232:235], v[224:227], a[16:19]
    s_add_u32 s50, s50, 8192
    v_exp_f32 v123, v155
    v_mfma_f32_16x16x32_bf16 a[16:19], a[236:239], v[228:231], a[16:19]
    ds_read_b128 a[216:219], v102 offset:4096
    v_cvt_pk_bf16_f32 v211, v122, v123
    v_mfma_f32_16x16x32_bf16 a[20:23], a[232:235], v[232:235], a[20:23]
    v_exp_f32 v116, v140
    v_mfma_f32_16x16x32_bf16 a[20:23], a[236:239], v[236:239], a[20:23]
    ds_read_b128 a[220:223], v103 offset:4096
    v_mfma_f32_16x16x32_bf16 a[24:27], a[232:235], v[240:243], a[24:27]
    v_exp_f32 v117, v141
    v_mfma_f32_16x16x32_bf16 a[24:27], a[236:239], v[244:247], a[24:27]
    s_waitcnt lgkmcnt(8)
    v_cvt_pk_bf16_f32 v216, v116, v117
    v_mfma_f32_16x16x32_bf16 a[28:31], a[232:235], v[248:251], a[28:31]
    v_exp_f32 v118, v142
    v_mfma_f32_16x16x32_bf16 a[28:31], a[236:239], v[252:255], a[28:31]
    ds_read_b64_tr_b16 a[224:225], v108 offset:32768
    v_mfma_f32_16x16x32_bf16 a[32:35], a[240:243], v[224:227], a[32:35]
    v_exp_f32 v119, v143
    v_mfma_f32_16x16x32_bf16 a[32:35], a[244:247], v[228:231], a[32:35]
    ds_read_b64_tr_b16 a[226:227], v108 offset:36864
    v_cvt_pk_bf16_f32 v217, v118, v119
    v_mfma_f32_16x16x32_bf16 a[36:39], a[240:243], v[232:235], a[36:39]
    v_exp_f32 v120, v156
    v_mfma_f32_16x16x32_bf16 a[36:39], a[244:247], v[236:239], a[36:39]
    buffer_load_dword v15, v115, s[88:91], s67 offen
    v_mfma_f32_16x16x32_bf16 a[40:43], a[240:243], v[240:243], a[40:43]
    s_add_u32 s67, s67, 512
    v_exp_f32 v121, v157
    v_mfma_f32_16x16x32_bf16 a[40:43], a[244:247], v[244:247], a[40:43]
    ds_read_b64_tr_b16 a[228:229], v108 offset:40960
    v_cvt_pk_bf16_f32 v218, v120, v121
    v_mfma_f32_16x16x32_bf16 a[44:47], a[240:243], v[248:251], a[44:47]
    v_exp_f32 v122, v158
    v_mfma_f32_16x16x32_bf16 a[44:47], a[244:247], v[252:255], a[44:47]
    ds_read_b64_tr_b16 a[230:231], v108 offset:45056
    v_mfma_f32_16x16x32_bf16 a[48:51], a[248:251], v[224:227], a[48:51]
    v_exp_f32 v123, v159
    v_mfma_f32_16x16x32_bf16 a[48:51], a[252:255], v[228:231], a[48:51]
    ds_read_b64_tr_b16 a[232:233], v109 offset:32768
    v_cvt_pk_bf16_f32 v219, v122, v123
    v_mfma_f32_16x16x32_bf16 a[52:55], a[248:251], v[232:235], a[52:55]
    v_exp_f32 v116, v160
    v_mfma_f32_16x16x32_bf16 a[52:55], a[252:255], v[236:239], a[52:55]
    ds_read_b64_tr_b16 a[234:235], v109 offset:36864
    v_mfma_f32_16x16x32_bf16 a[56:59], a[248:251], v[240:243], a[56:59]
    v_exp_f32 v117, v161
    v_mfma_f32_16x16x32_bf16 a[56:59], a[252:255], v[244:247], a[56:59]
    v_cvt_pk_bf16_f32 v196, v116, v117
    v_mfma_f32_16x16x32_bf16 a[60:63], a[248:251], v[248:251], a[60:63]
    s_waitcnt lgkmcnt(6)
    v_exp_f32 v118, v162
    v_mfma_f32_16x16x32_bf16 a[60:63], a[252:255], v[252:255], a[60:63]
    v_mfma_f32_16x16x32_bf16 v[128:131], a[192:195], v[32:35], v[16:19]
    v_exp_f32 v119, v163
    v_mfma_f32_16x16x32_bf16 v[128:131], a[196:199], v[36:39], v[128:131]
    ds_read_b64_tr_b16 a[236:237], v109 offset:40960
    v_cvt_pk_bf16_f32 v197, v118, v119
    v_mfma_f32_16x16x32_bf16 v[128:131], a[200:203], v[40:43], v[128:131]
    s_add_u32 m0, s42, 40960
    v_exp_f32 v120, v176
    v_mfma_f32_16x16x32_bf16 v[128:131], a[204:207], v[44:47], v[128:131]
    buffer_load_dwordx4 v112, s[20:23], s40 offen offset:0 lds
    v_mfma_f32_16x16x32_bf16 v[132:135], a[192:195], v[48:51], v[20:23]
    v_exp_f32 v121, v177
    v_mfma_f32_16x16x32_bf16 v[132:135], a[196:199], v[52:55], v[132:135]
    ds_read_b64_tr_b16 a[238:239], v109 offset:45056
    v_cvt_pk_bf16_f32 v198, v120, v121
    v_mfma_f32_16x16x32_bf16 v[132:135], a[200:203], v[56:59], v[132:135]
    v_exp_f32 v122, v178
    v_mfma_f32_16x16x32_bf16 v[132:135], a[204:207], v[60:63], v[132:135]
    buffer_load_dwordx4 v113, s[20:23], s40 offen offset:1024 lds
    v_mfma_f32_16x16x32_bf16 v[136:139], a[192:195], v[64:67], v[24:27]
    s_add_u32 s40, s40, 8192
    v_exp_f32 v123, v179
    v_mfma_f32_16x16x32_bf16 v[136:139], a[196:199], v[68:71], v[136:139]
    ds_read_b64_tr_b16 a[240:241], v110 offset:32768
    v_cvt_pk_bf16_f32 v199, v122, v123
    v_mfma_f32_16x16x32_bf16 v[136:139], a[200:203], v[72:75], v[136:139]
    v_exp_f32 v116, v164
    v_mfma_f32_16x16x32_bf16 v[136:139], a[204:207], v[76:79], v[136:139]
    ds_read_b64_tr_b16 a[242:243], v110 offset:36864
    v_mfma_f32_16x16x32_bf16 v[140:143], a[192:195], v[80:83], v[28:31]
    v_exp_f32 v117, v165
    v_mfma_f32_16x16x32_bf16 v[140:143], a[196:199], v[84:87], v[140:143]
    ds_read_b64_tr_b16 a[244:245], v110 offset:40960
    v_cvt_pk_bf16_f32 v204, v116, v117
    v_mfma_f32_16x16x32_bf16 v[140:143], a[200:203], v[88:91], v[140:143]
    v_exp_f32 v118, v166
    v_mfma_f32_16x16x32_bf16 v[140:143], a[204:207], v[92:95], v[140:143]
    ds_read_b64_tr_b16 a[246:247], v110 offset:45056
    v_mfma_f32_16x16x32_bf16 v[144:147], a[208:211], v[32:35], v[16:19]
    v_exp_f32 v119, v167
    v_mfma_f32_16x16x32_bf16 v[144:147], a[212:215], v[36:39], v[144:147]
    ds_read_b64_tr_b16 a[248:249], v111 offset:32768
    v_cvt_pk_bf16_f32 v205, v118, v119
    v_mfma_f32_16x16x32_bf16 v[144:147], a[216:219], v[40:43], v[144:147]
    v_exp_f32 v120, v180
    v_mfma_f32_16x16x32_bf16 v[144:147], a[220:223], v[44:47], v[144:147]
    ds_read_b64_tr_b16 a[250:251], v111 offset:36864
    v_mfma_f32_16x16x32_bf16 v[148:151], a[208:211], v[48:51], v[20:23]
    v_exp_f32 v121, v181
    v_mfma_f32_16x16x32_bf16 v[148:151], a[212:215], v[52:55], v[148:151]
    ds_read_b64_tr_b16 a[252:253], v111 offset:40960
    v_cvt_pk_bf16_f32 v206, v120, v121
    v_mfma_f32_16x16x32_bf16 v[148:151], a[216:219], v[56:59], v[148:151]
    v_exp_f32 v122, v182
    v_mfma_f32_16x16x32_bf16 v[148:151], a[220:223], v[60:63], v[148:151]
    ds_read_b64_tr_b16 a[254:255], v111 offset:45056
    v_mfma_f32_16x16x32_bf16 v[152:155], a[208:211], v[64:67], v[24:27]
    v_exp_f32 v123, v183
    v_mfma_f32_16x16x32_bf16 v[152:155], a[212:215], v[68:71], v[152:155]
    ds_read_b128 a[192:195], v100 offset:8192
    v_cvt_pk_bf16_f32 v207, v122, v123
    v_mfma_f32_16x16x32_bf16 v[152:155], a[216:219], v[72:75], v[152:155]
    ds_read_b128 a[196:199], v101 offset:8192
    v_mfma_f32_16x16x32_bf16 v[152:155], a[220:223], v[76:79], v[152:155]
    v_exp_f32 v116, v168
    v_mfma_f32_16x16x32_bf16 v[156:159], a[208:211], v[80:83], v[28:31]
    ds_read_b128 a[200:203], v102 offset:8192
    v_mfma_f32_16x16x32_bf16 v[156:159], a[212:215], v[84:87], v[156:159]
    s_add_u32 m0, s42, 90112
    v_exp_f32 v117, v169
    v_mfma_f32_16x16x32_bf16 v[156:159], a[216:219], v[88:91], v[156:159]
    ds_read_b128 a[204:207], v103 offset:8192
    v_cvt_pk_bf16_f32 v212, v116, v117
    v_mfma_f32_16x16x32_bf16 v[156:159], a[220:223], v[92:95], v[156:159]
    v_exp_f32 v118, v170
    v_smfmac_f32_16x16x64_bf16 a[152:155], a[160:163], v[240:247], v0
    s_waitcnt lgkmcnt(12)
    ds_read_b128 a[208:211], v100 offset:12288
    v_smfmac_f32_16x16x64_bf16 a[156:159], a[160:163], v[248:255], v0
    ds_read_b128 a[212:215], v101 offset:12288
    v_mfma_f32_16x16x32_bf16 a[64:67], a[224:227], v[224:227], a[64:67]
    v_exp_f32 v119, v171
    v_mfma_f32_16x16x32_bf16 a[64:67], a[228:231], v[228:231], a[64:67]
    ds_read_b128 a[216:219], v102 offset:12288
    v_cvt_pk_bf16_f32 v213, v118, v119
    v_mfma_f32_16x16x32_bf16 a[68:71], a[224:227], v[232:235], a[68:71]
    v_exp_f32 v120, v184
    v_mfma_f32_16x16x32_bf16 a[68:71], a[228:231], v[236:239], a[68:71]
    buffer_load_dwordx4 v114, s[24:27], s50 offen offset:0 lds
    v_mfma_f32_16x16x32_bf16 a[72:75], a[224:227], v[240:243], a[72:75]
    v_exp_f32 v121, v185
    v_mfma_f32_16x16x32_bf16 a[72:75], a[228:231], v[244:247], a[72:75]
    ds_read_b128 a[220:223], v103 offset:12288
    v_cvt_pk_bf16_f32 v214, v120, v121
    v_mfma_f32_16x16x32_bf16 a[76:79], a[224:227], v[248:251], a[76:79]
    v_exp_f32 v122, v186
    v_mfma_f32_16x16x32_bf16 a[76:79], a[228:231], v[252:255], a[76:79]
    buffer_load_dwordx4 v125, s[24:27], s50 offen offset:1024 lds
    v_mfma_f32_16x16x32_bf16 a[80:83], a[232:235], v[224:227], a[80:83]
    s_add_u32 s50, s50, 8192
    v_exp_f32 v123, v187
    v_mfma_f32_16x16x32_bf16 a[80:83], a[236:239], v[228:231], a[80:83]
    v_cvt_pk_bf16_f32 v215, v122, v123
    v_mfma_f32_16x16x32_bf16 a[84:87], a[232:235], v[232:235], a[84:87]
    v_exp_f32 v116, v172
    v_mfma_f32_16x16x32_bf16 a[84:87], a[236:239], v[236:239], a[84:87]
    v_mfma_f32_16x16x32_bf16 a[88:91], a[232:235], v[240:243], a[88:91]
    v_exp_f32 v117, v173
    v_mfma_f32_16x16x32_bf16 a[88:91], a[236:239], v[244:247], a[88:91]
    s_waitcnt lgkmcnt(8)
    v_cvt_pk_bf16_f32 v220, v116, v117
    v_mfma_f32_16x16x32_bf16 a[92:95], a[232:235], v[248:251], a[92:95]
    v_exp_f32 v118, v174
    v_mfma_f32_16x16x32_bf16 a[92:95], a[236:239], v[252:255], a[92:95]
    ds_read_b64_tr_b16 a[224:225], v104 offset:49152
    v_mfma_f32_16x16x32_bf16 a[96:99], a[240:243], v[224:227], a[96:99]
    v_exp_f32 v119, v175
    v_mfma_f32_16x16x32_bf16 a[96:99], a[244:247], v[228:231], a[96:99]
    ds_read_b64_tr_b16 a[226:227], v104 offset:53248
    v_cvt_pk_bf16_f32 v221, v118, v119
    v_mfma_f32_16x16x32_bf16 a[100:103], a[240:243], v[232:235], a[100:103]
    v_exp_f32 v120, v188
    v_mfma_f32_16x16x32_bf16 a[100:103], a[244:247], v[236:239], a[100:103]
    ds_read_b64_tr_b16 a[228:229], v104 offset:57344
    v_mfma_f32_16x16x32_bf16 a[104:107], a[240:243], v[240:243], a[104:107]
    v_exp_f32 v121, v189
    v_mfma_f32_16x16x32_bf16 a[104:107], a[244:247], v[244:247], a[104:107]
    ds_read_b64_tr_b16 a[230:231], v104 offset:61440
    v_cvt_pk_bf16_f32 v222, v120, v121
    v_mfma_f32_16x16x32_bf16 a[108:111], a[240:243], v[248:251], a[108:111]
    v_exp_f32 v122, v190
    v_mfma_f32_16x16x32_bf16 a[108:111], a[244:247], v[252:255], a[108:111]
    ds_read_b64_tr_b16 a[232:233], v105 offset:49152
    v_mfma_f32_16x16x32_bf16 a[112:115], a[248:251], v[224:227], a[112:115]
    v_exp_f32 v123, v191
    v_mfma_f32_16x16x32_bf16 a[112:115], a[252:255], v[228:231], a[112:115]
    ds_read_b64_tr_b16 a[234:235], v105 offset:53248
    v_cvt_pk_bf16_f32 v223, v122, v123
    v_mfma_f32_16x16x32_bf16 a[116:119], a[248:251], v[232:235], a[116:119]
    v_exp_f32 v116, v128
    v_mfma_f32_16x16x32_bf16 a[116:119], a[252:255], v[236:239], a[116:119]
    v_mfma_f32_16x16x32_bf16 a[120:123], a[248:251], v[240:243], a[120:123]
    v_exp_f32 v117, v129
    v_mfma_f32_16x16x32_bf16 a[120:123], a[252:255], v[244:247], a[120:123]
    v_cvt_pk_bf16_f32 v224, v116, v117
    v_mfma_f32_16x16x32_bf16 a[124:127], a[248:251], v[248:251], a[124:127]
    s_waitcnt lgkmcnt(6)
    v_exp_f32 v118, v130
    v_mfma_f32_16x16x32_bf16 a[124:127], a[252:255], v[252:255], a[124:127]
    v_mfma_f32_16x16x32_bf16 v[160:163], a[192:195], v[32:35], v[16:19]
    v_exp_f32 v119, v131
    v_mfma_f32_16x16x32_bf16 v[160:163], a[196:199], v[36:39], v[160:163]
    ds_read_b64_tr_b16 a[236:237], v105 offset:57344
    v_cvt_pk_bf16_f32 v225, v118, v119
    v_mfma_f32_16x16x32_bf16 v[160:163], a[200:203], v[40:43], v[160:163]
    s_add_u32 m0, s42, 49152
    v_exp_f32 v120, v144
    v_mfma_f32_16x16x32_bf16 v[160:163], a[204:207], v[44:47], v[160:163]
    buffer_load_dwordx4 v112, s[20:23], s40 offen offset:0 lds
    v_mfma_f32_16x16x32_bf16 v[164:167], a[192:195], v[48:51], v[20:23]
    v_exp_f32 v121, v145
    v_mfma_f32_16x16x32_bf16 v[164:167], a[196:199], v[52:55], v[164:167]
    ds_read_b64_tr_b16 a[238:239], v105 offset:61440
    v_cvt_pk_bf16_f32 v226, v120, v121
    v_mfma_f32_16x16x32_bf16 v[164:167], a[200:203], v[56:59], v[164:167]
    v_exp_f32 v122, v146
    v_mfma_f32_16x16x32_bf16 v[164:167], a[204:207], v[60:63], v[164:167]
    buffer_load_dwordx4 v113, s[20:23], s40 offen offset:1024 lds
    v_mfma_f32_16x16x32_bf16 v[168:171], a[192:195], v[64:67], v[24:27]
    s_add_u32 s40, s40, 8192
    v_exp_f32 v123, v147
    v_mfma_f32_16x16x32_bf16 v[168:171], a[196:199], v[68:71], v[168:171]
    ds_read_b64_tr_b16 a[240:241], v106 offset:49152
    v_cvt_pk_bf16_f32 v227, v122, v123
    v_mfma_f32_16x16x32_bf16 v[168:171], a[200:203], v[72:75], v[168:171]
    v_exp_f32 v116, v132
    v_mfma_f32_16x16x32_bf16 v[168:171], a[204:207], v[76:79], v[168:171]
    ds_read_b64_tr_b16 a[242:243], v106 offset:53248
    v_mfma_f32_16x16x32_bf16 v[172:175], a[192:195], v[80:83], v[28:31]
    v_exp_f32 v117, v133
    v_mfma_f32_16x16x32_bf16 v[172:175], a[196:199], v[84:87], v[172:175]
    ds_read_b64_tr_b16 a[244:245], v106 offset:57344
    v_cvt_pk_bf16_f32 v232, v116, v117
    v_mfma_f32_16x16x32_bf16 v[172:175], a[200:203], v[88:91], v[172:175]
    v_exp_f32 v118, v134
    v_mfma_f32_16x16x32_bf16 v[172:175], a[204:207], v[92:95], v[172:175]
    ds_read_b64_tr_b16 a[246:247], v106 offset:61440
    v_mfma_f32_16x16x32_bf16 v[176:179], a[208:211], v[32:35], v[16:19]
    v_exp_f32 v119, v135
    v_mfma_f32_16x16x32_bf16 v[176:179], a[212:215], v[36:39], v[176:179]
    ds_read_b64_tr_b16 a[248:249], v107 offset:49152
    v_cvt_pk_bf16_f32 v233, v118, v119
    v_mfma_f32_16x16x32_bf16 v[176:179], a[216:219], v[40:43], v[176:179]
    v_exp_f32 v120, v148
    v_mfma_f32_16x16x32_bf16 v[176:179], a[220:223], v[44:47], v[176:179]
    ds_read_b64_tr_b16 a[250:251], v107 offset:53248
    v_mfma_f32_16x16x32_bf16 v[180:183], a[208:211], v[48:51], v[20:23]
    v_exp_f32 v121, v149
    v_mfma_f32_16x16x32_bf16 v[180:183], a[212:215], v[52:55], v[180:183]
    ds_read_b64_tr_b16 a[252:253], v107 offset:57344
    v_cvt_pk_bf16_f32 v234, v120, v121
    v_mfma_f32_16x16x32_bf16 v[180:183], a[216:219], v[56:59], v[180:183]
    v_exp_f32 v122, v150
    v_mfma_f32_16x16x32_bf16 v[180:183], a[220:223], v[60:63], v[180:183]
    ds_read_b64_tr_b16 a[254:255], v107 offset:61440
    v_mfma_f32_16x16x32_bf16 v[184:187], a[208:211], v[64:67], v[24:27]
    v_exp_f32 v123, v151
    v_mfma_f32_16x16x32_bf16 v[184:187], a[212:215], v[68:71], v[184:187]
    v_cvt_pk_bf16_f32 v235, v122, v123
    v_mfma_f32_16x16x32_bf16 v[184:187], a[216:219], v[72:75], v[184:187]
    s_waitcnt vmcnt(12)
    s_barrier
    v_mfma_f32_16x16x32_bf16 v[184:187], a[220:223], v[76:79], v[184:187]
    v_exp_f32 v116, v136
    v_mfma_f32_16x16x32_bf16 v[188:191], a[208:211], v[80:83], v[28:31]
    ds_read_b128 a[192:195], v100 offset:16384
    v_mfma_f32_16x16x32_bf16 v[188:191], a[212:215], v[84:87], v[188:191]
    s_add_u32 m0, s42, 98304
    v_exp_f32 v117, v137
    v_mfma_f32_16x16x32_bf16 v[188:191], a[216:219], v[88:91], v[188:191]
    ds_read_b128 a[196:199], v101 offset:16384
    v_cvt_pk_bf16_f32 v240, v116, v117
    v_mfma_f32_16x16x32_bf16 v[188:191], a[220:223], v[92:95], v[188:191]
    v_exp_f32 v118, v138
    v_smfmac_f32_16x16x64_bf16 a[144:147], a[160:163], v[192:199], v0
    s_waitcnt lgkmcnt(10)
    ds_read_b128 a[200:203], v102 offset:16384
    v_smfmac_f32_16x16x64_bf16 a[148:151], a[160:163], v[200:207], v0
    ds_read_b128 a[204:207], v103 offset:16384
    v_mfma_f32_16x16x32_bf16 a[0:3], a[224:227], v[192:195], a[0:3]
    v_exp_f32 v119, v139
    v_mfma_f32_16x16x32_bf16 a[0:3], a[228:231], v[196:199], a[0:3]
    ds_read_b128 a[208:211], v100 offset:20480
    v_cvt_pk_bf16_f32 v241, v118, v119
    v_mfma_f32_16x16x32_bf16 a[4:7], a[224:227], v[200:203], a[4:7]
    v_exp_f32 v120, v152
    v_mfma_f32_16x16x32_bf16 a[4:7], a[228:231], v[204:207], a[4:7]
    buffer_load_dwordx4 v114, s[24:27], s50 offen offset:0 lds
    v_mfma_f32_16x16x32_bf16 a[8:11], a[224:227], v[208:211], a[8:11]
    v_exp_f32 v121, v153
    v_mfma_f32_16x16x32_bf16 a[8:11], a[228:231], v[212:215], a[8:11]
    ds_read_b128 a[212:215], v101 offset:20480
    v_cvt_pk_bf16_f32 v242, v120, v121
    v_mfma_f32_16x16x32_bf16 a[12:15], a[224:227], v[216:219], a[12:15]
    v_exp_f32 v122, v154
    v_mfma_f32_16x16x32_bf16 a[12:15], a[228:231], v[220:223], a[12:15]
    buffer_load_dwordx4 v125, s[24:27], s50 offen offset:1024 lds
    v_mfma_f32_16x16x32_bf16 a[16:19], a[232:235], v[192:195], a[16:19]
    s_add_u32 s50, s50, 8192
    v_exp_f32 v123, v155
    v_mfma_f32_16x16x32_bf16 a[16:19], a[236:239], v[196:199], a[16:19]
    ds_read_b128 a[216:219], v102 offset:20480
    v_cvt_pk_bf16_f32 v243, v122, v123
    v_mfma_f32_16x16x32_bf16 a[20:23], a[232:235], v[200:203], a[20:23]
    v_exp_f32 v116, v140
    v_mfma_f32_16x16x32_bf16 a[20:23], a[236:239], v[204:207], a[20:23]
    ds_read_b128 a[220:223], v103 offset:20480
    v_mfma_f32_16x16x32_bf16 a[24:27], a[232:235], v[208:211], a[24:27]
    v_exp_f32 v117, v141
    v_mfma_f32_16x16x32_bf16 a[24:27], a[236:239], v[212:215], a[24:27]
    s_waitcnt lgkmcnt(8)
    v_cvt_pk_bf16_f32 v248, v116, v117
    v_mfma_f32_16x16x32_bf16 a[28:31], a[232:235], v[216:219], a[28:31]
    v_exp_f32 v118, v142
    v_mfma_f32_16x16x32_bf16 a[28:31], a[236:239], v[220:223], a[28:31]
    ds_read_b64_tr_b16 a[224:225], v108 offset:49152
    v_mfma_f32_16x16x32_bf16 a[32:35], a[240:243], v[192:195], a[32:35]
    v_exp_f32 v119, v143
    v_mfma_f32_16x16x32_bf16 a[32:35], a[244:247], v[196:199], a[32:35]
    ds_read_b64_tr_b16 a[226:227], v108 offset:53248
    v_cvt_pk_bf16_f32 v249, v118, v119
    v_mfma_f32_16x16x32_bf16 a[36:39], a[240:243], v[200:203], a[36:39]
    v_exp_f32 v120, v156
    v_mfma_f32_16x16x32_bf16 a[36:39], a[244:247], v[204:207], a[36:39]
    buffer_load_dword v15, v115, s[84:87], s66 offen
    v_mfma_f32_16x16x32_bf16 a[40:43], a[240:243], v[208:211], a[40:43]
    s_add_u32 s66, s66, 640
    v_exp_f32 v121, v157
    v_mfma_f32_16x16x32_bf16 a[40:43], a[244:247], v[212:215], a[40:43]
    ds_read_b64_tr_b16 a[228:229], v108 offset:57344
    v_cvt_pk_bf16_f32 v250, v120, v121
    v_mfma_f32_16x16x32_bf16 a[44:47], a[240:243], v[216:219], a[44:47]
    v_exp_f32 v122, v158
    v_mfma_f32_16x16x32_bf16 a[44:47], a[244:247], v[220:223], a[44:47]
    ds_read_b64_tr_b16 a[230:231], v108 offset:61440
    v_mfma_f32_16x16x32_bf16 a[48:51], a[248:251], v[192:195], a[48:51]
    v_exp_f32 v123, v159
    v_mfma_f32_16x16x32_bf16 a[48:51], a[252:255], v[196:199], a[48:51]
    ds_read_b64_tr_b16 a[232:233], v109 offset:49152
    v_cvt_pk_bf16_f32 v251, v122, v123
    v_mfma_f32_16x16x32_bf16 a[52:55], a[248:251], v[200:203], a[52:55]
    v_exp_f32 v116, v160
    v_mfma_f32_16x16x32_bf16 a[52:55], a[252:255], v[204:207], a[52:55]
    ds_read_b64_tr_b16 a[234:235], v109 offset:53248
    v_mfma_f32_16x16x32_bf16 a[56:59], a[248:251], v[208:211], a[56:59]
    v_exp_f32 v117, v161
    v_mfma_f32_16x16x32_bf16 a[56:59], a[252:255], v[212:215], a[56:59]
    v_cvt_pk_bf16_f32 v228, v116, v117
    v_mfma_f32_16x16x32_bf16 a[60:63], a[248:251], v[216:219], a[60:63]
    s_waitcnt lgkmcnt(6)
    v_exp_f32 v118, v162
    v_mfma_f32_16x16x32_bf16 a[60:63], a[252:255], v[220:223], a[60:63]
    v_mfma_f32_16x16x32_bf16 v[128:131], a[192:195], v[32:35], v[16:19]
    v_exp_f32 v119, v163
    v_mfma_f32_16x16x32_bf16 v[128:131], a[196:199], v[36:39], v[128:131]
    ds_read_b64_tr_b16 a[236:237], v109 offset:57344
    v_cvt_pk_bf16_f32 v229, v118, v119
    v_mfma_f32_16x16x32_bf16 v[128:131], a[200:203], v[40:43], v[128:131]
    s_add_u32 m0, s42, 57344
    v_exp_f32 v120, v176
    v_mfma_f32_16x16x32_bf16 v[128:131], a[204:207], v[44:47], v[128:131]
    buffer_load_dwordx4 v112, s[20:23], s40 offen offset:0 lds
    v_mfma_f32_16x16x32_bf16 v[132:135], a[192:195], v[48:51], v[20:23]
    v_exp_f32 v121, v177
    v_mfma_f32_16x16x32_bf16 v[132:135], a[196:199], v[52:55], v[132:135]
    ds_read_b64_tr_b16 a[238:239], v109 offset:61440
    v_cvt_pk_bf16_f32 v230, v120, v121
    v_mfma_f32_16x16x32_bf16 v[132:135], a[200:203], v[56:59], v[132:135]
    v_exp_f32 v122, v178
    v_mfma_f32_16x16x32_bf16 v[132:135], a[204:207], v[60:63], v[132:135]
    buffer_load_dwordx4 v113, s[20:23], s40 offen offset:1024 lds
    v_mfma_f32_16x16x32_bf16 v[136:139], a[192:195], v[64:67], v[24:27]
    s_add_u32 s40, s40, 8192
    v_exp_f32 v123, v179
    v_mfma_f32_16x16x32_bf16 v[136:139], a[196:199], v[68:71], v[136:139]
    ds_read_b64_tr_b16 a[240:241], v110 offset:49152
    v_cvt_pk_bf16_f32 v231, v122, v123
    v_mfma_f32_16x16x32_bf16 v[136:139], a[200:203], v[72:75], v[136:139]
    v_exp_f32 v116, v164
    v_mfma_f32_16x16x32_bf16 v[136:139], a[204:207], v[76:79], v[136:139]
    ds_read_b64_tr_b16 a[242:243], v110 offset:53248
    v_mfma_f32_16x16x32_bf16 v[140:143], a[192:195], v[80:83], v[28:31]
    v_exp_f32 v117, v165
    v_mfma_f32_16x16x32_bf16 v[140:143], a[196:199], v[84:87], v[140:143]
    ds_read_b64_tr_b16 a[244:245], v110 offset:57344
    v_cvt_pk_bf16_f32 v236, v116, v117
    v_mfma_f32_16x16x32_bf16 v[140:143], a[200:203], v[88:91], v[140:143]
    v_exp_f32 v118, v166
    v_mfma_f32_16x16x32_bf16 v[140:143], a[204:207], v[92:95], v[140:143]
    ds_read_b64_tr_b16 a[246:247], v110 offset:61440
    v_mfma_f32_16x16x32_bf16 v[144:147], a[208:211], v[32:35], v[16:19]
    v_exp_f32 v119, v167
    v_mfma_f32_16x16x32_bf16 v[144:147], a[212:215], v[36:39], v[144:147]
    ds_read_b64_tr_b16 a[248:249], v111 offset:49152
    v_cvt_pk_bf16_f32 v237, v118, v119
    v_mfma_f32_16x16x32_bf16 v[144:147], a[216:219], v[40:43], v[144:147]
    v_exp_f32 v120, v180
    v_mfma_f32_16x16x32_bf16 v[144:147], a[220:223], v[44:47], v[144:147]
    ds_read_b64_tr_b16 a[250:251], v111 offset:53248
    v_mfma_f32_16x16x32_bf16 v[148:151], a[208:211], v[48:51], v[20:23]
    v_exp_f32 v121, v181
    v_mfma_f32_16x16x32_bf16 v[148:151], a[212:215], v[52:55], v[148:151]
    ds_read_b64_tr_b16 a[252:253], v111 offset:57344
    v_cvt_pk_bf16_f32 v238, v120, v121
    v_mfma_f32_16x16x32_bf16 v[148:151], a[216:219], v[56:59], v[148:151]
    v_exp_f32 v122, v182
    v_mfma_f32_16x16x32_bf16 v[148:151], a[220:223], v[60:63], v[148:151]
    ds_read_b64_tr_b16 a[254:255], v111 offset:61440
    v_mfma_f32_16x16x32_bf16 v[152:155], a[208:211], v[64:67], v[24:27]
    v_exp_f32 v123, v183
    v_mfma_f32_16x16x32_bf16 v[152:155], a[212:215], v[68:71], v[152:155]
    ds_read_b128 a[192:195], v100 offset:24576
    v_cvt_pk_bf16_f32 v239, v122, v123
    v_mfma_f32_16x16x32_bf16 v[152:155], a[216:219], v[72:75], v[152:155]
    ds_read_b128 a[196:199], v101 offset:24576
    v_mfma_f32_16x16x32_bf16 v[152:155], a[220:223], v[76:79], v[152:155]
    v_exp_f32 v116, v168
    v_mfma_f32_16x16x32_bf16 v[156:159], a[208:211], v[80:83], v[28:31]
    ds_read_b128 a[200:203], v102 offset:24576
    v_mfma_f32_16x16x32_bf16 v[156:159], a[212:215], v[84:87], v[156:159]
    s_add_u32 m0, s42, 106496
    v_exp_f32 v117, v169
    v_mfma_f32_16x16x32_bf16 v[156:159], a[216:219], v[88:91], v[156:159]
    ds_read_b128 a[204:207], v103 offset:24576
    v_cvt_pk_bf16_f32 v244, v116, v117
    v_mfma_f32_16x16x32_bf16 v[156:159], a[220:223], v[92:95], v[156:159]
    v_exp_f32 v118, v170
    v_smfmac_f32_16x16x64_bf16 a[152:155], a[160:163], v[208:215], v0
    s_waitcnt lgkmcnt(12)
    ds_read_b128 a[208:211], v100 offset:28672
    v_smfmac_f32_16x16x64_bf16 a[156:159], a[160:163], v[216:223], v0
    ds_read_b128 a[212:215], v101 offset:28672
    v_mfma_f32_16x16x32_bf16 a[64:67], a[224:227], v[192:195], a[64:67]
    v_exp_f32 v119, v171
    v_mfma_f32_16x16x32_bf16 a[64:67], a[228:231], v[196:199], a[64:67]
    ds_read_b128 a[216:219], v102 offset:28672
    v_cvt_pk_bf16_f32 v245, v118, v119
    v_mfma_f32_16x16x32_bf16 a[68:71], a[224:227], v[200:203], a[68:71]
    v_exp_f32 v120, v184
    v_mfma_f32_16x16x32_bf16 a[68:71], a[228:231], v[204:207], a[68:71]
    buffer_load_dwordx4 v114, s[24:27], s50 offen offset:0 lds
    v_mfma_f32_16x16x32_bf16 a[72:75], a[224:227], v[208:211], a[72:75]
    v_exp_f32 v121, v185
    v_mfma_f32_16x16x32_bf16 a[72:75], a[228:231], v[212:215], a[72:75]
    ds_read_b128 a[220:223], v103 offset:28672
    v_cvt_pk_bf16_f32 v246, v120, v121
    v_mfma_f32_16x16x32_bf16 a[76:79], a[224:227], v[216:219], a[76:79]
    v_exp_f32 v122, v186
    v_mfma_f32_16x16x32_bf16 a[76:79], a[228:231], v[220:223], a[76:79]
    buffer_load_dwordx4 v125, s[24:27], s50 offen offset:1024 lds
    v_mfma_f32_16x16x32_bf16 a[80:83], a[232:235], v[192:195], a[80:83]
    s_add_u32 s50, s50, 8192
    v_exp_f32 v123, v187
    v_mfma_f32_16x16x32_bf16 a[80:83], a[236:239], v[196:199], a[80:83]
    v_cvt_pk_bf16_f32 v247, v122, v123
    v_mfma_f32_16x16x32_bf16 a[84:87], a[232:235], v[200:203], a[84:87]
    v_exp_f32 v116, v172
    v_mfma_f32_16x16x32_bf16 a[84:87], a[236:239], v[204:207], a[84:87]
    v_mfma_f32_16x16x32_bf16 a[88:91], a[232:235], v[208:211], a[88:91]
    v_exp_f32 v117, v173
    v_mfma_f32_16x16x32_bf16 a[88:91], a[236:239], v[212:215], a[88:91]
    s_waitcnt lgkmcnt(8)
    v_cvt_pk_bf16_f32 v252, v116, v117
    v_mfma_f32_16x16x32_bf16 a[92:95], a[232:235], v[216:219], a[92:95]
    v_exp_f32 v118, v174
    v_mfma_f32_16x16x32_bf16 a[92:95], a[236:239], v[220:223], a[92:95]
    ds_read_b64_tr_b16 a[224:225], v104 offset:0
    v_mfma_f32_16x16x32_bf16 a[96:99], a[240:243], v[192:195], a[96:99]
    v_exp_f32 v119, v175
    v_mfma_f32_16x16x32_bf16 a[96:99], a[244:247], v[196:199], a[96:99]
    ds_read_b64_tr_b16 a[226:227], v104 offset:4096
    v_cvt_pk_bf16_f32 v253, v118, v119
    v_mfma_f32_16x16x32_bf16 a[100:103], a[240:243], v[200:203], a[100:103]
    v_exp_f32 v120, v188
    v_mfma_f32_16x16x32_bf16 a[100:103], a[244:247], v[204:207], a[100:103]
    global_load_dword v15, v115, s[0:1]
    v_mfma_f32_16x16x32_bf16 a[104:107], a[240:243], v[208:211], a[104:107]
    v_exp_f32 v121, v189
    v_mfma_f32_16x16x32_bf16 a[104:107], a[244:247], v[212:215], a[104:107]
    ds_read_b64_tr_b16 a[228:229], v104 offset:8192
    v_cvt_pk_bf16_f32 v254, v120, v121
    v_mfma_f32_16x16x32_bf16 a[108:111], a[240:243], v[216:219], a[108:111]
    v_exp_f32 v122, v190
    v_mfma_f32_16x16x32_bf16 a[108:111], a[244:247], v[220:223], a[108:111]
    ds_read_b64_tr_b16 a[230:231], v104 offset:12288
    v_mfma_f32_16x16x32_bf16 a[112:115], a[248:251], v[192:195], a[112:115]
    v_exp_f32 v123, v191
    v_mfma_f32_16x16x32_bf16 a[112:115], a[252:255], v[196:199], a[112:115]
    ds_read_b64_tr_b16 a[232:233], v105 offset:0
    v_cvt_pk_bf16_f32 v255, v122, v123
    v_mfma_f32_16x16x32_bf16 a[116:119], a[248:251], v[200:203], a[116:119]
    v_exp_f32 v116, v128
    v_mfma_f32_16x16x32_bf16 a[116:119], a[252:255], v[204:207], a[116:119]
    ds_read_b64_tr_b16 a[234:235], v105 offset:4096
    v_mfma_f32_16x16x32_bf16 a[120:123], a[248:251], v[208:211], a[120:123]
    v_exp_f32 v117, v129
    v_mfma_f32_16x16x32_bf16 a[120:123], a[252:255], v[212:215], a[120:123]
    v_cvt_pk_bf16_f32 v192, v116, v117
    v_mfma_f32_16x16x32_bf16 a[124:127], a[248:251], v[216:219], a[124:127]
    s_waitcnt lgkmcnt(6)
    v_exp_f32 v118, v130
    v_mfma_f32_16x16x32_bf16 a[124:127], a[252:255], v[220:223], a[124:127]
    v_mfma_f32_16x16x32_bf16 v[160:163], a[192:195], v[32:35], v[16:19]
    v_exp_f32 v119, v131
    v_mfma_f32_16x16x32_bf16 v[160:163], a[196:199], v[36:39], v[160:163]
    ds_read_b64_tr_b16 a[236:237], v105 offset:8192
    v_cvt_pk_bf16_f32 v193, v118, v119
    v_mfma_f32_16x16x32_bf16 v[160:163], a[200:203], v[40:43], v[160:163]
    s_add_u32 m0, s42, 0
    v_exp_f32 v120, v144
    v_mfma_f32_16x16x32_bf16 v[160:163], a[204:207], v[44:47], v[160:163]
    buffer_load_dwordx4 v112, s[20:23], s40 offen offset:0 lds
    v_mfma_f32_16x16x32_bf16 v[164:167], a[192:195], v[48:51], v[20:23]
    v_exp_f32 v121, v145
    v_mfma_f32_16x16x32_bf16 v[164:167], a[196:199], v[52:55], v[164:167]
    ds_read_b64_tr_b16 a[238:239], v105 offset:12288
    v_cvt_pk_bf16_f32 v194, v120, v121
    v_mfma_f32_16x16x32_bf16 v[164:167], a[200:203], v[56:59], v[164:167]
    v_exp_f32 v122, v146
    v_mfma_f32_16x16x32_bf16 v[164:167], a[204:207], v[60:63], v[164:167]
    buffer_load_dwordx4 v113, s[20:23], s40 offen offset:1024 lds
    v_mfma_f32_16x16x32_bf16 v[168:171], a[192:195], v[64:67], v[24:27]
    s_add_u32 s40, s40, 8192
    v_exp_f32 v123, v147
    v_mfma_f32_16x16x32_bf16 v[168:171], a[196:199], v[68:71], v[168:171]
    ds_read_b64_tr_b16 a[240:241], v106 offset:0
    v_cvt_pk_bf16_f32 v195, v122, v123
    v_mfma_f32_16x16x32_bf16 v[168:171], a[200:203], v[72:75], v[168:171]
    v_exp_f32 v116, v132
    v_mfma_f32_16x16x32_bf16 v[168:171], a[204:207], v[76:79], v[168:171]
    ds_read_b64_tr_b16 a[242:243], v106 offset:4096
    v_mfma_f32_16x16x32_bf16 v[172:175], a[192:195], v[80:83], v[28:31]
    v_exp_f32 v117, v133
    v_mfma_f32_16x16x32_bf16 v[172:175], a[196:199], v[84:87], v[172:175]
    ds_read_b64_tr_b16 a[244:245], v106 offset:8192
    v_cvt_pk_bf16_f32 v200, v116, v117
    v_mfma_f32_16x16x32_bf16 v[172:175], a[200:203], v[88:91], v[172:175]
    v_exp_f32 v118, v134
    v_mfma_f32_16x16x32_bf16 v[172:175], a[204:207], v[92:95], v[172:175]
    ds_read_b64_tr_b16 a[246:247], v106 offset:12288
    v_mfma_f32_16x16x32_bf16 v[176:179], a[208:211], v[32:35], v[16:19]
    v_exp_f32 v119, v135
    v_mfma_f32_16x16x32_bf16 v[176:179], a[212:215], v[36:39], v[176:179]
    ds_read_b64_tr_b16 a[248:249], v107 offset:0
    v_cvt_pk_bf16_f32 v201, v118, v119
    v_mfma_f32_16x16x32_bf16 v[176:179], a[216:219], v[40:43], v[176:179]
    v_exp_f32 v120, v148
    v_mfma_f32_16x16x32_bf16 v[176:179], a[220:223], v[44:47], v[176:179]
    ds_read_b64_tr_b16 a[250:251], v107 offset:4096
    v_mfma_f32_16x16x32_bf16 v[180:183], a[208:211], v[48:51], v[20:23]
    v_exp_f32 v121, v149
    v_mfma_f32_16x16x32_bf16 v[180:183], a[212:215], v[52:55], v[180:183]
    ds_read_b64_tr_b16 a[252:253], v107 offset:8192
    v_cvt_pk_bf16_f32 v202, v120, v121
    v_mfma_f32_16x16x32_bf16 v[180:183], a[216:219], v[56:59], v[180:183]
    v_exp_f32 v122, v150
    v_mfma_f32_16x16x32_bf16 v[180:183], a[220:223], v[60:63], v[180:183]
    ds_read_b64_tr_b16 a[254:255], v107 offset:12288
    v_mfma_f32_16x16x32_bf16 v[184:187], a[208:211], v[64:67], v[24:27]
    v_exp_f32 v123, v151
    v_mfma_f32_16x16x32_bf16 v[184:187], a[212:215], v[68:71], v[184:187]
    v_cvt_pk_bf16_f32 v203, v122, v123
    v_mfma_f32_16x16x32_bf16 v[184:187], a[216:219], v[72:75], v[184:187]
    s_waitcnt vmcnt(12)
    s_barrier
    v_mfma_f32_16x16x32_bf16 v[184:187], a[220:223], v[76:79], v[184:187]
    v_exp_f32 v116, v136
    v_mfma_f32_16x16x32_bf16 v[188:191], a[208:211], v[80:83], v[28:31]
    ds_read_b128 a[192:195], v100 offset:32768
    v_mfma_f32_16x16x32_bf16 v[188:191], a[212:215], v[84:87], v[188:191]
    s_add_u32 m0, s42, 114688
    v_exp_f32 v117, v137
    v_mfma_f32_16x16x32_bf16 v[188:191], a[216:219], v[88:91], v[188:191]
    ds_read_b128 a[196:199], v101 offset:32768
    v_cvt_pk_bf16_f32 v208, v116, v117
    v_mfma_f32_16x16x32_bf16 v[188:191], a[220:223], v[92:95], v[188:191]
    v_exp_f32 v118, v138
    v_smfmac_f32_16x16x64_bf16 a[144:147], a[160:163], v[224:231], v0
    s_waitcnt lgkmcnt(10)
    ds_read_b128 a[200:203], v102 offset:32768
    v_smfmac_f32_16x16x64_bf16 a[148:151], a[160:163], v[232:239], v0
    ds_read_b128 a[204:207], v103 offset:32768
    v_mfma_f32_16x16x32_bf16 a[0:3], a[224:227], v[224:227], a[0:3]
    v_exp_f32 v119, v139
    v_mfma_f32_16x16x32_bf16 a[0:3], a[228:231], v[228:231], a[0:3]
    ds_read_b128 a[208:211], v100 offset:36864
    v_cvt_pk_bf16_f32 v209, v118, v119
    v_mfma_f32_16x16x32_bf16 a[4:7], a[224:227], v[232:235], a[4:7]
    v_exp_f32 v120, v152
    v_mfma_f32_16x16x32_bf16 a[4:7], a[228:231], v[236:239], a[4:7]
    buffer_load_dwordx4 v114, s[24:27], s50 offen offset:0 lds
    v_mfma_f32_16x16x32_bf16 a[8:11], a[224:227], v[240:243], a[8:11]
    v_exp_f32 v121, v153
    v_mfma_f32_16x16x32_bf16 a[8:11], a[228:231], v[244:247], a[8:11]
    ds_read_b128 a[212:215], v101 offset:36864
    v_cvt_pk_bf16_f32 v210, v120, v121
    v_mfma_f32_16x16x32_bf16 a[12:15], a[224:227], v[248:251], a[12:15]
    v_exp_f32 v122, v154
    v_mfma_f32_16x16x32_bf16 a[12:15], a[228:231], v[252:255], a[12:15]
    buffer_load_dwordx4 v125, s[24:27], s50 offen offset:1024 lds
    v_mfma_f32_16x16x32_bf16 a[16:19], a[232:235], v[224:227], a[16:19]
    s_add_u32 s50, s50, 8192
    v_exp_f32 v123, v155
    v_mfma_f32_16x16x32_bf16 a[16:19], a[236:239], v[228:231], a[16:19]
    ds_read_b128 a[216:219], v102 offset:36864
    v_cvt_pk_bf16_f32 v211, v122, v123
    v_mfma_f32_16x16x32_bf16 a[20:23], a[232:235], v[232:235], a[20:23]
    v_exp_f32 v116, v140
    v_mfma_f32_16x16x32_bf16 a[20:23], a[236:239], v[236:239], a[20:23]
    ds_read_b128 a[220:223], v103 offset:36864
    v_mfma_f32_16x16x32_bf16 a[24:27], a[232:235], v[240:243], a[24:27]
    v_exp_f32 v117, v141
    v_mfma_f32_16x16x32_bf16 a[24:27], a[236:239], v[244:247], a[24:27]
    s_waitcnt lgkmcnt(8)
    v_cvt_pk_bf16_f32 v216, v116, v117
    v_mfma_f32_16x16x32_bf16 a[28:31], a[232:235], v[248:251], a[28:31]
    v_exp_f32 v118, v142
    v_mfma_f32_16x16x32_bf16 a[28:31], a[236:239], v[252:255], a[28:31]
    ds_read_b64_tr_b16 a[224:225], v108 offset:0
    v_mfma_f32_16x16x32_bf16 a[32:35], a[240:243], v[224:227], a[32:35]
    v_exp_f32 v119, v143
    v_mfma_f32_16x16x32_bf16 a[32:35], a[244:247], v[228:231], a[32:35]
    ds_read_b64_tr_b16 a[226:227], v108 offset:4096
    v_cvt_pk_bf16_f32 v217, v118, v119
    v_mfma_f32_16x16x32_bf16 a[36:39], a[240:243], v[232:235], a[36:39]
    v_exp_f32 v120, v156
    v_mfma_f32_16x16x32_bf16 a[36:39], a[244:247], v[236:239], a[36:39]
    buffer_load_dword v15, v115, s[88:91], s67 offen
    v_mfma_f32_16x16x32_bf16 a[40:43], a[240:243], v[240:243], a[40:43]
    s_add_u32 s67, s67, 512
    v_exp_f32 v121, v157
    v_mfma_f32_16x16x32_bf16 a[40:43], a[244:247], v[244:247], a[40:43]
    ds_read_b64_tr_b16 a[228:229], v108 offset:8192
    v_cvt_pk_bf16_f32 v218, v120, v121
    v_mfma_f32_16x16x32_bf16 a[44:47], a[240:243], v[248:251], a[44:47]
    v_exp_f32 v122, v158
    v_mfma_f32_16x16x32_bf16 a[44:47], a[244:247], v[252:255], a[44:47]
    ds_read_b64_tr_b16 a[230:231], v108 offset:12288
    v_mfma_f32_16x16x32_bf16 a[48:51], a[248:251], v[224:227], a[48:51]
    v_exp_f32 v123, v159
    v_mfma_f32_16x16x32_bf16 a[48:51], a[252:255], v[228:231], a[48:51]
    ds_read_b64_tr_b16 a[232:233], v109 offset:0
    v_cvt_pk_bf16_f32 v219, v122, v123
    v_mfma_f32_16x16x32_bf16 a[52:55], a[248:251], v[232:235], a[52:55]
    v_exp_f32 v116, v160
    v_mfma_f32_16x16x32_bf16 a[52:55], a[252:255], v[236:239], a[52:55]
    ds_read_b64_tr_b16 a[234:235], v109 offset:4096
    v_mfma_f32_16x16x32_bf16 a[56:59], a[248:251], v[240:243], a[56:59]
    v_exp_f32 v117, v161
    v_mfma_f32_16x16x32_bf16 a[56:59], a[252:255], v[244:247], a[56:59]
    v_cvt_pk_bf16_f32 v196, v116, v117
    v_mfma_f32_16x16x32_bf16 a[60:63], a[248:251], v[248:251], a[60:63]
    s_waitcnt lgkmcnt(6)
    v_exp_f32 v118, v162
    v_mfma_f32_16x16x32_bf16 a[60:63], a[252:255], v[252:255], a[60:63]
    v_mfma_f32_16x16x32_bf16 v[128:131], a[192:195], v[32:35], v[16:19]
    v_exp_f32 v119, v163
    v_mfma_f32_16x16x32_bf16 v[128:131], a[196:199], v[36:39], v[128:131]
    ds_read_b64_tr_b16 a[236:237], v109 offset:8192
    v_cvt_pk_bf16_f32 v197, v118, v119
    v_mfma_f32_16x16x32_bf16 v[128:131], a[200:203], v[40:43], v[128:131]
    s_add_u32 m0, s42, 8192
    v_exp_f32 v120, v176
    v_mfma_f32_16x16x32_bf16 v[128:131], a[204:207], v[44:47], v[128:131]
    buffer_load_dwordx4 v112, s[20:23], s40 offen offset:0 lds
    v_mfma_f32_16x16x32_bf16 v[132:135], a[192:195], v[48:51], v[20:23]
    v_exp_f32 v121, v177
    v_mfma_f32_16x16x32_bf16 v[132:135], a[196:199], v[52:55], v[132:135]
    ds_read_b64_tr_b16 a[238:239], v109 offset:12288
    v_cvt_pk_bf16_f32 v198, v120, v121
    v_mfma_f32_16x16x32_bf16 v[132:135], a[200:203], v[56:59], v[132:135]
    v_exp_f32 v122, v178
    v_mfma_f32_16x16x32_bf16 v[132:135], a[204:207], v[60:63], v[132:135]
    buffer_load_dwordx4 v113, s[20:23], s40 offen offset:1024 lds
    v_mfma_f32_16x16x32_bf16 v[136:139], a[192:195], v[64:67], v[24:27]
    s_add_u32 s40, s40, 8192
    v_exp_f32 v123, v179
    v_mfma_f32_16x16x32_bf16 v[136:139], a[196:199], v[68:71], v[136:139]
    ds_read_b64_tr_b16 a[240:241], v110 offset:0
    v_cvt_pk_bf16_f32 v199, v122, v123
    v_mfma_f32_16x16x32_bf16 v[136:139], a[200:203], v[72:75], v[136:139]
    v_exp_f32 v116, v164
    v_mfma_f32_16x16x32_bf16 v[136:139], a[204:207], v[76:79], v[136:139]
    ds_read_b64_tr_b16 a[242:243], v110 offset:4096
    v_mfma_f32_16x16x32_bf16 v[140:143], a[192:195], v[80:83], v[28:31]
    v_exp_f32 v117, v165
    v_mfma_f32_16x16x32_bf16 v[140:143], a[196:199], v[84:87], v[140:143]
    ds_read_b64_tr_b16 a[244:245], v110 offset:8192
    v_cvt_pk_bf16_f32 v204, v116, v117
    v_mfma_f32_16x16x32_bf16 v[140:143], a[200:203], v[88:91], v[140:143]
    v_exp_f32 v118, v166
    v_mfma_f32_16x16x32_bf16 v[140:143], a[204:207], v[92:95], v[140:143]
    ds_read_b64_tr_b16 a[246:247], v110 offset:12288
    v_mfma_f32_16x16x32_bf16 v[144:147], a[208:211], v[32:35], v[16:19]
    v_exp_f32 v119, v167
    v_mfma_f32_16x16x32_bf16 v[144:147], a[212:215], v[36:39], v[144:147]
    ds_read_b64_tr_b16 a[248:249], v111 offset:0
    v_cvt_pk_bf16_f32 v205, v118, v119
    v_mfma_f32_16x16x32_bf16 v[144:147], a[216:219], v[40:43], v[144:147]
    v_exp_f32 v120, v180
    v_mfma_f32_16x16x32_bf16 v[144:147], a[220:223], v[44:47], v[144:147]
    ds_read_b64_tr_b16 a[250:251], v111 offset:4096
    v_mfma_f32_16x16x32_bf16 v[148:151], a[208:211], v[48:51], v[20:23]
    v_exp_f32 v121, v181
    v_mfma_f32_16x16x32_bf16 v[148:151], a[212:215], v[52:55], v[148:151]
    ds_read_b64_tr_b16 a[252:253], v111 offset:8192
    v_cvt_pk_bf16_f32 v206, v120, v121
    v_mfma_f32_16x16x32_bf16 v[148:151], a[216:219], v[56:59], v[148:151]
    v_exp_f32 v122, v182
    v_mfma_f32_16x16x32_bf16 v[148:151], a[220:223], v[60:63], v[148:151]
    ds_read_b64_tr_b16 a[254:255], v111 offset:12288
    v_mfma_f32_16x16x32_bf16 v[152:155], a[208:211], v[64:67], v[24:27]
    v_exp_f32 v123, v183
    v_mfma_f32_16x16x32_bf16 v[152:155], a[212:215], v[68:71], v[152:155]
    ds_read_b128 a[192:195], v100 offset:40960
    v_cvt_pk_bf16_f32 v207, v122, v123
    v_mfma_f32_16x16x32_bf16 v[152:155], a[216:219], v[72:75], v[152:155]
    ds_read_b128 a[196:199], v101 offset:40960
    v_mfma_f32_16x16x32_bf16 v[152:155], a[220:223], v[76:79], v[152:155]
    v_exp_f32 v116, v168
    v_mfma_f32_16x16x32_bf16 v[156:159], a[208:211], v[80:83], v[28:31]
    ds_read_b128 a[200:203], v102 offset:40960
    v_mfma_f32_16x16x32_bf16 v[156:159], a[212:215], v[84:87], v[156:159]
    s_add_u32 m0, s42, 122880
    v_exp_f32 v117, v169
    v_mfma_f32_16x16x32_bf16 v[156:159], a[216:219], v[88:91], v[156:159]
    ds_read_b128 a[204:207], v103 offset:40960
    v_cvt_pk_bf16_f32 v212, v116, v117
    v_mfma_f32_16x16x32_bf16 v[156:159], a[220:223], v[92:95], v[156:159]
    v_exp_f32 v118, v170
    v_smfmac_f32_16x16x64_bf16 a[152:155], a[160:163], v[240:247], v0
    s_waitcnt lgkmcnt(12)
    ds_read_b128 a[208:211], v100 offset:45056
    v_smfmac_f32_16x16x64_bf16 a[156:159], a[160:163], v[248:255], v0
    ds_read_b128 a[212:215], v101 offset:45056
    v_mfma_f32_16x16x32_bf16 a[64:67], a[224:227], v[224:227], a[64:67]
    v_exp_f32 v119, v171
    v_mfma_f32_16x16x32_bf16 a[64:67], a[228:231], v[228:231], a[64:67]
    ds_read_b128 a[216:219], v102 offset:45056
    v_cvt_pk_bf16_f32 v213, v118, v119
    v_mfma_f32_16x16x32_bf16 a[68:71], a[224:227], v[232:235], a[68:71]
    v_exp_f32 v120, v184
    v_mfma_f32_16x16x32_bf16 a[68:71], a[228:231], v[236:239], a[68:71]
    buffer_load_dwordx4 v114, s[24:27], s50 offen offset:0 lds
    v_mfma_f32_16x16x32_bf16 a[72:75], a[224:227], v[240:243], a[72:75]
    v_exp_f32 v121, v185
    v_mfma_f32_16x16x32_bf16 a[72:75], a[228:231], v[244:247], a[72:75]
    ds_read_b128 a[220:223], v103 offset:45056
    v_cvt_pk_bf16_f32 v214, v120, v121
    v_mfma_f32_16x16x32_bf16 a[76:79], a[224:227], v[248:251], a[76:79]
    v_exp_f32 v122, v186
    v_mfma_f32_16x16x32_bf16 a[76:79], a[228:231], v[252:255], a[76:79]
    buffer_load_dwordx4 v125, s[24:27], s50 offen offset:1024 lds
    v_mfma_f32_16x16x32_bf16 a[80:83], a[232:235], v[224:227], a[80:83]
    s_add_u32 s50, s50, 8192
    v_exp_f32 v123, v187
    v_mfma_f32_16x16x32_bf16 a[80:83], a[236:239], v[228:231], a[80:83]
    v_cvt_pk_bf16_f32 v215, v122, v123
    v_mfma_f32_16x16x32_bf16 a[84:87], a[232:235], v[232:235], a[84:87]
    v_exp_f32 v116, v172
    v_mfma_f32_16x16x32_bf16 a[84:87], a[236:239], v[236:239], a[84:87]
    v_mfma_f32_16x16x32_bf16 a[88:91], a[232:235], v[240:243], a[88:91]
    v_exp_f32 v117, v173
    v_mfma_f32_16x16x32_bf16 a[88:91], a[236:239], v[244:247], a[88:91]
    s_waitcnt lgkmcnt(8)
    v_cvt_pk_bf16_f32 v220, v116, v117
    v_mfma_f32_16x16x32_bf16 a[92:95], a[232:235], v[248:251], a[92:95]
    v_exp_f32 v118, v174
    v_mfma_f32_16x16x32_bf16 a[92:95], a[236:239], v[252:255], a[92:95]
    ds_read_b64_tr_b16 a[224:225], v104 offset:16384
    v_mfma_f32_16x16x32_bf16 a[96:99], a[240:243], v[224:227], a[96:99]
    v_exp_f32 v119, v175
    v_mfma_f32_16x16x32_bf16 a[96:99], a[244:247], v[228:231], a[96:99]
    ds_read_b64_tr_b16 a[226:227], v104 offset:20480
    v_cvt_pk_bf16_f32 v221, v118, v119
    v_mfma_f32_16x16x32_bf16 a[100:103], a[240:243], v[232:235], a[100:103]
    v_exp_f32 v120, v188
    v_mfma_f32_16x16x32_bf16 a[100:103], a[244:247], v[236:239], a[100:103]
    ds_read_b64_tr_b16 a[228:229], v104 offset:24576
    v_mfma_f32_16x16x32_bf16 a[104:107], a[240:243], v[240:243], a[104:107]
    v_exp_f32 v121, v189
    v_mfma_f32_16x16x32_bf16 a[104:107], a[244:247], v[244:247], a[104:107]
    ds_read_b64_tr_b16 a[230:231], v104 offset:28672
    v_cvt_pk_bf16_f32 v222, v120, v121
    v_mfma_f32_16x16x32_bf16 a[108:111], a[240:243], v[248:251], a[108:111]
    v_exp_f32 v122, v190
    v_mfma_f32_16x16x32_bf16 a[108:111], a[244:247], v[252:255], a[108:111]
    ds_read_b64_tr_b16 a[232:233], v105 offset:16384
    v_mfma_f32_16x16x32_bf16 a[112:115], a[248:251], v[224:227], a[112:115]
    v_exp_f32 v123, v191
    v_mfma_f32_16x16x32_bf16 a[112:115], a[252:255], v[228:231], a[112:115]
    ds_read_b64_tr_b16 a[234:235], v105 offset:20480
    v_cvt_pk_bf16_f32 v223, v122, v123
    v_mfma_f32_16x16x32_bf16 a[116:119], a[248:251], v[232:235], a[116:119]
    s_sub_u32 s39, s39, 1
    v_exp_f32 v116, v128
    v_mfma_f32_16x16x32_bf16 a[116:119], a[252:255], v[236:239], a[116:119]
    v_mfma_f32_16x16x32_bf16 a[120:123], a[248:251], v[240:243], a[120:123]
    v_exp_f32 v117, v129
    v_mfma_f32_16x16x32_bf16 a[120:123], a[252:255], v[244:247], a[120:123]
    v_cvt_pk_bf16_f32 v224, v116, v117
    v_mfma_f32_16x16x32_bf16 a[124:127], a[248:251], v[248:251], a[124:127]
    s_waitcnt lgkmcnt(6)
    v_exp_f32 v118, v130
    v_mfma_f32_16x16x32_bf16 a[124:127], a[252:255], v[252:255], a[124:127]
    s_cbranch_scc0 L_att
L_r2:
    s_cmp_eq_u32 s70, 0
    s_cbranch_scc0 L_att_done
L_hook:
    s_and_b32 s4, s2, 7
    s_lshl_b32 s4, s4, 2
    s_cmp_eq_u32 s3, 0
    s_cselect_b32 s4, s4, 0x40000000
    s_mov_b32 s70, 1
    s_mov_b32 s39, 5
    buffer_atomic_add v11, v10, s[80:83], s4 offen sc1
    s_branch L_att
L_att_done:
    v_mfma_f32_16x16x32_bf16 v[160:163], a[192:195], v[32:35], v[16:19]
    v_exp_f32 v119, v131
    v_mfma_f32_16x16x32_bf16 v[160:163], a[196:199], v[36:39], v[160:163]
    ds_read_b64_tr_b16 a[236:237], v105 offset:24576
    v_cvt_pk_bf16_f32 v225, v118, v119
    v_mfma_f32_16x16x32_bf16 v[160:163], a[200:203], v[40:43], v[160:163]
    v_exp_f32 v120, v144
    v_mfma_f32_16x16x32_bf16 v[160:163], a[204:207], v[44:47], v[160:163]
    ds_read_b64_tr_b16 a[238:239], v105 offset:28672
    buffer_load_dword v2, v9, s[80:83], 0 offen sc1
    v_mfma_f32_16x16x32_bf16 v[164:167], a[192:195], v[48:51], v[20:23]
    v_exp_f32 v121, v145
    v_mfma_f32_16x16x32_bf16 v[164:167], a[196:199], v[52:55], v[164:167]
    ds_read_b64_tr_b16 a[240:241], v106 offset:16384
    v_cvt_pk_bf16_f32 v226, v120, v121
    v_mfma_f32_16x16x32_bf16 v[164:167], a[200:203], v[56:59], v[164:167]
    v_exp_f32 v122, v146
    v_mfma_f32_16x16x32_bf16 v[164:167], a[204:207], v[60:63], v[164:167]
    ds_read_b64_tr_b16 a[242:243], v106 offset:20480
    v_mfma_f32_16x16x32_bf16 v[168:171], a[192:195], v[64:67], v[24:27]
    s_mov_b64 s[66:67], 3
    v_exp_f32 v123, v147
    v_mfma_f32_16x16x32_bf16 v[168:171], a[196:199], v[68:71], v[168:171]
    ds_read_b64_tr_b16 a[244:245], v106 offset:24576
    v_cvt_pk_bf16_f32 v227, v122, v123
    v_mfma_f32_16x16x32_bf16 v[168:171], a[200:203], v[72:75], v[168:171]
    v_exp_f32 v116, v132
    v_mfma_f32_16x16x32_bf16 v[168:171], a[204:207], v[76:79], v[168:171]
    ds_read_b64_tr_b16 a[246:247], v106 offset:28672
    v_mfma_f32_16x16x32_bf16 v[172:175], a[192:195], v[80:83], v[28:31]
    v_exp_f32 v117, v133
    v_mfma_f32_16x16x32_bf16 v[172:175], a[196:199], v[84:87], v[172:175]
    ds_read_b64_tr_b16 a[248:249], v107 offset:16384
    v_cvt_pk_bf16_f32 v232, v116, v117
    v_mfma_f32_16x16x32_bf16 v[172:175], a[200:203], v[88:91], v[172:175]
    v_exp_f32 v118, v134
    v_mfma_f32_16x16x32_bf16 v[172:175], a[204:207], v[92:95], v[172:175]
    ds_read_b64_tr_b16 a[250:251], v107 offset:20480
    v_mfma_f32_16x16x32_bf16 v[176:179], a[208:211], v[32:35], v[16:19]
    v_exp_f32 v119, v135
    v_mfma_f32_16x16x32_bf16 v[176:179], a[212:215], v[36:39], v[176:179]
    ds_read_b64_tr_b16 a[252:253], v107 offset:24576
    v_cvt_pk_bf16_f32 v233, v118, v119
    v_mfma_f32_16x16x32_bf16 v[176:179], a[216:219], v[40:43], v[176:179]
    v_exp_f32 v120, v148
    v_mfma_f32_16x16x32_bf16 v[176:179], a[220:223], v[44:47], v[176:179]
    ds_read_b64_tr_b16 a[254:255], v107 offset:28672
    v_mfma_f32_16x16x32_bf16 v[180:183], a[208:211], v[48:51], v[20:23]
    v_exp_f32 v121, v149
    v_mfma_f32_16x16x32_bf16 v[180:183], a[212:215], v[52:55], v[180:183]
    v_cvt_pk_bf16_f32 v234, v120, v121
    v_mfma_f32_16x16x32_bf16 v[180:183], a[216:219], v[56:59], v[180:183]
    v_exp_f32 v122, v150
    v_mfma_f32_16x16x32_bf16 v[180:183], a[220:223], v[60:63], v[180:183]
    v_mfma_f32_16x16x32_bf16 v[184:187], a[208:211], v[64:67], v[24:27]
    v_exp_f32 v123, v151
    v_mfma_f32_16x16x32_bf16 v[184:187], a[212:215], v[68:71], v[184:187]
    v_cvt_pk_bf16_f32 v235, v122, v123
    v_mfma_f32_16x16x32_bf16 v[184:187], a[216:219], v[72:75], v[184:187]
    s_waitcnt vmcnt(11)
    s_barrier
    v_mfma_f32_16x16x32_bf16 v[184:187], a[220:223], v[76:79], v[184:187]
    v_exp_f32 v116, v136
    v_mfma_f32_16x16x32_bf16 v[188:191], a[208:211], v[80:83], v[28:31]
    ds_read_b128 a[192:195], v100 offset:49152
    v_mfma_f32_16x16x32_bf16 v[188:191], a[212:215], v[84:87], v[188:191]
    v_exp_f32 v117, v137
    v_mfma_f32_16x16x32_bf16 v[188:191], a[216:219], v[88:91], v[188:191]
    ds_read_b128 a[196:199], v101 offset:49152
    v_cvt_pk_bf16_f32 v240, v116, v117
    v_mfma_f32_16x16x32_bf16 v[188:191], a[220:223], v[92:95], v[188:191]
    v_exp_f32 v118, v138
    v_smfmac_f32_16x16x64_bf16 a[144:147], a[160:163], v[192:199], v0
    s_waitcnt lgkmcnt(10)
    ds_read_b128 a[200:203], v102 offset:49152
    v_smfmac_f32_16x16x64_bf16 a[148:151], a[160:163], v[200:207], v0
    ds_read_b128 a[204:207], v103 offset:49152
    v_mfma_f32_16x16x32_bf16 a[0:3], a[224:227], v[192:195], a[0:3]
    v_exp_f32 v119, v139
    v_mfma_f32_16x16x32_bf16 a[0:3], a[228:231], v[196:199], a[0:3]
    ds_read_b128 a[208:211], v100 offset:53248
    v_cvt_pk_bf16_f32 v241, v118, v119
    v_mfma_f32_16x16x32_bf16 a[4:7], a[224:227], v[200:203], a[4:7]
    v_exp_f32 v120, v152
    v_mfma_f32_16x16x32_bf16 a[4:7], a[228:231], v[204:207], a[4:7]
    ds_read_b128 a[212:215], v101 offset:53248
    v_mfma_f32_16x16x32_bf16 a[8:11], a[224:227], v[208:211], a[8:11]
    v_exp_f32 v121, v153
    v_mfma_f32_16x16x32_bf16 a[8:11], a[228:231], v[212:215], a[8:11]
    ds_read_b128 a[216:219], v102 offset:53248
    v_cvt_pk_bf16_f32 v242, v120, v121
    v_mfma_f32_16x16x32_bf16 a[12:15], a[224:227], v[216:219], a[12:15]
    v_exp_f32 v122, v154
    v_mfma_f32_16x16x32_bf16 a[12:15], a[228:231], v[220:223], a[12:15]
    ds_read_b128 a[220:223], v103 offset:53248
    v_mfma_f32_16x16x32_bf16 a[16:19], a[232:235], v[192:195], a[16:19]
    v_exp_f32 v123, v155
    v_mfma_f32_16x16x32_bf16 a[16:19], a[236:239], v[196:199], a[16:19]
    v_cvt_pk_bf16_f32 v243, v122, v123
    v_mfma_f32_16x16x32_bf16 a[20:23], a[232:235], v[200:203], a[20:23]
    v_exp_f32 v116, v140
    v_mfma_f32_16x16x32_bf16 a[20:23], a[236:239], v[204:207], a[20:23]
    v_mfma_f32_16x16x32_bf16 a[24:27], a[232:235], v[208:211], a[24:27]
    v_exp_f32 v117, v141
    v_mfma_f32_16x16x32_bf16 a[24:27], a[236:239], v[212:215], a[24:27]
    s_waitcnt lgkmcnt(8)
    v_cvt_pk_bf16_f32 v248, v116, v117
    v_mfma_f32_16x16x32_bf16 a[28:31], a[232:235], v[216:219], a[28:31]
    v_exp_f32 v118, v142
    v_mfma_f32_16x16x32_bf16 a[28:31], a[236:239], v[220:223], a[28:31]
    ds_read_b64_tr_b16 a[224:225], v108 offset:16384
    v_mfma_f32_16x16x32_bf16 a[32:35], a[240:243], v[192:195], a[32:35]
    v_exp_f32 v119, v143
    v_mfma_f32_16x16x32_bf16 a[32:35], a[244:247], v[196:199], a[32:35]
    ds_read_b64_tr_b16 a[226:227], v108 offset:20480
    v_cvt_pk_bf16_f32 v249, v118, v119
    v_mfma_f32_16x16x32_bf16 a[36:39], a[240:243], v[200:203], a[36:39]
    v_exp_f32 v120, v156
    v_mfma_f32_16x16x32_bf16 a[36:39], a[244:247], v[204:207], a[36:39]
    ds_read_b64_tr_b16 a[228:229], v108 offset:24576
    v_mfma_f32_16x16x32_bf16 a[40:43], a[240:243], v[208:211], a[40:43]
    v_exp_f32 v121, v157
    v_mfma_f32_16x16x32_bf16 a[40:43], a[244:247], v[212:215], a[40:43]
    ds_read_b64_tr_b16 a[230:231], v108 offset:28672
    v_cvt_pk_bf16_f32 v250, v120, v121
    v_mfma_f32_16x16x32_bf16 a[44:47], a[240:243], v[216:219], a[44:47]
    v_exp_f32 v122, v158
    v_mfma_f32_16x16x32_bf16 a[44:47], a[244:247], v[220:223], a[44:47]
    ds_read_b64_tr_b16 a[232:233], v109 offset:16384
    v_mfma_f32_16x16x32_bf16 a[48:51], a[248:251], v[192:195], a[48:51]
    v_exp_f32 v123, v159
    v_mfma_f32_16x16x32_bf16 a[48:51], a[252:255], v[196:199], a[48:51]
    ds_read_b64_tr_b16 a[234:235], v109 offset:20480
    v_cvt_pk_bf16_f32 v251, v122, v123
    v_mfma_f32_16x16x32_bf16 a[52:55], a[248:251], v[200:203], a[52:55]
    v_exp_f32 v116, v160
    v_mfma_f32_16x16x32_bf16 a[52:55], a[252:255], v[204:207], a[52:55]
    v_mfma_f32_16x16x32_bf16 a[56:59], a[248:251], v[208:211], a[56:59]
    v_exp_f32 v117, v161
    v_mfma_f32_16x16x32_bf16 a[56:59], a[252:255], v[212:215], a[56:59]
    v_cvt_pk_bf16_f32 v228, v116, v117
    v_mfma_f32_16x16x32_bf16 a[60:63], a[248:251], v[216:219], a[60:63]
    s_waitcnt lgkmcnt(6)
    v_exp_f32 v118, v162
    v_mfma_f32_16x16x32_bf16 a[60:63], a[252:255], v[220:223], a[60:63]
    v_mfma_f32_16x16x32_bf16 v[128:131], a[192:195], v[32:35], v[16:19]
    s_waitcnt vmcnt(0)
    v_exp_f32 v119, v163
    v_mfma_f32_16x16x32_bf16 v[128:131], a[196:199], v[36:39], v[128:131]
    ds_read_b64_tr_b16 a[236:237], v109 offset:24576
    v_cvt_pk_bf16_f32 v229, v118, v119
    v_mfma_f32_16x16x32_bf16 v[128:131], a[200:203], v[40:43], v[128:131]
    v_exp_f32 v120, v176
    v_mfma_f32_16x16x32_bf16 v[128:131], a[204:207], v[44:47], v[128:131]
    ds_read_b64_tr_b16 a[238:239], v109 offset:28672
    v_cmp_eq_u32 vcc, 32, v2
    v_mfma_f32_16x16x32_bf16 v[132:135], a[192:195], v[48:51], v[20:23]
    s_and_b32 s4, vcc_lo, 0xff
    v_exp_f32 v121, v177
    v_mfma_f32_16x16x32_bf16 v[132:135], a[196:199], v[52:55], v[132:135]
    s_cmp_eq_u32 s4, 0xff
    ds_read_b64_tr_b16 a[240:241], v110 offset:16384
    v_cvt_pk_bf16_f32 v230, v120, v121
    v_mfma_f32_16x16x32_bf16 v[132:135], a[200:203], v[56:59], v[132:135]
    s_cbranch_scc0 L_cnt_wait
    v_exp_f32 v122, v178
    v_mfma_f32_16x16x32_bf16 v[132:135], a[204:207], v[60:63], v[132:135]
L_cnt_ok:
    ds_read_b64_tr_b16 a[242:243], v110 offset:20480
    v_readlane_b32 s34, v3, 0
    v_mfma_f32_16x16x32_bf16 v[136:139], a[192:195], v[64:67], v[24:27]
    v_exp_f32 v123, v179
    v_mfma_f32_16x16x32_bf16 v[136:139], a[196:199], v[68:71], v[136:139]
    ds_read_b64_tr_b16 a[244:245], v110 offset:24576
    v_cvt_pk_bf16_f32 v231, v122, v123
    v_mfma_f32_16x16x32_bf16 v[136:139], a[200:203], v[72:75], v[136:139]
    v_exp_f32 v116, v164
    v_mfma_f32_16x16x32_bf16 v[136:139], a[204:207], v[76:79], v[136:139]
    ds_read_b64_tr_b16 a[246:247], v110 offset:28672
    v_and_b32 v9, 4, v9
    v_mfma_f32_16x16x32_bf16 v[140:143], a[192:195], v[80:83], v[28:31]
    s_waitcnt lgkmcnt(15)
    v_exp_f32 v117, v165
    v_mfma_f32_16x16x32_bf16 v[140:143], a[196:199], v[84:87], v[140:143]
    ds_read_b64_tr_b16 a[248:249], v111 offset:16384
    v_cvt_pk_bf16_f32 v236, v116, v117
    v_mfma_f32_16x16x32_bf16 v[140:143], a[200:203], v[88:91], v[140:143]
    v_exp_f32 v118, v166
    v_mfma_f32_16x16x32_bf16 v[140:143], a[204:207], v[92:95], v[140:143]
    ds_read_b64_tr_b16 a[250:251], v111 offset:20480
    v_lshl_add_u32 v9, v8, 3, v9
    v_cmp_gt_u32 vcc, 32, v6
    v_mfma_f32_16x16x32_bf16 v[144:147], a[208:211], v[32:35], v[16:19]
    v_mov_b32 v8, 0x40000000
    v_exp_f32 v119, v167
    v_mfma_f32_16x16x32_bf16 v[144:147], a[212:215], v[36:39], v[144:147]
    s_add_u32 s32, s36, s34
    ds_read_b64_tr_b16 a[252:253], v111 offset:24576
    v_cvt_pk_bf16_f32 v237, v118, v119
    v_mfma_f32_16x16x32_bf16 v[144:147], a[216:219], v[40:43], v[144:147]
    v_exp_f32 v120, v180
    v_mfma_f32_16x16x32_bf16 v[144:147], a[220:223], v[44:47], v[144:147]
    ds_read_b64_tr_b16 a[254:255], v111 offset:28672
    v_cndmask_b32 v9, v8, v9, vcc
    v_mfma_f32_16x16x32_bf16 v[148:151], a[208:211], v[48:51], v[20:23]
    s_lshl3_add_u32 s33, s32, s35
    v_exp_f32 v121, v181
    v_mfma_f32_16x16x32_bf16 v[148:151], a[212:215], v[52:55], v[148:151]
    ds_read_b128 a[192:195], v100 offset:57344
    v_cvt_pk_bf16_f32 v238, v120, v121
    v_mfma_f32_16x16x32_bf16 v[148:151], a[216:219], v[56:59], v[148:151]
    v_exp_f32 v122, v182
    v_mfma_f32_16x16x32_bf16 v[148:151], a[220:223], v[60:63], v[148:151]
    ds_read_b128 a[196:199], v101 offset:57344
    v_mov_b32 v8, 0
    v_mfma_f32_16x16x32_bf16 v[152:155], a[208:211], v[64:67], v[24:27]
    v_exp_f32 v123, v183
    v_mfma_f32_16x16x32_bf16 v[152:155], a[212:215], v[68:71], v[152:155]
    ds_read_b128 a[200:203], v102 offset:57344
    v_cvt_pk_bf16_f32 v239, v122, v123
    v_mfma_f32_16x16x32_bf16 v[152:155], a[216:219], v[72:75], v[152:155]
    ds_read_b128 a[204:207], v103 offset:57344
    v_mfma_f32_16x16x32_bf16 v[152:155], a[220:223], v[76:79], v[152:155]
    v_exp_f32 v116, v168
    v_mfma_f32_16x16x32_bf16 v[156:159], a[208:211], v[80:83], v[28:31]
    v_mfma_f32_16x16x32_bf16 v[156:159], a[212:215], v[84:87], v[156:159]
    v_exp_f32 v117, v169
    v_mfma_f32_16x16x32_bf16 v[156:159], a[216:219], v[88:91], v[156:159]
    v_cvt_pk_bf16_f32 v244, v116, v117
    v_mfma_f32_16x16x32_bf16 v[156:159], a[220:223], v[92:95], v[156:159]
    v_exp_f32 v118, v170
    v_smfmac_f32_16x16x64_bf16 a[152:155], a[160:163], v[208:215], v0
    s_waitcnt lgkmcnt(12)
    ds_read_b128 a[208:211], v100 offset:61440
    v_smfmac_f32_16x16x64_bf16 a[156:159], a[160:163], v[216:223], v0
    ds_read_b128 a[212:215], v101 offset:61440
    v_mfma_f32_16x16x32_bf16 a[64:67], a[224:227], v[192:195], a[64:67]
    v_exp_f32 v119, v171
    v_mfma_f32_16x16x32_bf16 a[64:67], a[228:231], v[196:199], a[64:67]
    ds_read_b128 a[216:219], v102 offset:61440
    v_cvt_pk_bf16_f32 v245, v118, v119
    v_mfma_f32_16x16x32_bf16 a[68:71], a[224:227], v[200:203], a[68:71]
    v_exp_f32 v120, v184
    v_mfma_f32_16x16x32_bf16 a[68:71], a[228:231], v[204:207], a[68:71]
    ds_read_b128 a[220:223], v103 offset:61440
    v_mfma_f32_16x16x32_bf16 a[72:75], a[224:227], v[208:211], a[72:75]
    v_exp_f32 v121, v185
    v_mfma_f32_16x16x32_bf16 a[72:75], a[228:231], v[212:215], a[72:75]
    v_cvt_pk_bf16_f32 v246, v120, v121
    v_mfma_f32_16x16x32_bf16 a[76:79], a[224:227], v[216:219], a[76:79]
    v_exp_f32 v122, v186
    v_mfma_f32_16x16x32_bf16 a[76:79], a[228:231], v[220:223], a[76:79]
    v_mfma_f32_16x16x32_bf16 a[80:83], a[232:235], v[192:195], a[80:83]
    v_exp_f32 v123, v187
    v_mfma_f32_16x16x32_bf16 a[80:83], a[236:239], v[196:199], a[80:83]
    v_cvt_pk_bf16_f32 v247, v122, v123
    v_mfma_f32_16x16x32_bf16 a[84:87], a[232:235], v[200:203], a[84:87]
    v_exp_f32 v116, v172
    v_mfma_f32_16x16x32_bf16 a[84:87], a[236:239], v[204:207], a[84:87]
    v_mfma_f32_16x16x32_bf16 a[88:91], a[232:235], v[208:211], a[88:91]
    v_exp_f32 v117, v173
    v_mfma_f32_16x16x32_bf16 a[88:91], a[236:239], v[212:215], a[88:91]
    s_waitcnt lgkmcnt(8)
    v_cvt_pk_bf16_f32 v252, v116, v117
    v_mfma_f32_16x16x32_bf16 a[92:95], a[232:235], v[216:219], a[92:95]
    v_exp_f32 v118, v174
    v_mfma_f32_16x16x32_bf16 a[92:95], a[236:239], v[220:223], a[92:95]
    ds_read_b64_tr_b16 a[224:225], v104 offset:32768
    v_mfma_f32_16x16x32_bf16 a[96:99], a[240:243], v[192:195], a[96:99]
    v_exp_f32 v119, v175
    v_mfma_f32_16x16x32_bf16 a[96:99], a[244:247], v[196:199], a[96:99]
    ds_read_b64_tr_b16 a[226:227], v104 offset:36864
    v_cvt_pk_bf16_f32 v253, v118, v119
    v_mfma_f32_16x16x32_bf16 a[100:103], a[240:243], v[200:203], a[100:103]
    v_exp_f32 v120, v188
    v_mfma_f32_16x16x32_bf16 a[100:103], a[244:247], v[204:207], a[100:103]
    ds_read_b64_tr_b16 a[228:229], v104 offset:40960
    v_mfma_f32_16x16x32_bf16 a[104:107], a[240:243], v[208:211], a[104:107]
    v_exp_f32 v121, v189
    v_mfma_f32_16x16x32_bf16 a[104:107], a[244:247], v[212:215], a[104:107]
    ds_read_b64_tr_b16 a[230:231], v104 offset:45056
    v_cvt_pk_bf16_f32 v254, v120, v121
    v_mfma_f32_16x16x32_bf16 a[108:111], a[240:243], v[216:219], a[108:111]
    s_mov_b32 m0, s53
    v_exp_f32 v122, v190
    v_mfma_f32_16x16x32_bf16 a[108:111], a[244:247], v[220:223], a[108:111]
    ds_read_b64_tr_b16 a[232:233], v105 offset:32768
    v_mfma_f32_16x16x32_bf16 a[112:115], a[248:251], v[192:195], a[112:115]
    v_exp_f32 v123, v191
    v_mfma_f32_16x16x32_bf16 a[112:115], a[252:255], v[196:199], a[112:115]
    ds_read_b64_tr_b16 a[234:235], v105 offset:36864
    v_cvt_pk_bf16_f32 v255, v122, v123
    v_mfma_f32_16x16x32_bf16 a[116:119], a[248:251], v[200:203], a[116:119]
    v_exp_f32 v116, v128
    v_mfma_f32_16x16x32_bf16 a[116:119], a[252:255], v[204:207], a[116:119]
    v_mfma_f32_16x16x32_bf16 a[120:123], a[248:251], v[208:211], a[120:123]
    v_exp_f32 v117, v129
    v_mfma_f32_16x16x32_bf16 a[120:123], a[252:255], v[212:215], a[120:123]
    v_cvt_pk_bf16_f32 v192, v116, v117
    v_mfma_f32_16x16x32_bf16 a[124:127], a[248:251], v[216:219], a[124:127]
    s_waitcnt lgkmcnt(6)
    v_exp_f32 v118, v130
    v_mfma_f32_16x16x32_bf16 a[124:127], a[252:255], v[220:223], a[124:127]
    v_mfma_f32_16x16x32_bf16 v[160:163], a[192:195], v[32:35], v[16:19]
    v_exp_f32 v119, v131
    v_mfma_f32_16x16x32_bf16 v[160:163], a[196:199], v[36:39], v[160:163]
    ds_read_b64_tr_b16 a[236:237], v105 offset:40960
    v_cvt_pk_bf16_f32 v193, v118, v119
    v_mfma_f32_16x16x32_bf16 v[160:163], a[200:203], v[40:43], v[160:163]
    v_exp_f32 v120, v144
    v_mfma_f32_16x16x32_bf16 v[160:163], a[204:207], v[44:47], v[160:163]
    ds_read_b64_tr_b16 a[238:239], v105 offset:45056
    buffer_load_dwordx4 v4, s[12:15], s33 offen offset:0 lds
    v_mfma_f32_16x16x32_bf16 v[164:167], a[192:195], v[48:51], v[20:23]
    v_exp_f32 v121, v145
    v_mfma_f32_16x16x32_bf16 v[164:167], a[196:199], v[52:55], v[164:167]
    ds_read_b64_tr_b16 a[240:241], v106 offset:32768
    v_cvt_pk_bf16_f32 v194, v120, v121
    v_mfma_f32_16x16x32_bf16 v[164:167], a[200:203], v[56:59], v[164:167]
    v_exp_f32 v122, v146
    v_mfma_f32_16x16x32_bf16 v[164:167], a[204:207], v[60:63], v[164:167]
    ds_read_b64_tr_b16 a[242:243], v106 offset:36864
    buffer_load_dwordx4 v5, s[12:15], s33 offen offset:1024 lds
    v_mfma_f32_16x16x32_bf16 v[168:171], a[192:195], v[64:67], v[24:27]
    v_exp_f32 v123, v147
    v_mfma_f32_16x16x32_bf16 v[168:171], a[196:199], v[68:71], v[168:171]
    ds_read_b64_tr_b16 a[244:245], v106 offset:40960
    v_cvt_pk_bf16_f32 v195, v122, v123
    v_mfma_f32_16x16x32_bf16 v[168:171], a[200:203], v[72:75], v[168:171]
    v_exp_f32 v116, v132
    v_mfma_f32_16x16x32_bf16 v[168:171], a[204:207], v[76:79], v[168:171]
    ds_read_b64_tr_b16 a[246:247], v106 offset:45056
    buffer_load_dwordx4 v1, s[8:11], s32 offen offset:2048 sc1 lds
    v_mfma_f32_16x16x32_bf16 v[172:175], a[192:195], v[80:83], v[28:31]
    v_exp_f32 v117, v133
    v_mfma_f32_16x16x32_bf16 v[172:175], a[196:199], v[84:87], v[172:175]
    ds_read_b64_tr_b16 a[248:249], v107 offset:32768
    v_cvt_pk_bf16_f32 v200, v116, v117
    v_mfma_f32_16x16x32_bf16 v[172:175], a[200:203], v[88:91], v[172:175]
    v_exp_f32 v118, v134
    v_mfma_f32_16x16x32_bf16 v[172:175], a[204:207], v[92:95], v[172:175]
    ds_read_b64_tr_b16 a[250:251], v107 offset:36864
    buffer_load_dwordx4 v1, s[8:11], s32 offen offset:3072 sc1 lds
    v_mfma_f32_16x16x32_bf16 v[176:179], a[208:211], v[32:35], v[16:19]
    s_add_u32 s36, s36, 8192
    v_exp_f32 v119, v135
    v_mfma_f32_16x16x32_bf16 v[176:179], a[212:215], v[36:39], v[176:179]
    s_mov_b32 m0, s54
    ds_read_b64_tr_b16 a[252:253], v107 offset:40960
    v_cvt_pk_bf16_f32 v201, v118, v119
    v_mfma_f32_16x16x32_bf16 v[176:179], a[216:219], v[40:43], v[176:179]
    s_and_b32 s36, s36, 0xe000
    v_exp_f32 v120, v148
    v_mfma_f32_16x16x32_bf16 v[176:179], a[220:223], v[44:47], v[176:179]
    s_add_u32 s37, s36, s34
    s_lshl3_add_u32 s33, s37, s35
    ds_read_b64_tr_b16 a[254:255], v107 offset:45056
    v_mfma_f32_16x16x32_bf16 v[180:183], a[208:211], v[48:51], v[20:23]
    v_exp_f32 v121, v149
    v_mfma_f32_16x16x32_bf16 v[180:183], a[212:215], v[52:55], v[180:183]
    buffer_load_dwordx4 v4, s[12:15], s33 offen offset:0 lds
    v_cvt_pk_bf16_f32 v202, v120, v121
    v_mfma_f32_16x16x32_bf16 v[180:183], a[216:219], v[56:59], v[180:183]
    v_exp_f32 v122, v150
    v_mfma_f32_16x16x32_bf16 v[180:183], a[220:223], v[60:63], v[180:183]
    buffer_load_dwordx4 v5, s[12:15], s33 offen offset:1024 lds
    v_mfma_f32_16x16x32_bf16 v[184:187], a[208:211], v[64:67], v[24:27]
    v_exp_f32 v123, v151
    v_mfma_f32_16x16x32_bf16 v[184:187], a[212:215], v[68:71], v[184:187]
    buffer_load_dwordx4 v1, s[8:11], s37 offen offset:2048 sc1 lds
    v_cvt_pk_bf16_f32 v203, v122, v123
    v_mfma_f32_16x16x32_bf16 v[184:187], a[216:219], v[72:75], v[184:187]
    s_waitcnt vmcnt(8)
    s_barrier
    v_mfma_f32_16x16x32_bf16 v[184:187], a[220:223], v[76:79], v[184:187]
    v_exp_f32 v116, v136
    v_mfma_f32_16x16x32_bf16 v[188:191], a[208:211], v[80:83], v[28:31]
    buffer_load_dwordx4 v1, s[8:11], s37 offen offset:3072 sc1 lds
    v_mfma_f32_16x16x32_bf16 v[188:191], a[212:215], v[84:87], v[188:191]
    s_add_u32 s36, s36, 8192
    v_exp_f32 v117, v137
    v_mfma_f32_16x16x32_bf16 v[188:191], a[216:219], v[88:91], v[188:191]
    s_mov_b32 m0, s52
    s_and_b32 s36, s36, 0xe000
    v_cvt_pk_bf16_f32 v208, v116, v117
    v_mfma_f32_16x16x32_bf16 v[188:191], a[220:223], v[92:95], v[188:191]
    s_add_u32 s32, s36, s34
    v_exp_f32 v118, v138
    v_smfmac_f32_16x16x64_bf16 a[144:147], a[160:163], v[224:231], v0
    s_waitcnt lgkmcnt(8)
    s_lshl3_add_u32 s33, s32, s35
    v_accvgpr_read_b32 v15, a142
    v_smfmac_f32_16x16x64_bf16 a[148:151], a[160:163], v[232:239], v0
    buffer_load_dwordx4 v4, s[12:15], s33 offen offset:0 lds
    v_mfma_f32_16x16x32_bf16 a[0:3], a[224:227], v[224:227], a[0:3]
    v_exp_f32 v119, v139
    v_mfma_f32_16x16x32_bf16 a[0:3], a[228:231], v[228:231], a[0:3]
    v_cvt_pk_bf16_f32 v209, v118, v119
    v_mfma_f32_16x16x32_bf16 a[4:7], a[224:227], v[232:235], a[4:7]
    v_exp_f32 v120, v152
    v_mfma_f32_16x16x32_bf16 a[4:7], a[228:231], v[236:239], a[4:7]
    buffer_load_dwordx4 v5, s[12:15], s33 offen offset:1024 lds
    v_mfma_f32_16x16x32_bf16 a[8:11], a[224:227], v[240:243], a[8:11]
    v_exp_f32 v121, v153
    v_mfma_f32_16x16x32_bf16 a[8:11], a[228:231], v[244:247], a[8:11]
    v_cvt_pk_bf16_f32 v210, v120, v121
    v_mfma_f32_16x16x32_bf16 a[12:15], a[224:227], v[248:251], a[12:15]
    v_exp_f32 v122, v154
    v_mfma_f32_16x16x32_bf16 a[12:15], a[228:231], v[252:255], a[12:15]
    buffer_load_dwordx4 v1, s[8:11], s32 offen offset:2048 sc1 lds
    v_mfma_f32_16x16x32_bf16 a[16:19], a[232:235], v[224:227], a[16:19]
    v_exp_f32 v123, v155
    v_mfma_f32_16x16x32_bf16 a[16:19], a[236:239], v[228:231], a[16:19]
    v_cvt_pk_bf16_f32 v211, v122, v123
    v_mfma_f32_16x16x32_bf16 a[20:23], a[232:235], v[232:235], a[20:23]
    v_exp_f32 v116, v140
    v_mfma_f32_16x16x32_bf16 a[20:23], a[236:239], v[236:239], a[20:23]
    buffer_load_dwordx4 v1, s[8:11], s32 offen offset:3072 sc1 lds
    v_mfma_f32_16x16x32_bf16 a[24:27], a[232:235], v[240:243], a[24:27]
    s_add_u32 s36, s36, 8192
    v_exp_f32 v117, v141
    v_mfma_f32_16x16x32_bf16 a[24:27], a[236:239], v[244:247], a[24:27]
    s_waitcnt lgkmcnt(0)
    s_mov_b32 m0, s55
    v_cvt_pk_bf16_f32 v216, v116, v117
    v_mfma_f32_16x16x32_bf16 a[28:31], a[232:235], v[248:251], a[28:31]
    v_exp_f32 v118, v142
    v_mfma_f32_16x16x32_bf16 a[28:31], a[236:239], v[252:255], a[28:31]
    s_and_b32 s36, s36, 0xe000
    ds_read_b64_tr_b16 a[224:225], v108 offset:32768
    v_mfma_f32_16x16x32_bf16 a[32:35], a[240:243], v[224:227], a[32:35]
    v_exp_f32 v119, v143
    v_mfma_f32_16x16x32_bf16 a[32:35], a[244:247], v[228:231], a[32:35]
    ds_read_b64_tr_b16 a[226:227], v108 offset:36864
    v_cvt_pk_bf16_f32 v217, v118, v119
    v_mfma_f32_16x16x32_bf16 a[36:39], a[240:243], v[232:235], a[36:39]
    s_add_u32 s37, s36, s34
    v_exp_f32 v120, v156
    v_mfma_f32_16x16x32_bf16 a[36:39], a[244:247], v[236:239], a[36:39]
    ds_read_b64_tr_b16 a[228:229], v108 offset:40960
    v_mfma_f32_16x16x32_bf16 a[40:43], a[240:243], v[240:243], a[40:43]
    v_exp_f32 v121, v157
    v_mfma_f32_16x16x32_bf16 a[40:43], a[244:247], v[244:247], a[40:43]
    s_lshl3_add_u32 s33, s37, s35
    ds_read_b64_tr_b16 a[230:231], v108 offset:45056
    v_cvt_pk_bf16_f32 v218, v120, v121
    v_mfma_f32_16x16x32_bf16 a[44:47], a[240:243], v[248:251], a[44:47]
    v_exp_f32 v122, v158
    v_mfma_f32_16x16x32_bf16 a[44:47], a[244:247], v[252:255], a[44:47]
    ds_read_b64_tr_b16 a[232:233], v109 offset:32768
    v_mfma_f32_16x16x32_bf16 a[48:51], a[248:251], v[224:227], a[48:51]
    v_exp_f32 v123, v159
    v_mfma_f32_16x16x32_bf16 a[48:51], a[252:255], v[228:231], a[48:51]
    ds_read_b64_tr_b16 a[234:235], v109 offset:36864
    v_cvt_pk_bf16_f32 v219, v122, v123
    v_mfma_f32_16x16x32_bf16 a[52:55], a[248:251], v[232:235], a[52:55]
    v_exp_f32 v116, v160
    v_mfma_f32_16x16x32_bf16 a[52:55], a[252:255], v[236:239], a[52:55]
    v_mfma_f32_16x16x32_bf16 a[56:59], a[248:251], v[240:243], a[56:59]
    v_exp_f32 v117, v161
    v_mfma_f32_16x16x32_bf16 a[56:59], a[252:255], v[244:247], a[56:59]
    v_cvt_pk_bf16_f32 v196, v116, v117
    v_mfma_f32_16x16x32_bf16 a[60:63], a[248:251], v[248:251], a[60:63]
    v_exp_f32 v118, v162
    v_mfma_f32_16x16x32_bf16 a[60:63], a[252:255], v[252:255], a[60:63]
    s_add_u32 s4, s18, 0
    v_exp_f32 v119, v163
    ds_read_b64_tr_b16 a[236:237], v109 offset:40960
    v_cvt_pk_bf16_f32 v197, v118, v119
    v_exp_f32 v120, v176
    ds_read_b64_tr_b16 a[238:239], v109 offset:45056
    buffer_load_dwordx4 v[128:131], v15, s[72:75], s4 offen offset:0
    v_exp_f32 v121, v177
    ds_read_b64_tr_b16 a[240:241], v110 offset:32768
    v_cvt_pk_bf16_f32 v198, v120, v121
    v_exp_f32 v122, v178
    ds_read_b64_tr_b16 a[242:243], v110 offset:36864
    buffer_load_dwordx4 v[132:135], v15, s[72:75], s4 offen offset:64
    s_add_u32 s4, s18, 32768
    v_exp_f32 v123, v179
    ds_read_b64_tr_b16 a[244:245], v110 offset:40960
    v_cvt_pk_bf16_f32 v199, v122, v123
    v_exp_f32 v116, v164
    ds_read_b64_tr_b16 a[246:247], v110 offset:45056
    buffer_load_dwordx4 v[136:139], v15, s[72:75], s4 offen offset:0
    v_exp_f32 v117, v165
    ds_read_b64_tr_b16 a[248:249], v111 offset:32768
    v_cvt_pk_bf16_f32 v204, v116, v117
    v_exp_f32 v118, v166
    ds_read_b64_tr_b16 a[250:251], v111 offset:36864
    buffer_load_dwordx4 v[140:143], v15, s[72:75], s4 offen offset:64
    s_add_u32 s4, s18, 65536
    v_exp_f32 v119, v167
    ds_read_b64_tr_b16 a[252:253], v111 offset:40960
    v_cvt_pk_bf16_f32 v205, v118, v119
    v_exp_f32 v120, v180
    ds_read_b64_tr_b16 a[254:255], v111 offset:45056
    buffer_load_dwordx4 v[144:147], v15, s[72:75], s4 offen offset:0
    v_exp_f32 v121, v181
    s_nop 0
    v_cvt_pk_bf16_f32 v206, v120, v121
    v_exp_f32 v122, v182
    buffer_load_dwordx4 v[148:151], v15, s[72:75], s4 offen offset:64
    s_add_u32 s4, s18, 98304
    v_exp_f32 v123, v183
    s_nop 0
    v_cvt_pk_bf16_f32 v207, v122, v123
    buffer_load_dwordx4 v[152:155], v15, s[72:75], s4 offen offset:0
    v_exp_f32 v116, v168
    buffer_load_dwordx4 v[156:159], v15, s[72:75], s4 offen offset:64
    v_exp_f32 v117, v169
    s_nop 0
    v_cvt_pk_bf16_f32 v212, v116, v117
    v_exp_f32 v118, v170
    v_smfmac_f32_16x16x64_bf16 a[152:155], a[160:163], v[240:247], v0
    s_waitcnt lgkmcnt(8)
    v_accvgpr_read_b32 v100, a132
    v_smfmac_f32_16x16x64_bf16 a[156:159], a[160:163], v[248:255], v0
    buffer_load_dwordx4 v4, s[12:15], s33 offen offset:0 lds
    v_accvgpr_read_b32 v101, a133
    v_mfma_f32_16x16x32_bf16 a[64:67], a[224:227], v[224:227], a[64:67]
    v_exp_f32 v119, v171
    v_mfma_f32_16x16x32_bf16 a[64:67], a[228:231], v[228:231], a[64:67]
    v_cvt_pk_bf16_f32 v213, v118, v119
    v_accvgpr_read_b32 v102, a134
    v_mfma_f32_16x16x32_bf16 a[68:71], a[224:227], v[232:235], a[68:71]
    v_exp_f32 v120, v184
    v_mfma_f32_16x16x32_bf16 a[68:71], a[228:231], v[236:239], a[68:71]
    buffer_load_dwordx4 v5, s[12:15], s33 offen offset:1024 lds
    v_accvgpr_read_b32 v103, a135
    v_mfma_f32_16x16x32_bf16 a[72:75], a[224:227], v[240:243], a[72:75]
    v_exp_f32 v121, v185
    v_mfma_f32_16x16x32_bf16 a[72:75], a[228:231], v[244:247], a[72:75]
    buffer_load_dwordx4 v1, s[8:11], s37 offen offset:2048 sc1 lds
    v_cvt_pk_bf16_f32 v214, v120, v121
    v_mfma_f32_16x16x32_bf16 a[76:79], a[224:227], v[248:251], a[76:79]
    v_exp_f32 v122, v186
    v_mfma_f32_16x16x32_bf16 a[76:79], a[228:231], v[252:255], a[76:79]
    buffer_load_dwordx4 v1, s[8:11], s37 offen offset:3072 sc1 lds
    v_accvgpr_read_b32 v112, a136
    v_mfma_f32_16x16x32_bf16 a[80:83], a[232:235], v[224:227], a[80:83]
    s_add_u32 s36, s36, 8192
    v_exp_f32 v123, v187
    v_mfma_f32_16x16x32_bf16 a[80:83], a[236:239], v[228:231], a[80:83]
    v_cvt_pk_bf16_f32 v215, v122, v123
    v_accvgpr_read_b32 v113, a137
    v_mfma_f32_16x16x32_bf16 a[84:87], a[232:235], v[232:235], a[84:87]
    v_exp_f32 v116, v172
    v_mfma_f32_16x16x32_bf16 a[84:87], a[236:239], v[236:239], a[84:87]
    s_mov_b32 m0, s56
    v_accvgpr_read_b32 v114, a138
    v_mfma_f32_16x16x32_bf16 a[88:91], a[232:235], v[240:243], a[88:91]
    v_exp_f32 v117, v173
    v_mfma_f32_16x16x32_bf16 a[88:91], a[236:239], v[244:247], a[88:91]
    s_waitcnt lgkmcnt(0)
    v_cvt_pk_bf16_f32 v220, v116, v117
    v_mfma_f32_16x16x32_bf16 a[92:95], a[232:235], v[248:251], a[92:95]
    s_and_b32 s36, s36, 0xe000
    v_exp_f32 v118, v174
    v_mfma_f32_16x16x32_bf16 a[92:95], a[236:239], v[252:255], a[92:95]
    ds_read_b64_tr_b16 a[224:225], v104 offset:49152
    v_accvgpr_read_b32 v124, a139
    v_mfma_f32_16x16x32_bf16 a[96:99], a[240:243], v[224:227], a[96:99]
    v_exp_f32 v119, v175
    v_mfma_f32_16x16x32_bf16 a[96:99], a[244:247], v[228:231], a[96:99]
    s_add_u32 s32, s36, s34
    ds_read_b64_tr_b16 a[226:227], v104 offset:53248
    v_cvt_pk_bf16_f32 v221, v118, v119
    v_mfma_f32_16x16x32_bf16 a[100:103], a[240:243], v[232:235], a[100:103]
    v_exp_f32 v120, v188
    v_mfma_f32_16x16x32_bf16 a[100:103], a[244:247], v[236:239], a[100:103]
    ds_read_b64_tr_b16 a[228:229], v104 offset:57344
    v_accvgpr_read_b32 v125, a140
    v_mfma_f32_16x16x32_bf16 a[104:107], a[240:243], v[240:243], a[104:107]
    s_lshl3_add_u32 s33, s32, s35
    v_exp_f32 v121, v189
    v_mfma_f32_16x16x32_bf16 a[104:107], a[244:247], v[244:247], a[104:107]
    ds_read_b64_tr_b16 a[230:231], v104 offset:61440
    v_cvt_pk_bf16_f32 v222, v120, v121
    v_mfma_f32_16x16x32_bf16 a[108:111], a[240:243], v[248:251], a[108:111]
    v_exp_f32 v122, v190
    v_mfma_f32_16x16x32_bf16 a[108:111], a[244:247], v[252:255], a[108:111]
    ds_read_b64_tr_b16 a[232:233], v105 offset:49152
    v_accvgpr_read_b32 v126, a141
    v_mfma_f32_16x16x32_bf16 a[112:115], a[248:251], v[224:227], a[112:115]
    v_exp_f32 v123, v191
    v_mfma_f32_16x16x32_bf16 a[112:115], a[252:255], v[228:231], a[112:115]
    ds_read_b64_tr_b16 a[234:235], v105 offset:53248
    v_cvt_pk_bf16_f32 v223, v122, v123
    v_mfma_f32_16x16x32_bf16 a[116:119], a[248:251], v[232:235], a[116:119]
    v_mfma_f32_16x16x32_bf16 a[116:119], a[252:255], v[236:239], a[116:119]
    v_mfma_f32_16x16x32_bf16 a[120:123], a[248:251], v[240:243], a[120:123]
    v_mfma_f32_16x16x32_bf16 a[120:123], a[252:255], v[244:247], a[120:123]
    v_mfma_f32_16x16x32_bf16 a[124:127], a[248:251], v[248:251], a[124:127]
    v_mfma_f32_16x16x32_bf16 a[124:127], a[252:255], v[252:255], a[124:127]
    s_cmp_lg_u32 s41, 0
    s_cbranch_scc1 L_c_late
    v_smfmac_f32_16x16x64_bf16 a[144:147], a[160:163], v[192:199], v0
    ds_read_b64_tr_b16 a[236:237], v105 offset:57344
    v_smfmac_f32_16x16x64_bf16 a[148:151], a[160:163], v[200:207], v0
    ds_read_b64_tr_b16 a[238:239], v105 offset:61440
    v_smfmac_f32_16x16x64_bf16 a[152:155], a[160:163], v[208:215], v0
    s_waitcnt lgkmcnt(4)
    ds_read_b64_tr_b16 a[240:241], v106 offset:49152
    v_smfmac_f32_16x16x64_bf16 a[156:159], a[160:163], v[216:223], v0
    ds_read_b64_tr_b16 a[242:243], v106 offset:53248
    v_mfma_f32_16x16x32_bf16 a[0:3], a[224:227], v[192:195], a[0:3]
    ds_read_b64_tr_b16 a[244:245], v106 offset:57344
    v_mfma_f32_16x16x32_bf16 a[0:3], a[228:231], v[196:199], a[0:3]
    ds_read_b64_tr_b16 a[246:247], v106 offset:61440
    v_mfma_f32_16x16x32_bf16 a[4:7], a[224:227], v[200:203], a[4:7]
    ds_read_b64_tr_b16 a[248:249], v107 offset:49152
    v_accvgpr_read_b32 v116, a144
    v_mfma_f32_16x16x32_bf16 a[4:7], a[228:231], v[204:207], a[4:7]
    ds_read_b64_tr_b16 a[250:251], v107 offset:53248
    v_accvgpr_read_b32 v117, a148
    v_mfma_f32_16x16x32_bf16 a[8:11], a[224:227], v[208:211], a[8:11]
    ds_read_b64_tr_b16 a[252:253], v107 offset:57344
    v_accvgpr_read_b32 v118, a152
    v_mfma_f32_16x16x32_bf16 a[8:11], a[228:231], v[212:215], a[8:11]
    ds_read_b64_tr_b16 a[254:255], v107 offset:61440
    v_accvgpr_read_b32 v119, a156
    v_mfma_f32_16x16x32_bf16 a[12:15], a[224:227], v[216:219], a[12:15]
    s_waitcnt lgkmcnt(8)
    v_accvgpr_read_b32 v120, a145
    v_accvgpr_read_b32 v121, a149
    v_mfma_f32_16x16x32_bf16 a[12:15], a[228:231], v[220:223], a[12:15]
    v_accvgpr_read_b32 v122, a153
    v_accvgpr_read_b32 v123, a157
    v_mfma_f32_16x16x32_bf16 a[16:19], a[232:235], v[192:195], a[16:19]
    ds_read_b64_tr_b16 a[224:225], v108 offset:49152
    v_add_f32 v116, v116, v120
    v_mfma_f32_16x16x32_bf16 a[16:19], a[236:239], v[196:199], a[16:19]
    ds_read_b64_tr_b16 a[226:227], v108 offset:53248
    v_add_f32 v117, v117, v121
    v_mfma_f32_16x16x32_bf16 a[20:23], a[232:235], v[200:203], a[20:23]
    ds_read_b64_tr_b16 a[228:229], v108 offset:57344
    v_add_f32 v118, v118, v122
    v_mfma_f32_16x16x32_bf16 a[20:23], a[236:239], v[204:207], a[20:23]
    ds_read_b64_tr_b16 a[230:231], v108 offset:61440
    v_add_f32 v119, v119, v123
    v_mfma_f32_16x16x32_bf16 a[24:27], a[232:235], v[208:211], a[24:27]
    v_max3_u32 v120, v116, v117, v118
    v_max_u32 v120, v120, v119
    v_mfma_f32_16x16x32_bf16 a[24:27], a[236:239], v[212:215], a[24:27]
    v_cmp_le_u32 vcc, s44, v120
    v_mfma_f32_16x16x32_bf16 a[28:31], a[232:235], v[216:219], a[28:31]
    s_waitcnt lgkmcnt(8)
    s_cbranch_vccnz L_rare_0
L_back_g:
    v_mfma_f32_16x16x32_bf16 a[28:31], a[236:239], v[220:223], a[28:31]
    v_rcp_f32 v116, v116
    v_mfma_f32_16x16x32_bf16 a[32:35], a[240:243], v[192:195], a[32:35]
    ds_read_b64_tr_b16 a[232:233], v109 offset:49152
    v_mfma_f32_16x16x32_bf16 a[32:35], a[244:247], v[196:199], a[32:35]
    ds_read_b64_tr_b16 a[234:235], v109 offset:53248
    v_mfma_f32_16x16x32_bf16 a[36:39], a[240:243], v[200:203], a[36:39]
    ds_read_b64_tr_b16 a[236:237], v109 offset:57344
    v_mfma_f32_16x16x32_bf16 a[36:39], a[244:247], v[204:207], a[36:39]
    ds_read_b64_tr_b16 a[238:239], v109 offset:61440
    v_mfma_f32_16x16x32_bf16 a[40:43], a[240:243], v[208:211], a[40:43]
    v_rcp_f32 v117, v117
    v_mfma_f32_16x16x32_bf16 a[40:43], a[244:247], v[212:215], a[40:43]
    v_rcp_f32 v118, v118
    v_mfma_f32_16x16x32_bf16 a[44:47], a[240:243], v[216:219], a[44:47]
    s_waitcnt lgkmcnt(8)
    v_rcp_f32 v119, v119
    v_mfma_f32_16x16x32_bf16 a[44:47], a[244:247], v[220:223], a[44:47]
    buffer_load_dwordx4 v4, s[12:15], s33 offen offset:0 lds
    v_mfma_f32_16x16x32_bf16 a[48:51], a[248:251], v[192:195], a[48:51]
    ds_read_b64_tr_b16 a[240:241], v110 offset:49152
    buffer_load_dwordx4 v5, s[12:15], s33 offen offset:1024 lds
    v_mfma_f32_16x16x32_bf16 a[48:51], a[252:255], v[196:199], a[48:51]
    ds_read_b64_tr_b16 a[242:243], v110 offset:53248
    buffer_load_dwordx4 v1, s[8:11], s32 offen offset:2048 sc1 lds
    v_mfma_f32_16x16x32_bf16 a[52:55], a[248:251], v[200:203], a[52:55]
    ds_read_b64_tr_b16 a[244:245], v110 offset:57344
    v_mfma_f32_16x16x32_bf16 a[52:55], a[252:255], v[204:207], a[52:55]
    ds_read_b64_tr_b16 a[246:247], v110 offset:61440
    v_mfma_f32_16x16x32_bf16 a[56:59], a[248:251], v[208:211], a[56:59]
    buffer_load_dwordx4 v1, s[8:11], s32 offen offset:3072 sc1 lds
    v_mfma_f32_16x16x32_bf16 a[56:59], a[252:255], v[212:215], a[56:59]
    s_add_u32 s36, s36, 8192
    s_mov_b32 m0, s57
    v_mfma_f32_16x16x32_bf16 a[60:63], a[248:251], v[216:219], a[60:63]
    s_waitcnt lgkmcnt(8)
    v_mfma_f32_16x16x32_bf16 a[60:63], a[252:255], v[220:223], a[60:63]
    s_and_b32 s36, s36, 0xe000
    v_mfma_f32_16x16x32_bf16 a[64:67], a[224:227], v[192:195], a[64:67]
    s_add_u32 s37, s36, s34
    ds_read_b64_tr_b16 a[248:249], v111 offset:49152
    v_mfma_f32_16x16x32_bf16 a[64:67], a[228:231], v[196:199], a[64:67]
    ds_read_b64_tr_b16 a[250:251], v111 offset:53248
    v_mfma_f32_16x16x32_bf16 a[68:71], a[224:227], v[200:203], a[68:71]
    s_lshl3_add_u32 s33, s37, s35
    ds_read_b64_tr_b16 a[252:253], v111 offset:57344
    v_mfma_f32_16x16x32_bf16 a[68:71], a[228:231], v[204:207], a[68:71]
    ds_read_b64_tr_b16 a[254:255], v111 offset:61440
    v_mfma_f32_16x16x32_bf16 a[72:75], a[224:227], v[208:211], a[72:75]
    buffer_load_dwordx4 v4, s[12:15], s33 offen offset:0 lds
    v_mfma_f32_16x16x32_bf16 a[72:75], a[228:231], v[212:215], a[72:75]
    buffer_load_dwordx4 v5, s[12:15], s33 offen offset:1024 lds
    v_mfma_f32_16x16x32_bf16 a[76:79], a[224:227], v[216:219], a[76:79]
    s_waitcnt lgkmcnt(8)
    buffer_load_dwordx4 v1, s[8:11], s37 offen offset:2048 sc1 lds
    v_mfma_f32_16x16x32_bf16 a[76:79], a[228:231], v[220:223], a[76:79]
    v_mfma_f32_16x16x32_bf16 a[80:83], a[232:235], v[192:195], a[80:83]
    buffer_load_dwordx4 v1, s[8:11], s37 offen offset:3072 sc1 lds
    v_mfma_f32_16x16x32_bf16 a[80:83], a[236:239], v[196:199], a[80:83]
    v_mfma_f32_16x16x32_bf16 a[84:87], a[232:235], v[200:203], a[84:87]
    s_add_u32 s36, s36, 8192
    v_mfma_f32_16x16x32_bf16 a[84:87], a[236:239], v[204:207], a[84:87]
    s_mov_b32 m0, s58
    v_mfma_f32_16x16x32_bf16 a[88:91], a[232:235], v[208:211], a[88:91]
    v_mfma_f32_16x16x32_bf16 a[88:91], a[236:239], v[212:215], a[88:91]
    s_and_b32 s36, s36, 0xe000
    v_mfma_f32_16x16x32_bf16 a[92:95], a[232:235], v[216:219], a[92:95]
    s_waitcnt lgkmcnt(4)
    s_add_u32 s32, s36, s34
    v_mfma_f32_16x16x32_bf16 a[92:95], a[236:239], v[220:223], a[92:95]
    v_mfma_f32_16x16x32_bf16 a[96:99], a[240:243], v[192:195], a[96:99]
    s_lshl3_add_u32 s33, s32, s35
    v_mfma_f32_16x16x32_bf16 a[96:99], a[244:247], v[196:199], a[96:99]
    v_and_b32 v52, 15, v6
    v_mfma_f32_16x16x32_bf16 a[100:103], a[240:243], v[200:203], a[100:103]
    v_mfma_f32_16x16x32_bf16 a[100:103], a[244:247], v[204:207], a[100:103]
    v_lshlrev_b32 v52, 2, v52
    v_mfma_f32_16x16x32_bf16 a[104:107], a[240:243], v[208:211], a[104:107]
    buffer_load_dword v48, v52, s[28:31], s46 offen offset:0 sc1
    v_mfma_f32_16x16x32_bf16 a[104:107], a[244:247], v[212:215], a[104:107]
    v_mfma_f32_16x16x32_bf16 a[108:111], a[240:243], v[216:219], a[108:111]
    s_waitcnt lgkmcnt(0)
    buffer_load_dword v49, v52, s[28:31], s46 offen offset:64 sc1
    v_mfma_f32_16x16x32_bf16 a[108:111], a[244:247], v[220:223], a[108:111]
    buffer_load_dword v50, v52, s[28:31], s46 offen offset:128 sc1
    v_mfma_f32_16x16x32_bf16 a[112:115], a[248:251], v[192:195], a[112:115]
    v_mfma_f32_16x16x32_bf16 a[112:115], a[252:255], v[196:199], a[112:115]
    buffer_load_dword v51, v52, s[28:31], s46 offen offset:192 sc1
    v_mfma_f32_16x16x32_bf16 a[116:119], a[248:251], v[200:203], a[116:119]
    v_mfma_f32_16x16x32_bf16 a[116:119], a[252:255], v[204:207], a[116:119]
    v_mfma_f32_16x16x32_bf16 a[120:123], a[248:251], v[208:211], a[120:123]
    v_mfma_f32_16x16x32_bf16 a[120:123], a[252:255], v[212:215], a[120:123]
    v_mfma_f32_16x16x32_bf16 a[124:127], a[248:251], v[216:219], a[124:127]
    v_mfma_f32_16x16x32_bf16 a[124:127], a[252:255], v[220:223], a[124:127]
    s_nop 1
    v_accvgpr_read_b32 v16, a0
    v_accvgpr_read_b32 v17, a1
    v_accvgpr_read_b32 v18, a2
    v_accvgpr_read_b32 v19, a3
    v_accvgpr_read_b32 v20, a16
    v_accvgpr_read_b32 v21, a17
    v_accvgpr_read_b32 v22, a18
    v_accvgpr_read_b32 v23, a19
    v_pk_mul_f32 v[16:17], v[16:17], v[116:117] op_sel:[0,0] op_sel_hi:[1,0]
    v_pk_mul_f32 v[18:19], v[18:19], v[116:117] op_sel:[0,0] op_sel_hi:[1,0]
    v_pk_mul_f32 v[20:21], v[20:21], v[116:117] op_sel:[0,0] op_sel_hi:[1,0]
    v_pk_mul_f32 v[22:23], v[22:23], v[116:117] op_sel:[0,0] op_sel_hi:[1,0]
    v_cvt_pk_bf16_f32 v16, v16, v17
    v_cvt_pk_bf16_f32 v17, v18, v19
    v_cvt_pk_bf16_f32 v18, v20, v21
    v_cvt_pk_bf16_f32 v19, v22, v23
    buffer_store_dwordx4 v[16:19], v115, s[28:31], s49 offen offset:0 sc1
    v_accvgpr_read_b32 v24, a4
    v_accvgpr_read_b32 v25, a5
    v_accvgpr_read_b32 v26, a6
    v_accvgpr_read_b32 v27, a7
    v_accvgpr_read_b32 v28, a20
    v_accvgpr_read_b32 v29, a21
    v_accvgpr_read_b32 v30, a22
    v_accvgpr_read_b32 v31, a23
    v_pk_mul_f32 v[24:25], v[24:25], v[116:117] op_sel:[0,1] op_sel_hi:[1,1]
    v_pk_mul_f32 v[26:27], v[26:27], v[116:117] op_sel:[0,1] op_sel_hi:[1,1]
    v_pk_mul_f32 v[28:29], v[28:29], v[116:117] op_sel:[0,1] op_sel_hi:[1,1]
    v_pk_mul_f32 v[30:31], v[30:31], v[116:117] op_sel:[0,1] op_sel_hi:[1,1]
    v_cvt_pk_bf16_f32 v24, v24, v25
    v_cvt_pk_bf16_f32 v25, v26, v27
    v_cvt_pk_bf16_f32 v26, v28, v29
    v_cvt_pk_bf16_f32 v27, v30, v31
    buffer_store_dwordx4 v[24:27], v115, s[28:31], s49 offen offset:1024 sc1
    v_accvgpr_read_b32 v32, a8
    v_accvgpr_read_b32 v33, a9
    v_accvgpr_read_b32 v34, a10
    v_accvgpr_read_b32 v35, a11
    v_accvgpr_read_b32 v36, a24
    v_accvgpr_read_b32 v37, a25
    v_accvgpr_read_b32 v38, a26
    v_accvgpr_read_b32 v39, a27
    v_pk_mul_f32 v[32:33], v[32:33], v[118:119] op_sel:[0,0] op_sel_hi:[1,0]
    v_pk_mul_f32 v[34:35], v[34:35], v[118:119] op_sel:[0,0] op_sel_hi:[1,0]
    v_pk_mul_f32 v[36:37], v[36:37], v[118:119] op_sel:[0,0] op_sel_hi:[1,0]
    v_pk_mul_f32 v[38:39], v[38:39], v[118:119] op_sel:[0,0] op_sel_hi:[1,0]
    v_cvt_pk_bf16_f32 v32, v32, v33
    v_cvt_pk_bf16_f32 v33, v34, v35
    v_cvt_pk_bf16_f32 v34, v36, v37
    v_cvt_pk_bf16_f32 v35, v38, v39
    buffer_store_dwordx4 v[32:35], v115, s[28:31], s49 offen offset:2048 sc1
    v_accvgpr_read_b32 v40, a12
    v_accvgpr_read_b32 v41, a13
    v_accvgpr_read_b32 v42, a14
    v_accvgpr_read_b32 v43, a15
    v_accvgpr_read_b32 v44, a28
    v_accvgpr_read_b32 v45, a29
    v_accvgpr_read_b32 v46, a30
    v_accvgpr_read_b32 v47, a31
    v_pk_mul_f32 v[40:41], v[40:41], v[118:119] op_sel:[0,1] op_sel_hi:[1,1]
    v_pk_mul_f32 v[42:43], v[42:43], v[118:119] op_sel:[0,1] op_sel_hi:[1,1]
    v_pk_mul_f32 v[44:45], v[44:45], v[118:119] op_sel:[0,1] op_sel_hi:[1,1]
    v_pk_mul_f32 v[46:47], v[46:47], v[118:119] op_sel:[0,1] op_sel_hi:[1,1]
    v_cvt_pk_bf16_f32 v40, v40, v41
    v_cvt_pk_bf16_f32 v41, v42, v43
    v_cvt_pk_bf16_f32 v42, v44, v45
    v_cvt_pk_bf16_f32 v43, v46, v47
    buffer_store_dwordx4 v[40:43], v115, s[28:31], s49 offen offset:3072 sc1
    s_add_u32 s49, s49, 8192
    v_accvgpr_read_b32 v16, a32
    v_accvgpr_read_b32 v17, a33
    v_accvgpr_read_b32 v18, a34
    v_accvgpr_read_b32 v19, a35
    v_accvgpr_read_b32 v20, a48
    v_accvgpr_read_b32 v21, a49
    v_accvgpr_read_b32 v22, a50
    v_accvgpr_read_b32 v23, a51
    v_pk_mul_f32 v[16:17], v[16:17], v[116:117] op_sel:[0,0] op_sel_hi:[1,0]
    v_pk_mul_f32 v[18:19], v[18:19], v[116:117] op_sel:[0,0] op_sel_hi:[1,0]
    v_pk_mul_f32 v[20:21], v[20:21], v[116:117] op_sel:[0,0] op_sel_hi:[1,0]
    v_pk_mul_f32 v[22:23], v[22:23], v[116:117] op_sel:[0,0] op_sel_hi:[1,0]
    v_cvt_pk_bf16_f32 v16, v16, v17
    v_cvt_pk_bf16_f32 v17, v18, v19
    v_cvt_pk_bf16_f32 v18, v20, v21
    v_cvt_pk_bf16_f32 v19, v22, v23
    buffer_store_dwordx4 v[16:19], v115, s[28:31], s49 offen offset:0 sc1
    v_accvgpr_read_b32 v24, a36
    v_accvgpr_read_b32 v25, a37
    v_accvgpr_read_b32 v26, a38
    v_accvgpr_read_b32 v27, a39
    v_accvgpr_read_b32 v28, a52
    v_accvgpr_read_b32 v29, a53
    v_accvgpr_read_b32 v30, a54
    v_accvgpr_read_b32 v31, a55
    v_pk_mul_f32 v[24:25], v[24:25], v[116:117] op_sel:[0,1] op_sel_hi:[1,1]
    v_pk_mul_f32 v[26:27], v[26:27], v[116:117] op_sel:[0,1] op_sel_hi:[1,1]
    v_pk_mul_f32 v[28:29], v[28:29], v[116:117] op_sel:[0,1] op_sel_hi:[1,1]
    v_pk_mul_f32 v[30:31], v[30:31], v[116:117] op_sel:[0,1] op_sel_hi:[1,1]
    v_cvt_pk_bf16_f32 v24, v24, v25
    v_cvt_pk_bf16_f32 v25, v26, v27
    v_cvt_pk_bf16_f32 v26, v28, v29
    v_cvt_pk_bf16_f32 v27, v30, v31
    buffer_store_dwordx4 v[24:27], v115, s[28:31], s49 offen offset:1024 sc1
    v_accvgpr_read_b32 v32, a40
    v_accvgpr_read_b32 v33, a41
    v_accvgpr_read_b32 v34, a42
    v_accvgpr_read_b32 v35, a43
    v_accvgpr_read_b32 v36, a56
    v_accvgpr_read_b32 v37, a57
    v_accvgpr_read_b32 v38, a58
    v_accvgpr_read_b32 v39, a59
    v_pk_mul_f32 v[32:33], v[32:33], v[118:119] op_sel:[0,0] op_sel_hi:[1,0]
    v_pk_mul_f32 v[34:35], v[34:35], v[118:119] op_sel:[0,0] op_sel_hi:[1,0]
    v_pk_mul_f32 v[36:37], v[36:37], v[118:119] op_sel:[0,0] op_sel_hi:[1,0]
    v_pk_mul_f32 v[38:39], v[38:39], v[118:119] op_sel:[0,0] op_sel_hi:[1,0]
    v_cvt_pk_bf16_f32 v32, v32, v33
    v_cvt_pk_bf16_f32 v33, v34, v35
    v_cvt_pk_bf16_f32 v34, v36, v37
    v_cvt_pk_bf16_f32 v35, v38, v39
    buffer_store_dwordx4 v[32:35], v115, s[28:31], s49 offen offset:2048 sc1
    v_accvgpr_read_b32 v40, a44
    v_accvgpr_read_b32 v41, a45
    v_accvgpr_read_b32 v42, a46
    v_accvgpr_read_b32 v43, a47
    v_accvgpr_read_b32 v44, a60
    v_accvgpr_read_b32 v45, a61
    v_accvgpr_read_b32 v46, a62
    v_accvgpr_read_b32 v47, a63
    v_pk_mul_f32 v[40:41], v[40:41], v[118:119] op_sel:[0,1] op_sel_hi:[1,1]
    v_pk_mul_f32 v[42:43], v[42:43], v[118:119] op_sel:[0,1] op_sel_hi:[1,1]
    v_pk_mul_f32 v[44:45], v[44:45], v[118:119] op_sel:[0,1] op_sel_hi:[1,1]
    v_pk_mul_f32 v[46:47], v[46:47], v[118:119] op_sel:[0,1] op_sel_hi:[1,1]
    v_cvt_pk_bf16_f32 v40, v40, v41
    v_cvt_pk_bf16_f32 v41, v42, v43
    v_cvt_pk_bf16_f32 v42, v44, v45
    v_cvt_pk_bf16_f32 v43, v46, v47
    buffer_store_dwordx4 v[40:43], v115, s[28:31], s49 offen offset:3072 sc1
    s_add_u32 s49, s49, 8192
    v_accvgpr_read_b32 v16, a64
    v_accvgpr_read_b32 v17, a65
    v_accvgpr_read_b32 v18, a66
    v_accvgpr_read_b32 v19, a67
    v_accvgpr_read_b32 v20, a80
    v_accvgpr_read_b32 v21, a81
    v_accvgpr_read_b32 v22, a82
    v_accvgpr_read_b32 v23, a83
    v_pk_mul_f32 v[16:17], v[16:17], v[116:117] op_sel:[0,0] op_sel_hi:[1,0]
    v_pk_mul_f32 v[18:19], v[18:19], v[116:117] op_sel:[0,0] op_sel_hi:[1,0]
    v_pk_mul_f32 v[20:21], v[20:21], v[116:117] op_sel:[0,0] op_sel_hi:[1,0]
    v_pk_mul_f32 v[22:23], v[22:23], v[116:117] op_sel:[0,0] op_sel_hi:[1,0]
    v_cvt_pk_bf16_f32 v16, v16, v17
    v_cvt_pk_bf16_f32 v17, v18, v19
    v_cvt_pk_bf16_f32 v18, v20, v21
    v_cvt_pk_bf16_f32 v19, v22, v23
    buffer_store_dwordx4 v[16:19], v115, s[28:31], s49 offen offset:0 sc1
    v_accvgpr_read_b32 v24, a68
    v_accvgpr_read_b32 v25, a69
    v_accvgpr_read_b32 v26, a70
    v_accvgpr_read_b32 v27, a71
    v_accvgpr_read_b32 v28, a84
    v_accvgpr_read_b32 v29, a85
    v_accvgpr_read_b32 v30, a86
    v_accvgpr_read_b32 v31, a87
    v_pk_mul_f32 v[24:25], v[24:25], v[116:117] op_sel:[0,1] op_sel_hi:[1,1]
    v_pk_mul_f32 v[26:27], v[26:27], v[116:117] op_sel:[0,1] op_sel_hi:[1,1]
    v_pk_mul_f32 v[28:29], v[28:29], v[116:117] op_sel:[0,1] op_sel_hi:[1,1]
    v_pk_mul_f32 v[30:31], v[30:31], v[116:117] op_sel:[0,1] op_sel_hi:[1,1]
    v_cvt_pk_bf16_f32 v24, v24, v25
    v_cvt_pk_bf16_f32 v25, v26, v27
    v_cvt_pk_bf16_f32 v26, v28, v29
    v_cvt_pk_bf16_f32 v27, v30, v31
    buffer_store_dwordx4 v[24:27], v115, s[28:31], s49 offen offset:1024 sc1
    v_accvgpr_read_b32 v32, a72
    v_accvgpr_read_b32 v33, a73
    v_accvgpr_read_b32 v34, a74
    v_accvgpr_read_b32 v35, a75
    v_accvgpr_read_b32 v36, a88
    v_accvgpr_read_b32 v37, a89
    v_accvgpr_read_b32 v38, a90
    v_accvgpr_read_b32 v39, a91
    v_pk_mul_f32 v[32:33], v[32:33], v[118:119] op_sel:[0,0] op_sel_hi:[1,0]
    v_pk_mul_f32 v[34:35], v[34:35], v[118:119] op_sel:[0,0] op_sel_hi:[1,0]
    v_pk_mul_f32 v[36:37], v[36:37], v[118:119] op_sel:[0,0] op_sel_hi:[1,0]
    v_pk_mul_f32 v[38:39], v[38:39], v[118:119] op_sel:[0,0] op_sel_hi:[1,0]
    v_cvt_pk_bf16_f32 v32, v32, v33
    v_cvt_pk_bf16_f32 v33, v34, v35
    v_cvt_pk_bf16_f32 v34, v36, v37
    v_cvt_pk_bf16_f32 v35, v38, v39
    buffer_store_dwordx4 v[32:35], v115, s[28:31], s49 offen offset:2048 sc1
    v_accvgpr_read_b32 v40, a76
    v_accvgpr_read_b32 v41, a77
    v_accvgpr_read_b32 v42, a78
    v_accvgpr_read_b32 v43, a79
    v_accvgpr_read_b32 v44, a92
    v_accvgpr_read_b32 v45, a93
    v_accvgpr_read_b32 v46, a94
    v_accvgpr_read_b32 v47, a95
    v_pk_mul_f32 v[40:41], v[40:41], v[118:119] op_sel:[0,1] op_sel_hi:[1,1]
    v_pk_mul_f32 v[42:43], v[42:43], v[118:119] op_sel:[0,1] op_sel_hi:[1,1]
    v_pk_mul_f32 v[44:45], v[44:45], v[118:119] op_sel:[0,1] op_sel_hi:[1,1]
    v_pk_mul_f32 v[46:47], v[46:47], v[118:119] op_sel:[0,1] op_sel_hi:[1,1]
    v_cvt_pk_bf16_f32 v40, v40, v41
    v_cvt_pk_bf16_f32 v41, v42, v43
    v_cvt_pk_bf16_f32 v42, v44, v45
    v_cvt_pk_bf16_f32 v43, v46, v47
    buffer_store_dwordx4 v[40:43], v115, s[28:31], s49 offen offset:3072 sc1
    s_add_u32 s49, s49, 8192
    v_accvgpr_read_b32 v16, a96
    v_accvgpr_read_b32 v17, a97
    v_accvgpr_read_b32 v18, a98
    v_accvgpr_read_b32 v19, a99
    v_accvgpr_read_b32 v20, a112
    v_accvgpr_read_b32 v21, a113
    v_accvgpr_read_b32 v22, a114
    v_accvgpr_read_b32 v23, a115
    v_pk_mul_f32 v[16:17], v[16:17], v[116:117] op_sel:[0,0] op_sel_hi:[1,0]
    v_pk_mul_f32 v[18:19], v[18:19], v[116:117] op_sel:[0,0] op_sel_hi:[1,0]
    v_pk_mul_f32 v[20:21], v[20:21], v[116:117] op_sel:[0,0] op_sel_hi:[1,0]
    v_pk_mul_f32 v[22:23], v[22:23], v[116:117] op_sel:[0,0] op_sel_hi:[1,0]
    v_cvt_pk_bf16_f32 v16, v16, v17
    v_cvt_pk_bf16_f32 v17, v18, v19
    v_cvt_pk_bf16_f32 v18, v20, v21
    v_cvt_pk_bf16_f32 v19, v22, v23
    buffer_store_dwordx4 v[16:19], v115, s[28:31], s49 offen offset:0 sc1
    v_accvgpr_read_b32 v24, a100
    v_accvgpr_read_b32 v25, a101
    v_accvgpr_read_b32 v26, a102
    v_accvgpr_read_b32 v27, a103
    v_accvgpr_read_b32 v28, a116
    v_accvgpr_read_b32 v29, a117
    v_accvgpr_read_b32 v30, a118
    v_accvgpr_read_b32 v31, a119
    v_pk_mul_f32 v[24:25], v[24:25], v[116:117] op_sel:[0,1] op_sel_hi:[1,1]
    v_pk_mul_f32 v[26:27], v[26:27], v[116:117] op_sel:[0,1] op_sel_hi:[1,1]
    v_pk_mul_f32 v[28:29], v[28:29], v[116:117] op_sel:[0,1] op_sel_hi:[1,1]
    v_pk_mul_f32 v[30:31], v[30:31], v[116:117] op_sel:[0,1] op_sel_hi:[1,1]
    v_cvt_pk_bf16_f32 v24, v24, v25
    v_cvt_pk_bf16_f32 v25, v26, v27
    v_cvt_pk_bf16_f32 v26, v28, v29
    v_cvt_pk_bf16_f32 v27, v30, v31
    buffer_store_dwordx4 v[24:27], v115, s[28:31], s49 offen offset:1024 sc1
    v_accvgpr_read_b32 v32, a104
    v_accvgpr_read_b32 v33, a105
    v_accvgpr_read_b32 v34, a106
    v_accvgpr_read_b32 v35, a107
    v_accvgpr_read_b32 v36, a120
    v_accvgpr_read_b32 v37, a121
    v_accvgpr_read_b32 v38, a122
    v_accvgpr_read_b32 v39, a123
    v_pk_mul_f32 v[32:33], v[32:33], v[118:119] op_sel:[0,0] op_sel_hi:[1,0]
    v_pk_mul_f32 v[34:35], v[34:35], v[118:119] op_sel:[0,0] op_sel_hi:[1,0]
    v_pk_mul_f32 v[36:37], v[36:37], v[118:119] op_sel:[0,0] op_sel_hi:[1,0]
    v_pk_mul_f32 v[38:39], v[38:39], v[118:119] op_sel:[0,0] op_sel_hi:[1,0]
    v_cvt_pk_bf16_f32 v32, v32, v33
    v_cvt_pk_bf16_f32 v33, v34, v35
    v_cvt_pk_bf16_f32 v34, v36, v37
    v_cvt_pk_bf16_f32 v35, v38, v39
    buffer_store_dwordx4 v[32:35], v115, s[28:31], s49 offen offset:2048 sc1
    v_accvgpr_read_b32 v40, a108
    v_accvgpr_read_b32 v41, a109
    v_accvgpr_read_b32 v42, a110
    v_accvgpr_read_b32 v43, a111
    v_accvgpr_read_b32 v44, a124
    v_accvgpr_read_b32 v45, a125
    v_accvgpr_read_b32 v46, a126
    v_accvgpr_read_b32 v47, a127
    v_pk_mul_f32 v[40:41], v[40:41], v[118:119] op_sel:[0,1] op_sel_hi:[1,1]
    v_pk_mul_f32 v[42:43], v[42:43], v[118:119] op_sel:[0,1] op_sel_hi:[1,1]
    v_pk_mul_f32 v[44:45], v[44:45], v[118:119] op_sel:[0,1] op_sel_hi:[1,1]
    v_pk_mul_f32 v[46:47], v[46:47], v[118:119] op_sel:[0,1] op_sel_hi:[1,1]
    v_cvt_pk_bf16_f32 v40, v40, v41
    v_cvt_pk_bf16_f32 v41, v42, v43
    v_cvt_pk_bf16_f32 v42, v44, v45
    v_cvt_pk_bf16_f32 v43, v46, v47
    buffer_store_dwordx4 v[40:43], v115, s[28:31], s49 offen offset:3072 sc1
    s_waitcnt vmcnt(32)
    s_barrier
    ds_read_b64_tr_b16 v[16:17], v102 offset:16384
    ds_read_b64_tr_b16 v[18:19], v102 offset:24576
    ds_read_b128 a[0:3], v100 offset:16384
    ds_read_b64_tr_b16 v[32:33], v102 offset:32768
    ds_read_b64_tr_b16 v[34:35], v102 offset:40960
    ds_read_b128 a[16:19], v100 offset:32768
    ds_read_b128 a[4:7], v100 offset:17408
    ds_read_b128 a[20:23], v100 offset:33792
    ds_read_b128 a[8:11], v100 offset:20480
    ds_read_b128 a[24:27], v100 offset:36864
    ds_read_b128 a[12:15], v100 offset:21504
    ds_read_b128 a[28:31], v100 offset:37888
    ds_read_b64_tr_b16 v[20:21], v103 offset:16384
    ds_read_b64_tr_b16 v[22:23], v103 offset:24576
    ds_read_b64_tr_b16 v[36:37], v103 offset:32768
    ds_read_b64_tr_b16 v[38:39], v103 offset:40960
    ds_read_b64_tr_b16 v[24:25], v112 offset:16384
    ds_read_b64_tr_b16 v[26:27], v112 offset:24576
    s_waitcnt lgkmcnt(12)
    v_mfma_f32_16x16x32_bf16 v[128:131], v[16:19], a[0:3], 0
    buffer_load_dwordx4 v4, s[12:15], s33 offen offset:0 lds
    v_mfma_f32_16x16x32_bf16 v[128:131], v[32:35], a[16:19], v[128:131]
    s_waitcnt lgkmcnt(11)
    ds_read_b64_tr_b16 v[28:29], v113 offset:16384
    v_mfma_f32_16x16x32_bf16 v[132:135], v[16:19], a[4:7], 0
    s_waitcnt lgkmcnt(11)
    ds_read_b64_tr_b16 v[30:31], v113 offset:24576
    v_mfma_f32_16x16x32_bf16 v[132:135], v[32:35], a[20:23], v[132:135]
    s_waitcnt lgkmcnt(11)
    ds_read_b64_tr_b16 v[40:41], v112 offset:32768
    v_mfma_f32_16x16x32_bf16 v[136:139], v[16:19], a[8:11], 0
    s_waitcnt lgkmcnt(11)
    buffer_load_dwordx4 v5, s[12:15], s33 offen offset:1024 lds
    v_mfma_f32_16x16x32_bf16 v[136:139], v[32:35], a[24:27], v[136:139]
    s_add_u32 s36, s36, 8192
    s_waitcnt lgkmcnt(10)
    ds_read_b64_tr_b16 v[42:43], v112 offset:40960
    v_mfma_f32_16x16x32_bf16 v[140:143], v[16:19], a[12:15], 0
    s_and_b32 s36, s36, 0xe000
    s_waitcnt lgkmcnt(10)
    ds_read_b64_tr_b16 v[44:45], v113 offset:32768
    v_mfma_f32_16x16x32_bf16 v[140:143], v[32:35], a[28:31], v[140:143]
    s_waitcnt lgkmcnt(3)
    ds_read_b64_tr_b16 v[46:47], v113 offset:40960
    v_mfma_f32_16x16x32_bf16 v[144:147], v[20:23], a[0:3], 0
    s_waitcnt vmcnt(30)
    s_barrier
    buffer_load_dwordx4 v1, s[28:31], s32 offen offset:2048 sc1 lds
    v_mfma_f32_16x16x32_bf16 v[144:147], v[36:39], a[16:19], v[144:147]
    s_add_u32 s37, s36, s34
    ds_read_b64_tr_b16 v[16:17], v102 offset:0
    v_mfma_f32_16x16x32_bf16 v[148:151], v[20:23], a[4:7], 0
    s_lshl3_add_u32 s33, s37, s35
    ds_read_b64_tr_b16 v[18:19], v102 offset:8192
    v_mfma_f32_16x16x32_bf16 v[148:151], v[36:39], a[20:23], v[148:151]
    ds_read_b64_tr_b16 v[32:33], v102 offset:49152
    v_mfma_f32_16x16x32_bf16 v[152:155], v[20:23], a[8:11], 0
    buffer_load_dwordx4 v1, s[28:31], s32 offen offset:3072 sc1 lds
    v_mfma_f32_16x16x32_bf16 v[152:155], v[36:39], a[24:27], v[152:155]
    ds_read_b64_tr_b16 v[34:35], v102 offset:57344
    v_mfma_f32_16x16x32_bf16 v[156:159], v[20:23], a[12:15], 0
    s_mov_b32 m0, s59
    ds_read_b128 a[32:35], v100 offset:0
    v_mfma_f32_16x16x32_bf16 v[156:159], v[36:39], a[28:31], v[156:159]
    s_waitcnt lgkmcnt(7)
    ds_read_b128 a[48:51], v100 offset:49152
    v_mfma_f32_16x16x32_bf16 v[160:163], v[24:27], a[0:3], 0
    buffer_load_dwordx4 v4, s[12:15], s33 offen offset:0 lds
    v_mfma_f32_16x16x32_bf16 v[160:163], v[40:43], a[16:19], v[160:163]
    s_add_u32 s68, s68, 1
    ds_read_b128 a[36:39], v100 offset:1024
    v_mfma_f32_16x16x32_bf16 v[164:167], v[24:27], a[4:7], 0
    ds_read_b128 a[52:55], v100 offset:50176
    v_readlane_b32 s34, v3, s68
    v_mfma_f32_16x16x32_bf16 v[164:167], v[40:43], a[20:23], v[164:167]
    s_lshl_b64 s[66:67], s[66:67], 2
    ds_read_b128 a[40:43], v100 offset:4096
    v_mfma_f32_16x16x32_bf16 v[168:171], v[24:27], a[8:11], 0
    buffer_load_dwordx4 v5, s[12:15], s33 offen offset:1024 lds
    v_mfma_f32_16x16x32_bf16 v[168:171], v[40:43], a[24:27], v[168:171]
    s_add_u32 s36, s36, 8192
    ds_read_b128 a[56:59], v100 offset:53248
    v_mfma_f32_16x16x32_bf16 v[172:175], v[24:27], a[12:15], 0
    s_and_b32 s36, s36, 0xe000
    ds_read_b128 a[44:47], v100 offset:5120
    v_cmp_eq_u32 vcc, v12, v8
    v_mfma_f32_16x16x32_bf16 v[172:175], v[40:43], a[28:31], v[172:175]
    s_waitcnt lgkmcnt(11)
    ds_read_b128 a[60:63], v100 offset:54272
    v_mfma_f32_16x16x32_bf16 v[176:179], v[28:31], a[0:3], 0
    buffer_load_dwordx4 v1, s[28:31], s37 offen offset:2048 sc1 lds
    v_mfma_f32_16x16x32_bf16 v[176:179], v[44:47], a[16:19], v[176:179]
    s_add_u32 s32, s36, s34
    ds_read_b64_tr_b16 v[20:21], v103 offset:0
    v_mfma_f32_16x16x32_bf16 v[180:183], v[28:31], a[4:7], 0
    s_lshl3_add_u32 s33, s32, s35
    ds_read_b64_tr_b16 v[22:23], v103 offset:8192
    v_mfma_f32_16x16x32_bf16 v[180:183], v[44:47], a[20:23], v[180:183]
    ds_read_b64_tr_b16 v[36:37], v103 offset:49152
    v_mfma_f32_16x16x32_bf16 v[184:187], v[28:31], a[8:11], 0
    buffer_load_dwordx4 v1, s[28:31], s37 offen offset:3072 sc1 lds
    v_mfma_f32_16x16x32_bf16 v[184:187], v[44:47], a[24:27], v[184:187]
    s_andn2_b64 s[4:5], s[66:67], vcc
    ds_read_b64_tr_b16 v[38:39], v103 offset:57344
    v_mfma_f32_16x16x32_bf16 v[188:191], v[28:31], a[12:15], 0
    s_mov_b32 m0, s53
    ds_read_b64_tr_b16 v[24:25], v112 offset:0
    v_mfma_f32_16x16x32_bf16 v[188:191], v[44:47], a[28:31], v[188:191]
    ds_read_b64_tr_b16 v[26:27], v112 offset:8192
    s_waitcnt lgkmcnt(6)
    s_waitcnt vmcnt(8)
    buffer_store_short v11, v10, s[28:31], s71 offen sc1
    v_mul_f32 v52, 0xbfb8aa3b, v48
    v_mul_f32 v53, 0xbfb8aa3b, v49
    v_mul_f32 v54, 0xbfb8aa3b, v50
    v_mul_f32 v55, 0xbfb8aa3b, v51
    v_rcp_f32 v48, v48
    v_rcp_f32 v49, v49
    v_rcp_f32 v50, v50
    v_rcp_f32 v51, v51
    s_branch L_c_loop
L_c_late:
    v_smfmac_f32_16x16x64_bf16 a[144:147], a[160:163], v[192:199], v0
    ds_read_b64_tr_b16 a[236:237], v105 offset:57344
    v_smfmac_f32_16x16x64_bf16 a[148:151], a[160:163], v[200:207], v0
    ds_read_b64_tr_b16 a[238:239], v105 offset:61440
    v_smfmac_f32_16x16x64_bf16 a[152:155], a[160:163], v[208:215], v0
    s_waitcnt lgkmcnt(4)
    ds_read_b64_tr_b16 a[240:241], v106 offset:49152
    v_smfmac_f32_16x16x64_bf16 a[156:159], a[160:163], v[216:223], v0
    ds_read_b64_tr_b16 a[242:243], v106 offset:53248
    v_mfma_f32_16x16x32_bf16 a[0:3], a[224:227], v[192:195], a[0:3]
    ds_read_b64_tr_b16 a[244:245], v106 offset:57344
    v_mfma_f32_16x16x32_bf16 a[0:3], a[228:231], v[196:199], a[0:3]
    ds_read_b64_tr_b16 a[246:247], v106 offset:61440
    v_mfma_f32_16x16x32_bf16 a[4:7], a[224:227], v[200:203], a[4:7]
    ds_read_b64_tr_b16 a[248:249], v107 offset:49152
    v_accvgpr_read_b32 v116, a144
    v_mfma_f32_16x16x32_bf16 a[4:7], a[228:231], v[204:207], a[4:7]
    ds_read_b64_tr_b16 a[250:251], v107 offset:53248
    v_accvgpr_read_b32 v117, a148
    v_mfma_f32_16x16x32_bf16 a[8:11], a[224:227], v[208:211], a[8:11]
    ds_read_b64_tr_b16 a[252:253], v107 offset:57344
    v_accvgpr_read_b32 v118, a152
    v_mfma_f32_16x16x32_bf16 a[8:11], a[228:231], v[212:215], a[8:11]
    ds_read_b64_tr_b16 a[254:255], v107 offset:61440
    v_accvgpr_read_b32 v119, a156
    v_mfma_f32_16x16x32_bf16 a[12:15], a[224:227], v[216:219], a[12:15]
    s_waitcnt lgkmcnt(8)
    buffer_load_dwordx4 v4, s[12:15], s33 offen offset:0 lds
    v_mfma_f32_16x16x32_bf16 a[12:15], a[228:231], v[220:223], a[12:15]
    buffer_load_dwordx4 v5, s[12:15], s33 offen offset:1024 lds
    v_mfma_f32_16x16x32_bf16 a[16:19], a[232:235], v[192:195], a[16:19]
    s_add_u32 s36, s36, 8192
    s_mov_b32 m0, s57
    s_and_b32 s36, s36, 0xe000
    ds_read_b64_tr_b16 a[224:225], v108 offset:49152
    v_mfma_f32_16x16x32_bf16 a[16:19], a[236:239], v[196:199], a[16:19]
    s_add_u32 s37, s36, s34
    s_lshl3_add_u32 s33, s37, s35
    ds_read_b64_tr_b16 a[226:227], v108 offset:53248
    v_mfma_f32_16x16x32_bf16 a[20:23], a[232:235], v[200:203], a[20:23]
    ds_read_b64_tr_b16 a[228:229], v108 offset:57344
    v_accvgpr_read_b32 v120, a145
    v_mfma_f32_16x16x32_bf16 a[20:23], a[236:239], v[204:207], a[20:23]
    ds_read_b64_tr_b16 a[230:231], v108 offset:61440
    v_accvgpr_read_b32 v121, a149
    v_mfma_f32_16x16x32_bf16 a[24:27], a[232:235], v[208:211], a[24:27]
    buffer_load_dwordx4 v4, s[12:15], s33 offen offset:0 lds
    v_mfma_f32_16x16x32_bf16 a[24:27], a[236:239], v[212:215], a[24:27]
    buffer_load_dwordx4 v5, s[12:15], s33 offen offset:1024 lds
    v_mfma_f32_16x16x32_bf16 a[28:31], a[232:235], v[216:219], a[28:31]
    s_waitcnt lgkmcnt(8)
    s_add_u32 s36, s36, 8192
    s_mov_b32 m0, s58
    v_accvgpr_read_b32 v122, a153
    v_mfma_f32_16x16x32_bf16 a[28:31], a[236:239], v[220:223], a[28:31]
    s_and_b32 s36, s36, 0xe000
    s_add_u32 s32, s36, s34
    v_accvgpr_read_b32 v123, a157
    v_mfma_f32_16x16x32_bf16 a[32:35], a[240:243], v[192:195], a[32:35]
    s_lshl3_add_u32 s33, s32, s35
    ds_read_b64_tr_b16 a[232:233], v109 offset:49152
    v_add_f32 v116, v116, v120
    v_mfma_f32_16x16x32_bf16 a[32:35], a[244:247], v[196:199], a[32:35]
    ds_read_b64_tr_b16 a[234:235], v109 offset:53248
    v_add_f32 v117, v117, v121
    v_mfma_f32_16x16x32_bf16 a[36:39], a[240:243], v[200:203], a[36:39]
    ds_read_b64_tr_b16 a[236:237], v109 offset:57344
    v_add_f32 v118, v118, v122
    v_mfma_f32_16x16x32_bf16 a[36:39], a[244:247], v[204:207], a[36:39]
    ds_read_b64_tr_b16 a[238:239], v109 offset:61440
    v_add_f32 v119, v119, v123
    v_mfma_f32_16x16x32_bf16 a[40:43], a[240:243], v[208:211], a[40:43]
    v_max3_u32 v120, v116, v117, v118
    v_max_u32 v120, v120, v119
    v_mfma_f32_16x16x32_bf16 a[40:43], a[244:247], v[212:215], a[40:43]
    v_cmp_le_u32 vcc, s44, v120
    v_mfma_f32_16x16x32_bf16 a[44:47], a[240:243], v[216:219], a[44:47]
    s_waitcnt lgkmcnt(8)
    s_cbranch_vccnz L_rare_0
L_back_s:
    v_mfma_f32_16x16x32_bf16 a[44:47], a[244:247], v[220:223], a[44:47]
    v_rcp_f32 v116, v116
    v_mfma_f32_16x16x32_bf16 a[48:51], a[248:251], v[192:195], a[48:51]
    ds_read_b64_tr_b16 a[240:241], v110 offset:49152
    v_mfma_f32_16x16x32_bf16 a[48:51], a[252:255], v[196:199], a[48:51]
    ds_read_b64_tr_b16 a[242:243], v110 offset:53248
    v_mfma_f32_16x16x32_bf16 a[52:55], a[248:251], v[200:203], a[52:55]
    ds_read_b64_tr_b16 a[244:245], v110 offset:57344
    v_mfma_f32_16x16x32_bf16 a[52:55], a[252:255], v[204:207], a[52:55]
    ds_read_b64_tr_b16 a[246:247], v110 offset:61440
    v_mfma_f32_16x16x32_bf16 a[56:59], a[248:251], v[208:211], a[56:59]
    v_rcp_f32 v117, v117
    v_mfma_f32_16x16x32_bf16 a[56:59], a[252:255], v[212:215], a[56:59]
    v_rcp_f32 v118, v118
    v_mfma_f32_16x16x32_bf16 a[60:63], a[248:251], v[216:219], a[60:63]
    s_waitcnt lgkmcnt(8)
    v_rcp_f32 v119, v119
    v_mfma_f32_16x16x32_bf16 a[60:63], a[252:255], v[220:223], a[60:63]
    v_accvgpr_read_b32 v16, a0
    v_accvgpr_read_b32 v17, a1
    v_mfma_f32_16x16x32_bf16 a[64:67], a[224:227], v[192:195], a[64:67]
    ds_read_b64_tr_b16 a[248:249], v111 offset:49152
    v_accvgpr_read_b32 v18, a2
    v_mfma_f32_16x16x32_bf16 a[64:67], a[228:231], v[196:199], a[64:67]
    ds_read_b64_tr_b16 a[250:251], v111 offset:53248
    v_accvgpr_read_b32 v19, a3
    v_mfma_f32_16x16x32_bf16 a[68:71], a[224:227], v[200:203], a[68:71]
    ds_read_b64_tr_b16 a[252:253], v111 offset:57344
    v_accvgpr_read_b32 v20, a16
    v_mfma_f32_16x16x32_bf16 a[68:71], a[228:231], v[204:207], a[68:71]
    ds_read_b64_tr_b16 a[254:255], v111 offset:61440
    v_accvgpr_read_b32 v21, a17
    v_mfma_f32_16x16x32_bf16 a[72:75], a[224:227], v[208:211], a[72:75]
    v_accvgpr_read_b32 v22, a18
    v_accvgpr_read_b32 v23, a19
    v_mfma_f32_16x16x32_bf16 a[72:75], a[228:231], v[212:215], a[72:75]
    v_mul_f32 v16, v16, v116
    v_mul_f32 v17, v17, v116
    v_mfma_f32_16x16x32_bf16 a[76:79], a[224:227], v[216:219], a[76:79]
    s_waitcnt lgkmcnt(8)
    v_mul_f32 v18, v18, v116
    v_mul_f32 v19, v19, v116
    v_mfma_f32_16x16x32_bf16 a[76:79], a[228:231], v[220:223], a[76:79]
    v_mul_f32 v20, v20, v116
    v_mul_f32 v21, v21, v116
    v_mfma_f32_16x16x32_bf16 a[80:83], a[232:235], v[192:195], a[80:83]
    v_mul_f32 v22, v22, v116
    v_mul_f32 v23, v23, v116
    v_mfma_f32_16x16x32_bf16 a[80:83], a[236:239], v[196:199], a[80:83]
    v_cvt_pk_bf16_f32 v16, v16, v17
    v_cvt_pk_bf16_f32 v17, v18, v19
    v_mfma_f32_16x16x32_bf16 a[84:87], a[232:235], v[200:203], a[84:87]
    v_cvt_pk_bf16_f32 v18, v20, v21
    v_cvt_pk_bf16_f32 v19, v22, v23
    v_mfma_f32_16x16x32_bf16 a[84:87], a[236:239], v[204:207], a[84:87]
    buffer_store_dwordx4 v[16:19], v115, s[28:31], s49 offen offset:0 sc1
    v_mfma_f32_16x16x32_bf16 a[88:91], a[232:235], v[208:211], a[88:91]
    v_accvgpr_read_b32 v24, a4
    v_accvgpr_read_b32 v25, a5
    v_mfma_f32_16x16x32_bf16 a[88:91], a[236:239], v[212:215], a[88:91]
    v_accvgpr_read_b32 v26, a6
    v_accvgpr_read_b32 v27, a7
    v_mfma_f32_16x16x32_bf16 a[92:95], a[232:235], v[216:219], a[92:95]
    s_waitcnt lgkmcnt(4)
    v_accvgpr_read_b32 v28, a20
    v_accvgpr_read_b32 v29, a21
    v_mfma_f32_16x16x32_bf16 a[92:95], a[236:239], v[220:223], a[92:95]
    v_accvgpr_read_b32 v30, a22
    v_accvgpr_read_b32 v31, a23
    v_mfma_f32_16x16x32_bf16 a[96:99], a[240:243], v[192:195], a[96:99]
    v_mul_f32 v24, v24, v117
    v_mul_f32 v25, v25, v117
    v_mfma_f32_16x16x32_bf16 a[96:99], a[244:247], v[196:199], a[96:99]
    v_mul_f32 v26, v26, v117
    v_mul_f32 v27, v27, v117
    v_mfma_f32_16x16x32_bf16 a[100:103], a[240:243], v[200:203], a[100:103]
    v_mul_f32 v28, v28, v117
    v_mul_f32 v29, v29, v117
    v_mfma_f32_16x16x32_bf16 a[100:103], a[244:247], v[204:207], a[100:103]
    v_mul_f32 v30, v30, v117
    v_mul_f32 v31, v31, v117
    v_mfma_f32_16x16x32_bf16 a[104:107], a[240:243], v[208:211], a[104:107]
    v_cvt_pk_bf16_f32 v24, v24, v25
    v_cvt_pk_bf16_f32 v25, v26, v27
    v_mfma_f32_16x16x32_bf16 a[104:107], a[244:247], v[212:215], a[104:107]
    v_cvt_pk_bf16_f32 v26, v28, v29
    v_cvt_pk_bf16_f32 v27, v30, v31
    v_mfma_f32_16x16x32_bf16 a[108:111], a[240:243], v[216:219], a[108:111]
    s_waitcnt lgkmcnt(0)
    buffer_store_dwordx4 v[24:27], v115, s[28:31], s49 offen offset:1024 sc1
    v_mfma_f32_16x16x32_bf16 a[108:111], a[244:247], v[220:223], a[108:111]
    v_accvgpr_read_b32 v32, a8
    v_accvgpr_read_b32 v33, a9
    v_mfma_f32_16x16x32_bf16 a[112:115], a[248:251], v[192:195], a[112:115]
    v_accvgpr_read_b32 v34, a10
    v_accvgpr_read_b32 v35, a11
    v_mfma_f32_16x16x32_bf16 a[112:115], a[252:255], v[196:199], a[112:115]
    v_accvgpr_read_b32 v36, a24
    v_accvgpr_read_b32 v37, a25
    v_mfma_f32_16x16x32_bf16 a[116:119], a[248:251], v[200:203], a[116:119]
    v_accvgpr_read_b32 v38, a26
    v_accvgpr_read_b32 v39, a27
    v_mfma_f32_16x16x32_bf16 a[116:119], a[252:255], v[204:207], a[116:119]
    v_mul_f32 v32, v32, v118
    v_mul_f32 v33, v33, v118
    v_mfma_f32_16x16x32_bf16 a[120:123], a[248:251], v[208:211], a[120:123]
    v_mul_f32 v34, v34, v118
    v_mul_f32 v35, v35, v118
    v_mfma_f32_16x16x32_bf16 a[120:123], a[252:255], v[212:215], a[120:123]
    v_mul_f32 v36, v36, v118
    v_mul_f32 v37, v37, v118
    v_mfma_f32_16x16x32_bf16 a[124:127], a[248:251], v[216:219], a[124:127]
    v_mul_f32 v38, v38, v118
    v_mul_f32 v39, v39, v118
    v_mfma_f32_16x16x32_bf16 a[124:127], a[252:255], v[220:223], a[124:127]
    v_cvt_pk_bf16_f32 v32, v32, v33
    v_cvt_pk_bf16_f32 v33, v34, v35
    v_cvt_pk_bf16_f32 v34, v36, v37
    v_cvt_pk_bf16_f32 v35, v38, v39
    buffer_store_dwordx4 v[32:35], v115, s[28:31], s49 offen offset:2048 sc1
    v_accvgpr_read_b32 v40, a12
    v_accvgpr_read_b32 v41, a13
    v_accvgpr_read_b32 v42, a14
    v_accvgpr_read_b32 v43, a15
    v_accvgpr_read_b32 v44, a28
    v_accvgpr_read_b32 v45, a29
    v_accvgpr_read_b32 v46, a30
    v_accvgpr_read_b32 v47, a31
    v_pk_mul_f32 v[40:41], v[40:41], v[118:119] op_sel:[0,1] op_sel_hi:[1,1]
    v_pk_mul_f32 v[42:43], v[42:43], v[118:119] op_sel:[0,1] op_sel_hi:[1,1]
    v_pk_mul_f32 v[44:45], v[44:45], v[118:119] op_sel:[0,1] op_sel_hi:[1,1]
    v_pk_mul_f32 v[46:47], v[46:47], v[118:119] op_sel:[0,1] op_sel_hi:[1,1]
    v_cvt_pk_bf16_f32 v40, v40, v41
    v_cvt_pk_bf16_f32 v41, v42, v43
    v_cvt_pk_bf16_f32 v42, v44, v45
    v_cvt_pk_bf16_f32 v43, v46, v47
    buffer_store_dwordx4 v[40:43], v115, s[28:31], s49 offen offset:3072 sc1
    s_add_u32 s49, s49, 8192
    v_accvgpr_read_b32 v16, a32
    v_accvgpr_read_b32 v17, a33
    v_accvgpr_read_b32 v18, a34
    v_accvgpr_read_b32 v19, a35
    v_accvgpr_read_b32 v20, a48
    v_accvgpr_read_b32 v21, a49
    v_accvgpr_read_b32 v22, a50
    v_accvgpr_read_b32 v23, a51
    v_pk_mul_f32 v[16:17], v[16:17], v[116:117] op_sel:[0,0] op_sel_hi:[1,0]
    v_pk_mul_f32 v[18:19], v[18:19], v[116:117] op_sel:[0,0] op_sel_hi:[1,0]
    v_pk_mul_f32 v[20:21], v[20:21], v[116:117] op_sel:[0,0] op_sel_hi:[1,0]
    v_pk_mul_f32 v[22:23], v[22:23], v[116:117] op_sel:[0,0] op_sel_hi:[1,0]
    v_cvt_pk_bf16_f32 v16, v16, v17
    v_cvt_pk_bf16_f32 v17, v18, v19
    v_cvt_pk_bf16_f32 v18, v20, v21
    v_cvt_pk_bf16_f32 v19, v22, v23
    buffer_store_dwordx4 v[16:19], v115, s[28:31], s49 offen offset:0 sc1
    v_accvgpr_read_b32 v24, a36
    v_accvgpr_read_b32 v25, a37
    v_accvgpr_read_b32 v26, a38
    v_accvgpr_read_b32 v27, a39
    v_accvgpr_read_b32 v28, a52
    v_accvgpr_read_b32 v29, a53
    v_accvgpr_read_b32 v30, a54
    v_accvgpr_read_b32 v31, a55
    v_pk_mul_f32 v[24:25], v[24:25], v[116:117] op_sel:[0,1] op_sel_hi:[1,1]
    v_pk_mul_f32 v[26:27], v[26:27], v[116:117] op_sel:[0,1] op_sel_hi:[1,1]
    v_pk_mul_f32 v[28:29], v[28:29], v[116:117] op_sel:[0,1] op_sel_hi:[1,1]
    v_pk_mul_f32 v[30:31], v[30:31], v[116:117] op_sel:[0,1] op_sel_hi:[1,1]
    v_cvt_pk_bf16_f32 v24, v24, v25
    v_cvt_pk_bf16_f32 v25, v26, v27
    v_cvt_pk_bf16_f32 v26, v28, v29
    v_cvt_pk_bf16_f32 v27, v30, v31
    buffer_store_dwordx4 v[24:27], v115, s[28:31], s49 offen offset:1024 sc1
    v_accvgpr_read_b32 v32, a40
    v_accvgpr_read_b32 v33, a41
    v_accvgpr_read_b32 v34, a42
    v_accvgpr_read_b32 v35, a43
    v_accvgpr_read_b32 v36, a56
    v_accvgpr_read_b32 v37, a57
    v_accvgpr_read_b32 v38, a58
    v_accvgpr_read_b32 v39, a59
    v_pk_mul_f32 v[32:33], v[32:33], v[118:119] op_sel:[0,0] op_sel_hi:[1,0]
    v_pk_mul_f32 v[34:35], v[34:35], v[118:119] op_sel:[0,0] op_sel_hi:[1,0]
    v_pk_mul_f32 v[36:37], v[36:37], v[118:119] op_sel:[0,0] op_sel_hi:[1,0]
    v_pk_mul_f32 v[38:39], v[38:39], v[118:119] op_sel:[0,0] op_sel_hi:[1,0]
    v_cvt_pk_bf16_f32 v32, v32, v33
    v_cvt_pk_bf16_f32 v33, v34, v35
    v_cvt_pk_bf16_f32 v34, v36, v37
    v_cvt_pk_bf16_f32 v35, v38, v39
    buffer_store_dwordx4 v[32:35], v115, s[28:31], s49 offen offset:2048 sc1
    v_accvgpr_read_b32 v40, a44
    v_accvgpr_read_b32 v41, a45
    v_accvgpr_read_b32 v42, a46
    v_accvgpr_read_b32 v43, a47
    v_accvgpr_read_b32 v44, a60
    v_accvgpr_read_b32 v45, a61
    v_accvgpr_read_b32 v46, a62
    v_accvgpr_read_b32 v47, a63
    v_pk_mul_f32 v[40:41], v[40:41], v[118:119] op_sel:[0,1] op_sel_hi:[1,1]
    v_pk_mul_f32 v[42:43], v[42:43], v[118:119] op_sel:[0,1] op_sel_hi:[1,1]
    v_pk_mul_f32 v[44:45], v[44:45], v[118:119] op_sel:[0,1] op_sel_hi:[1,1]
    v_pk_mul_f32 v[46:47], v[46:47], v[118:119] op_sel:[0,1] op_sel_hi:[1,1]
    v_cvt_pk_bf16_f32 v40, v40, v41
    v_cvt_pk_bf16_f32 v41, v42, v43
    v_cvt_pk_bf16_f32 v42, v44, v45
    v_cvt_pk_bf16_f32 v43, v46, v47
    buffer_store_dwordx4 v[40:43], v115, s[28:31], s49 offen offset:3072 sc1
    s_add_u32 s49, s49, 8192
    v_accvgpr_read_b32 v16, a64
    v_accvgpr_read_b32 v17, a65
    v_accvgpr_read_b32 v18, a66
    v_accvgpr_read_b32 v19, a67
    v_accvgpr_read_b32 v20, a80
    v_accvgpr_read_b32 v21, a81
    v_accvgpr_read_b32 v22, a82
    v_accvgpr_read_b32 v23, a83
    v_pk_mul_f32 v[16:17], v[16:17], v[116:117] op_sel:[0,0] op_sel_hi:[1,0]
    v_pk_mul_f32 v[18:19], v[18:19], v[116:117] op_sel:[0,0] op_sel_hi:[1,0]
    v_pk_mul_f32 v[20:21], v[20:21], v[116:117] op_sel:[0,0] op_sel_hi:[1,0]
    v_pk_mul_f32 v[22:23], v[22:23], v[116:117] op_sel:[0,0] op_sel_hi:[1,0]
    v_cvt_pk_bf16_f32 v16, v16, v17
    v_cvt_pk_bf16_f32 v17, v18, v19
    v_cvt_pk_bf16_f32 v18, v20, v21
    v_cvt_pk_bf16_f32 v19, v22, v23
    buffer_store_dwordx4 v[16:19], v115, s[28:31], s49 offen offset:0 sc1
    v_accvgpr_read_b32 v24, a68
    v_accvgpr_read_b32 v25, a69
    v_accvgpr_read_b32 v26, a70
    v_accvgpr_read_b32 v27, a71
    v_accvgpr_read_b32 v28, a84
    v_accvgpr_read_b32 v29, a85
    v_accvgpr_read_b32 v30, a86
    v_accvgpr_read_b32 v31, a87
    v_pk_mul_f32 v[24:25], v[24:25], v[116:117] op_sel:[0,1] op_sel_hi:[1,1]
    v_pk_mul_f32 v[26:27], v[26:27], v[116:117] op_sel:[0,1] op_sel_hi:[1,1]
    v_pk_mul_f32 v[28:29], v[28:29], v[116:117] op_sel:[0,1] op_sel_hi:[1,1]
    v_pk_mul_f32 v[30:31], v[30:31], v[116:117] op_sel:[0,1] op_sel_hi:[1,1]
    v_cvt_pk_bf16_f32 v24, v24, v25
    v_cvt_pk_bf16_f32 v25, v26, v27
    v_cvt_pk_bf16_f32 v26, v28, v29
    v_cvt_pk_bf16_f32 v27, v30, v31
    buffer_store_dwordx4 v[24:27], v115, s[28:31], s49 offen offset:1024 sc1
    v_accvgpr_read_b32 v32, a72
    v_accvgpr_read_b32 v33, a73
    v_accvgpr_read_b32 v34, a74
    v_accvgpr_read_b32 v35, a75
    v_accvgpr_read_b32 v36, a88
    v_accvgpr_read_b32 v37, a89
    v_accvgpr_read_b32 v38, a90
    v_accvgpr_read_b32 v39, a91
    v_pk_mul_f32 v[32:33], v[32:33], v[118:119] op_sel:[0,0] op_sel_hi:[1,0]
    v_pk_mul_f32 v[34:35], v[34:35], v[118:119] op_sel:[0,0] op_sel_hi:[1,0]
    v_pk_mul_f32 v[36:37], v[36:37], v[118:119] op_sel:[0,0] op_sel_hi:[1,0]
    v_pk_mul_f32 v[38:39], v[38:39], v[118:119] op_sel:[0,0] op_sel_hi:[1,0]
    v_cvt_pk_bf16_f32 v32, v32, v33
    v_cvt_pk_bf16_f32 v33, v34, v35
    v_cvt_pk_bf16_f32 v34, v36, v37
    v_cvt_pk_bf16_f32 v35, v38, v39
    buffer_store_dwordx4 v[32:35], v115, s[28:31], s49 offen offset:2048 sc1
    v_accvgpr_read_b32 v40, a76
    v_accvgpr_read_b32 v41, a77
    v_accvgpr_read_b32 v42, a78
    v_accvgpr_read_b32 v43, a79
    v_accvgpr_read_b32 v44, a92
    v_accvgpr_read_b32 v45, a93
    v_accvgpr_read_b32 v46, a94
    v_accvgpr_read_b32 v47, a95
    v_pk_mul_f32 v[40:41], v[40:41], v[118:119] op_sel:[0,1] op_sel_hi:[1,1]
    v_pk_mul_f32 v[42:43], v[42:43], v[118:119] op_sel:[0,1] op_sel_hi:[1,1]
    v_pk_mul_f32 v[44:45], v[44:45], v[118:119] op_sel:[0,1] op_sel_hi:[1,1]
    v_pk_mul_f32 v[46:47], v[46:47], v[118:119] op_sel:[0,1] op_sel_hi:[1,1]
    v_cvt_pk_bf16_f32 v40, v40, v41
    v_cvt_pk_bf16_f32 v41, v42, v43
    v_cvt_pk_bf16_f32 v42, v44, v45
    v_cvt_pk_bf16_f32 v43, v46, v47
    buffer_store_dwordx4 v[40:43], v115, s[28:31], s49 offen offset:3072 sc1
    s_add_u32 s49, s49, 8192
    v_accvgpr_read_b32 v16, a96
    v_accvgpr_read_b32 v17, a97
    v_accvgpr_read_b32 v18, a98
    v_accvgpr_read_b32 v19, a99
    v_accvgpr_read_b32 v20, a112
    v_accvgpr_read_b32 v21, a113
    v_accvgpr_read_b32 v22, a114
    v_accvgpr_read_b32 v23, a115
    v_pk_mul_f32 v[16:17], v[16:17], v[116:117] op_sel:[0,0] op_sel_hi:[1,0]
    v_pk_mul_f32 v[18:19], v[18:19], v[116:117] op_sel:[0,0] op_sel_hi:[1,0]
    v_pk_mul_f32 v[20:21], v[20:21], v[116:117] op_sel:[0,0] op_sel_hi:[1,0]
    v_pk_mul_f32 v[22:23], v[22:23], v[116:117] op_sel:[0,0] op_sel_hi:[1,0]
    v_cvt_pk_bf16_f32 v16, v16, v17
    v_cvt_pk_bf16_f32 v17, v18, v19
    v_cvt_pk_bf16_f32 v18, v20, v21
    v_cvt_pk_bf16_f32 v19, v22, v23
    buffer_store_dwordx4 v[16:19], v115, s[28:31], s49 offen offset:0 sc1
    v_accvgpr_read_b32 v24, a100
    v_accvgpr_read_b32 v25, a101
    v_accvgpr_read_b32 v26, a102
    v_accvgpr_read_b32 v27, a103
    v_accvgpr_read_b32 v28, a116
    v_accvgpr_read_b32 v29, a117
    v_accvgpr_read_b32 v30, a118
    v_accvgpr_read_b32 v31, a119
    v_pk_mul_f32 v[24:25], v[24:25], v[116:117] op_sel:[0,1] op_sel_hi:[1,1]
    v_pk_mul_f32 v[26:27], v[26:27], v[116:117] op_sel:[0,1] op_sel_hi:[1,1]
    v_pk_mul_f32 v[28:29], v[28:29], v[116:117] op_sel:[0,1] op_sel_hi:[1,1]
    v_pk_mul_f32 v[30:31], v[30:31], v[116:117] op_sel:[0,1] op_sel_hi:[1,1]
    v_cvt_pk_bf16_f32 v24, v24, v25
    v_cvt_pk_bf16_f32 v25, v26, v27
    v_cvt_pk_bf16_f32 v26, v28, v29
    v_cvt_pk_bf16_f32 v27, v30, v31
    buffer_store_dwordx4 v[24:27], v115, s[28:31], s49 offen offset:1024 sc1
    v_accvgpr_read_b32 v32, a104
    v_accvgpr_read_b32 v33, a105
    v_accvgpr_read_b32 v34, a106
    v_accvgpr_read_b32 v35, a107
    v_accvgpr_read_b32 v36, a120
    v_accvgpr_read_b32 v37, a121
    v_accvgpr_read_b32 v38, a122
    v_accvgpr_read_b32 v39, a123
    v_pk_mul_f32 v[32:33], v[32:33], v[118:119] op_sel:[0,0] op_sel_hi:[1,0]
    v_pk_mul_f32 v[34:35], v[34:35], v[118:119] op_sel:[0,0] op_sel_hi:[1,0]
    v_pk_mul_f32 v[36:37], v[36:37], v[118:119] op_sel:[0,0] op_sel_hi:[1,0]
    v_pk_mul_f32 v[38:39], v[38:39], v[118:119] op_sel:[0,0] op_sel_hi:[1,0]
    v_cvt_pk_bf16_f32 v32, v32, v33
    v_cvt_pk_bf16_f32 v33, v34, v35
    v_cvt_pk_bf16_f32 v34, v36, v37
    v_cvt_pk_bf16_f32 v35, v38, v39
    buffer_store_dwordx4 v[32:35], v115, s[28:31], s49 offen offset:2048 sc1
    v_accvgpr_read_b32 v40, a108
    v_accvgpr_read_b32 v41, a109
    v_accvgpr_read_b32 v42, a110
    v_accvgpr_read_b32 v43, a111
    v_accvgpr_read_b32 v44, a124
    v_accvgpr_read_b32 v45, a125
    v_accvgpr_read_b32 v46, a126
    v_accvgpr_read_b32 v47, a127
    v_pk_mul_f32 v[40:41], v[40:41], v[118:119] op_sel:[0,1] op_sel_hi:[1,1]
    v_pk_mul_f32 v[42:43], v[42:43], v[118:119] op_sel:[0,1] op_sel_hi:[1,1]
    v_pk_mul_f32 v[44:45], v[44:45], v[118:119] op_sel:[0,1] op_sel_hi:[1,1]
    v_pk_mul_f32 v[46:47], v[46:47], v[118:119] op_sel:[0,1] op_sel_hi:[1,1]
    v_cvt_pk_bf16_f32 v40, v40, v41
    v_cvt_pk_bf16_f32 v41, v42, v43
    v_cvt_pk_bf16_f32 v42, v44, v45
    v_cvt_pk_bf16_f32 v43, v46, v47
    buffer_store_dwordx4 v[40:43], v115, s[28:31], s49 offen offset:3072 sc1
    s_waitcnt vmcnt(0)
    buffer_store_short v11, v10, s[28:31], s71 offen sc1
    s_waitcnt vmcnt(25)
    ds_bpermute_b32 v128, v13, v128
    ds_bpermute_b32 v129, v13, v129
    ds_bpermute_b32 v130, v13, v130
    ds_bpermute_b32 v131, v13, v131
    ds_bpermute_b32 v132, v13, v132
    ds_bpermute_b32 v133, v13, v133
    ds_bpermute_b32 v134, v13, v134
    ds_bpermute_b32 v135, v13, v135
    ds_bpermute_b32 v136, v13, v136
    ds_bpermute_b32 v137, v13, v137
    ds_bpermute_b32 v138, v13, v138
    ds_bpermute_b32 v139, v13, v139
    ds_bpermute_b32 v140, v13, v140
    ds_bpermute_b32 v141, v13, v141
    ds_bpermute_b32 v142, v13, v142
    ds_bpermute_b32 v143, v13, v143
    ds_bpermute_b32 v144, v13, v144
    ds_bpermute_b32 v145, v13, v145
    ds_bpermute_b32 v146, v13, v146
    ds_bpermute_b32 v147, v13, v147
    ds_bpermute_b32 v148, v13, v148
    ds_bpermute_b32 v149, v13, v149
    ds_bpermute_b32 v150, v13, v150
    ds_bpermute_b32 v151, v13, v151
    ds_bpermute_b32 v152, v13, v152
    ds_bpermute_b32 v153, v13, v153
    ds_bpermute_b32 v154, v13, v154
    ds_bpermute_b32 v155, v13, v155
    ds_bpermute_b32 v156, v13, v156
    ds_bpermute_b32 v157, v13, v157
    ds_bpermute_b32 v158, v13, v158
    ds_bpermute_b32 v159, v13, v159
    s_waitcnt lgkmcnt(15)
    v_permlane16_swap_b32 v128, v130
    v_permlane16_swap_b32 v129, v131
    s_waitcnt lgkmcnt(15)
    v_permlane16_swap_b32 v132, v134
    v_permlane16_swap_b32 v133, v135
    s_waitcnt lgkmcnt(15)
    v_permlane16_swap_b32 v136, v138
    v_permlane16_swap_b32 v137, v139
    s_waitcnt lgkmcnt(15)
    v_permlane16_swap_b32 v140, v142
    v_permlane16_swap_b32 v141, v143
    s_waitcnt lgkmcnt(12)
    v_permlane16_swap_b32 v144, v146
    v_permlane16_swap_b32 v145, v147
    s_waitcnt lgkmcnt(8)
    v_permlane16_swap_b32 v148, v150
    v_permlane16_swap_b32 v149, v151
    s_waitcnt lgkmcnt(4)
    v_permlane16_swap_b32 v152, v154
    v_permlane16_swap_b32 v153, v155
    s_waitcnt lgkmcnt(0)
    v_permlane16_swap_b32 v156, v158
    v_permlane16_swap_b32 v157, v159
    v_lshlrev_b32 v80, 16, v128
    v_and_b32 v81, 0xffff0000, v128
    v_lshlrev_b32 v82, 16, v129
    v_and_b32 v83, 0xffff0000, v129
    v_lshlrev_b32 v84, 16, v130
    v_and_b32 v85, 0xffff0000, v130
    v_lshlrev_b32 v86, 16, v131
    v_and_b32 v87, 0xffff0000, v131
    v_lshlrev_b32 v88, 16, v132
    v_and_b32 v89, 0xffff0000, v132
    v_lshlrev_b32 v90, 16, v133
    v_and_b32 v91, 0xffff0000, v133
    v_lshlrev_b32 v92, 16, v134
    v_and_b32 v93, 0xffff0000, v134
    v_lshlrev_b32 v94, 16, v135
    v_and_b32 v95, 0xffff0000, v135
    v_lshlrev_b32 v104, 16, v136
    v_and_b32 v105, 0xffff0000, v136
    v_lshlrev_b32 v106, 16, v137
    v_and_b32 v107, 0xffff0000, v137
    v_lshlrev_b32 v108, 16, v138
    v_and_b32 v109, 0xffff0000, v138
    v_lshlrev_b32 v110, 16, v139
    v_and_b32 v111, 0xffff0000, v139
    v_lshlrev_b32 v116, 16, v140
    v_and_b32 v117, 0xffff0000, v140
    v_lshlrev_b32 v118, 16, v141
    v_and_b32 v119, 0xffff0000, v141
    v_lshlrev_b32 v120, 16, v142
    v_and_b32 v121, 0xffff0000, v142
    v_lshlrev_b32 v122, 16, v143
    v_and_b32 v123, 0xffff0000, v143
    v_lshlrev_b32 v48, 16, v144
    v_and_b32 v49, 0xffff0000, v144
    v_lshlrev_b32 v50, 16, v145
    v_and_b32 v51, 0xffff0000, v145
    v_lshlrev_b32 v52, 16, v146
    v_and_b32 v53, 0xffff0000, v146
    v_lshlrev_b32 v54, 16, v147
    v_and_b32 v55, 0xffff0000, v147
    v_lshlrev_b32 v56, 16, v148
    v_and_b32 v57, 0xffff0000, v148
    v_lshlrev_b32 v58, 16, v149
    v_and_b32 v59, 0xffff0000, v149
    v_lshlrev_b32 v60, 16, v150
    v_and_b32 v61, 0xffff0000, v150
    v_lshlrev_b32 v62, 16, v151
    v_and_b32 v63, 0xffff0000, v151
    v_lshlrev_b32 v64, 16, v152
    v_and_b32 v65, 0xffff0000, v152
    v_lshlrev_b32 v66, 16, v153
    v_and_b32 v67, 0xffff0000, v153
    v_lshlrev_b32 v68, 16, v154
    v_and_b32 v69, 0xffff0000, v154
    v_lshlrev_b32 v70, 16, v155
    v_and_b32 v71, 0xffff0000, v155
    v_lshlrev_b32 v72, 16, v156
    v_and_b32 v73, 0xffff0000, v156
    v_lshlrev_b32 v74, 16, v157
    v_and_b32 v75, 0xffff0000, v157
    v_lshlrev_b32 v76, 16, v158
    v_and_b32 v77, 0xffff0000, v158
    v_lshlrev_b32 v78, 16, v159
    v_and_b32 v79, 0xffff0000, v159
    s_cmp_eq_u32 s3, 0
    s_cbranch_scc0 L_spun_0
L_spin_0:
    s_mov_b32 s7, 0x100000
L_spin2_0:
    buffer_load_dword v8, v9, s[28:31], s100 offen sc1
    s_waitcnt vmcnt(0)
    v_cmp_eq_u32 vcc, v12, v8
    s_nop 0
    s_andn2_b64 s[4:5], s[66:67], vcc
    s_cbranch_scc0 L_spun_0
    s_sub_u32 s7, s7, 1
    s_cbranch_scc0 L_spin2_0
L_spun_0:
    s_barrier
    buffer_load_dword v8, v9, s[28:31], s100 offen sc1
    s_mov_b32 m0, s53
    s_add_u32 s4, s16, s34
    buffer_load_dwordx4 v1, s[28:31], s4 offen offset:2048 sc1 lds
    buffer_load_dwordx4 v1, s[28:31], s4 offen offset:3072 sc1 lds
    s_add_u32 s16, s16, 8192
    s_and_b32 s16, s16, 0xe000
    s_mov_b32 m0, s54
    s_add_u32 s4, s16, s34
    buffer_load_dwordx4 v1, s[28:31], s4 offen offset:2048 sc1 lds
    buffer_load_dwordx4 v1, s[28:31], s4 offen offset:3072 sc1 lds
    s_add_u32 s16, s16, 8192
    s_and_b32 s16, s16, 0xe000
    s_mov_b32 m0, s52
    s_add_u32 s4, s16, s34
    buffer_load_dwordx4 v1, s[28:31], s4 offen offset:2048 sc1 lds
    buffer_load_dwordx4 v1, s[28:31], s4 offen offset:3072 sc1 lds
    s_add_u32 s16, s16, 8192
    s_and_b32 s16, s16, 0xe000
    s_mov_b32 m0, s55
    s_add_u32 s4, s16, s34
    buffer_load_dwordx4 v1, s[28:31], s4 offen offset:2048 sc1 lds
    buffer_load_dwordx4 v1, s[28:31], s4 offen offset:3072 sc1 lds
    s_add_u32 s16, s16, 8192
    s_and_b32 s16, s16, 0xe000
    s_mov_b32 m0, s56
    s_add_u32 s4, s16, s34
    buffer_load_dwordx4 v1, s[28:31], s4 offen offset:2048 sc1 lds
    buffer_load_dwordx4 v1, s[28:31], s4 offen offset:3072 sc1 lds
    s_add_u32 s16, s16, 8192
    s_and_b32 s16, s16, 0xe000
    s_mov_b32 m0, s57
    s_add_u32 s4, s16, s34
    buffer_load_dwordx4 v1, s[28:31], s4 offen offset:2048 sc1 lds
    buffer_load_dwordx4 v1, s[28:31], s4 offen offset:3072 sc1 lds
    s_add_u32 s16, s16, 8192
    s_and_b32 s16, s16, 0xe000
    s_mov_b32 m0, s58
    s_waitcnt vmcnt(8)
    s_barrier
    ds_read_b64_tr_b16 v[16:17], v102 offset:16384
    ds_read_b64_tr_b16 v[18:19], v102 offset:24576
    ds_read_b128 a[0:3], v100 offset:16384
    ds_read_b64_tr_b16 v[32:33], v102 offset:32768
    ds_read_b64_tr_b16 v[34:35], v102 offset:40960
    ds_read_b128 a[16:19], v100 offset:32768
    ds_read_b128 a[4:7], v100 offset:17408
    ds_read_b128 a[20:23], v100 offset:33792
    ds_read_b128 a[8:11], v100 offset:20480
    ds_read_b128 a[24:27], v100 offset:36864
    ds_read_b128 a[12:15], v100 offset:21504
    ds_read_b128 a[28:31], v100 offset:37888
    ds_read_b64_tr_b16 v[20:21], v103 offset:16384
    ds_read_b64_tr_b16 v[22:23], v103 offset:24576
    ds_read_b64_tr_b16 v[36:37], v103 offset:32768
    ds_read_b64_tr_b16 v[38:39], v103 offset:40960
    ds_read_b64_tr_b16 v[24:25], v112 offset:16384
    ds_read_b64_tr_b16 v[26:27], v112 offset:24576
    s_waitcnt lgkmcnt(12)
    v_mfma_f32_16x16x32_bf16 v[128:131], v[16:19], a[0:3], 0
    buffer_load_dwordx4 v4, s[12:15], s33 offen offset:0 lds
    v_mfma_f32_16x16x32_bf16 v[128:131], v[32:35], a[16:19], v[128:131]
    s_waitcnt lgkmcnt(11)
    ds_read_b64_tr_b16 v[28:29], v113 offset:16384
    v_mfma_f32_16x16x32_bf16 v[132:135], v[16:19], a[4:7], 0
    s_waitcnt lgkmcnt(11)
    ds_read_b64_tr_b16 v[30:31], v113 offset:24576
    v_mfma_f32_16x16x32_bf16 v[132:135], v[32:35], a[20:23], v[132:135]
    s_waitcnt lgkmcnt(11)
    ds_read_b64_tr_b16 v[40:41], v112 offset:32768
    v_mfma_f32_16x16x32_bf16 v[136:139], v[16:19], a[8:11], 0
    s_waitcnt lgkmcnt(11)
    buffer_load_dwordx4 v5, s[12:15], s33 offen offset:1024 lds
    v_mfma_f32_16x16x32_bf16 v[136:139], v[32:35], a[24:27], v[136:139]
    s_add_u32 s36, s36, 8192
    s_waitcnt lgkmcnt(10)
    ds_read_b64_tr_b16 v[42:43], v112 offset:40960
    v_mfma_f32_16x16x32_bf16 v[140:143], v[16:19], a[12:15], 0
    s_and_b32 s36, s36, 0xe000
    s_waitcnt lgkmcnt(10)
    ds_read_b64_tr_b16 v[44:45], v113 offset:32768
    v_mfma_f32_16x16x32_bf16 v[140:143], v[32:35], a[28:31], v[140:143]
    s_waitcnt lgkmcnt(3)
    ds_read_b64_tr_b16 v[46:47], v113 offset:40960
    v_mfma_f32_16x16x32_bf16 v[144:147], v[20:23], a[0:3], 0
    s_waitcnt vmcnt(6)
    s_barrier
    buffer_load_dwordx4 v1, s[28:31], s32 offen offset:2048 sc1 lds
    v_mfma_f32_16x16x32_bf16 v[144:147], v[36:39], a[16:19], v[144:147]
    s_add_u32 s37, s36, s34
    ds_read_b64_tr_b16 v[16:17], v102 offset:0
    v_mfma_f32_16x16x32_bf16 v[148:151], v[20:23], a[4:7], 0
    s_lshl3_add_u32 s33, s37, s35
    ds_read_b64_tr_b16 v[18:19], v102 offset:8192
    v_mfma_f32_16x16x32_bf16 v[148:151], v[36:39], a[20:23], v[148:151]
    ds_read_b64_tr_b16 v[32:33], v102 offset:49152
    v_mfma_f32_16x16x32_bf16 v[152:155], v[20:23], a[8:11], 0
    buffer_load_dwordx4 v1, s[28:31], s32 offen offset:3072 sc1 lds
    v_mfma_f32_16x16x32_bf16 v[152:155], v[36:39], a[24:27], v[152:155]
    ds_read_b64_tr_b16 v[34:35], v102 offset:57344
    v_mfma_f32_16x16x32_bf16 v[156:159], v[20:23], a[12:15], 0
    s_mov_b32 m0, s59
    ds_read_b128 a[32:35], v100 offset:0
    v_mfma_f32_16x16x32_bf16 v[156:159], v[36:39], a[28:31], v[156:159]
    s_waitcnt lgkmcnt(7)
    ds_read_b128 a[48:51], v100 offset:49152
    v_mfma_f32_16x16x32_bf16 v[160:163], v[24:27], a[0:3], 0
    buffer_load_dwordx4 v4, s[12:15], s33 offen offset:0 lds
    v_mfma_f32_16x16x32_bf16 v[160:163], v[40:43], a[16:19], v[160:163]
    s_add_u32 s68, s68, 1
    ds_read_b128 a[36:39], v100 offset:1024
    v_mfma_f32_16x16x32_bf16 v[164:167], v[24:27], a[4:7], 0
    ds_read_b128 a[52:55], v100 offset:50176
    v_readlane_b32 s34, v3, s68
    v_mfma_f32_16x16x32_bf16 v[164:167], v[40:43], a[20:23], v[164:167]
    s_lshl_b64 s[66:67], s[66:67], 2
    ds_read_b128 a[40:43], v100 offset:4096
    v_mfma_f32_16x16x32_bf16 v[168:171], v[24:27], a[8:11], 0
    buffer_load_dwordx4 v5, s[12:15], s33 offen offset:1024 lds
    v_mfma_f32_16x16x32_bf16 v[168:171], v[40:43], a[24:27], v[168:171]
    s_add_u32 s36, s36, 8192
    ds_read_b128 a[56:59], v100 offset:53248
    v_mfma_f32_16x16x32_bf16 v[172:175], v[24:27], a[12:15], 0
    s_and_b32 s36, s36, 0xe000
    ds_read_b128 a[44:47], v100 offset:5120
    v_cmp_eq_u32 vcc, v12, v8
    v_mfma_f32_16x16x32_bf16 v[172:175], v[40:43], a[28:31], v[172:175]
    s_waitcnt lgkmcnt(11)
    ds_read_b128 a[60:63], v100 offset:54272
    v_mfma_f32_16x16x32_bf16 v[176:179], v[28:31], a[0:3], 0
    buffer_load_dwordx4 v1, s[28:31], s37 offen offset:2048 sc1 lds
    v_mfma_f32_16x16x32_bf16 v[176:179], v[44:47], a[16:19], v[176:179]
    s_add_u32 s32, s36, s34
    ds_read_b64_tr_b16 v[20:21], v103 offset:0
    v_mfma_f32_16x16x32_bf16 v[180:183], v[28:31], a[4:7], 0
    s_lshl3_add_u32 s33, s32, s35
    ds_read_b64_tr_b16 v[22:23], v103 offset:8192
    v_mfma_f32_16x16x32_bf16 v[180:183], v[44:47], a[20:23], v[180:183]
    ds_read_b64_tr_b16 v[36:37], v103 offset:49152
    v_mfma_f32_16x16x32_bf16 v[184:187], v[28:31], a[8:11], 0
    buffer_load_dwordx4 v1, s[28:31], s37 offen offset:3072 sc1 lds
    v_mfma_f32_16x16x32_bf16 v[184:187], v[44:47], a[24:27], v[184:187]
    s_andn2_b64 s[4:5], s[66:67], vcc
    ds_read_b64_tr_b16 v[38:39], v103 offset:57344
    v_mfma_f32_16x16x32_bf16 v[188:191], v[28:31], a[12:15], 0
    s_mov_b32 m0, s53
    ds_read_b64_tr_b16 v[24:25], v112 offset:0
    v_mfma_f32_16x16x32_bf16 v[188:191], v[44:47], a[28:31], v[188:191]
    ds_read_b64_tr_b16 v[26:27], v112 offset:8192
    s_waitcnt lgkmcnt(6)
    s_cbranch_scc0 L_c_loop
L_spin_l:
    s_mov_b32 s7, 0x100000
L_spin2_l:
    buffer_load_dword v8, v9, s[28:31], s100 offen sc1
    s_waitcnt vmcnt(0)
    v_cmp_eq_u32 vcc, v12, v8
    s_nop 0
    s_andn2_b64 s[4:5], s[66:67], vcc
    s_cbranch_scc0 L_c_loop
    s_sub_u32 s7, s7, 1
    s_cbranch_scc0 L_spin2_l
.p2align 6
L_c_loop:
    v_mfma_f32_16x16x32_bf16 v[128:131], v[16:19], a[32:35], v[128:131]
    buffer_load_dwordx4 v4, s[12:15], s33 offen offset:0 lds
    v_mfma_f32_16x16x32_bf16 v[128:131], v[32:35], a[48:51], v[128:131]
    ds_read_b64_tr_b16 v[28:29], v113 offset:0
    v_mfma_f32_16x16x32_bf16 v[132:135], v[16:19], a[36:39], v[132:135]
    ds_read_b64_tr_b16 v[30:31], v113 offset:8192
    v_mfma_f32_16x16x32_bf16 v[132:135], v[32:35], a[52:55], v[132:135]
    ds_read_b64_tr_b16 v[40:41], v112 offset:49152
    v_mfma_f32_16x16x32_bf16 v[136:139], v[16:19], a[40:43], v[136:139]
    buffer_load_dwordx4 v5, s[12:15], s33 offen offset:1024 lds
    v_mfma_f32_16x16x32_bf16 v[136:139], v[32:35], a[56:59], v[136:139]
    s_add_u32 s36, s36, 8192
    ds_read_b64_tr_b16 v[42:43], v112 offset:57344
    v_mfma_f32_16x16x32_bf16 v[140:143], v[16:19], a[44:47], v[140:143]
    s_and_b32 s36, s36, 0xe000
    ds_read_b64_tr_b16 v[44:45], v113 offset:49152
    v_mfma_f32_16x16x32_bf16 v[140:143], v[32:35], a[60:63], v[140:143]
    s_waitcnt lgkmcnt(3)
    ds_read_b64_tr_b16 v[46:47], v113 offset:57344
    v_mfma_f32_16x16x32_bf16 v[144:147], v[20:23], a[32:35], v[144:147]
    s_waitcnt vmcnt(10)
    s_barrier
    buffer_load_dwordx4 v1, s[28:31], s32 offen offset:2048 sc1 lds
    v_mfma_f32_16x16x32_bf16 v[144:147], v[36:39], a[48:51], v[144:147]
    s_add_u32 s37, s36, s34
    ds_read_b64_tr_b16 v[16:17], v114 offset:0
    v_mfma_f32_16x16x32_bf16 v[148:151], v[20:23], a[36:39], v[148:151]
    s_lshl3_add_u32 s33, s37, s35
    ds_read_b64_tr_b16 v[18:19], v114 offset:8192
    v_mfma_f32_16x16x32_bf16 v[148:151], v[36:39], a[52:55], v[148:151]
    ds_read_b64_tr_b16 v[32:33], v114 offset:16384
    v_mfma_f32_16x16x32_bf16 v[152:155], v[20:23], a[40:43], v[152:155]
    buffer_load_dwordx4 v1, s[28:31], s32 offen offset:3072 sc1 lds
    v_mfma_f32_16x16x32_bf16 v[152:155], v[36:39], a[56:59], v[152:155]
    ds_read_b64_tr_b16 v[34:35], v114 offset:24576
    v_mfma_f32_16x16x32_bf16 v[156:159], v[20:23], a[44:47], v[156:159]
    s_mov_b32 m0, s54
    ds_read_b128 a[0:3], v101 offset:0
    v_mfma_f32_16x16x32_bf16 v[156:159], v[36:39], a[60:63], v[156:159]
    s_waitcnt lgkmcnt(7)
    ds_read_b128 a[16:19], v101 offset:16384
    v_mfma_f32_16x16x32_bf16 v[160:163], v[24:27], a[32:35], v[160:163]
    buffer_load_dwordx4 v4, s[12:15], s33 offen offset:0 lds
    v_mfma_f32_16x16x32_bf16 v[160:163], v[40:43], a[48:51], v[160:163]
    ds_read_b128 a[4:7], v101 offset:1024
    v_mfma_f32_16x16x32_bf16 v[164:167], v[24:27], a[36:39], v[164:167]
    ds_read_b128 a[20:23], v101 offset:17408
    v_mfma_f32_16x16x32_bf16 v[164:167], v[40:43], a[52:55], v[164:167]
    ds_read_b128 a[8:11], v101 offset:4096
    v_mfma_f32_16x16x32_bf16 v[168:171], v[24:27], a[40:43], v[168:171]
    buffer_load_dwordx4 v5, s[12:15], s33 offen offset:1024 lds
    v_mfma_f32_16x16x32_bf16 v[168:171], v[40:43], a[56:59], v[168:171]
    s_add_u32 s36, s36, 8192
    ds_read_b128 a[24:27], v101 offset:20480
    v_mfma_f32_16x16x32_bf16 v[172:175], v[24:27], a[44:47], v[172:175]
    s_and_b32 s36, s36, 0xe000
    ds_read_b128 a[12:15], v101 offset:5120
    v_mfma_f32_16x16x32_bf16 v[172:175], v[40:43], a[60:63], v[172:175]
    s_waitcnt lgkmcnt(11)
    ds_read_b128 a[28:31], v101 offset:21504
    v_mfma_f32_16x16x32_bf16 v[176:179], v[28:31], a[32:35], v[176:179]
    buffer_load_dwordx4 v1, s[28:31], s37 offen offset:2048 sc1 lds
    v_mfma_f32_16x16x32_bf16 v[176:179], v[44:47], a[48:51], v[176:179]
    s_add_u32 s32, s36, s34
    ds_read_b64_tr_b16 v[20:21], v124 offset:0
    v_mfma_f32_16x16x32_bf16 v[180:183], v[28:31], a[36:39], v[180:183]
    s_lshl3_add_u32 s33, s32, s35
    ds_read_b64_tr_b16 v[22:23], v124 offset:8192
    v_mfma_f32_16x16x32_bf16 v[180:183], v[44:47], a[52:55], v[180:183]
    ds_read_b64_tr_b16 v[36:37], v124 offset:16384
    v_mfma_f32_16x16x32_bf16 v[184:187], v[28:31], a[40:43], v[184:187]
    buffer_load_dwordx4 v1, s[28:31], s37 offen offset:3072 sc1 lds
    v_mfma_f32_16x16x32_bf16 v[184:187], v[44:47], a[56:59], v[184:187]
    ds_read_b64_tr_b16 v[38:39], v124 offset:24576
    v_mfma_f32_16x16x32_bf16 v[188:191], v[28:31], a[44:47], v[188:191]
    s_mov_b32 m0, s52
    ds_read_b64_tr_b16 v[24:25], v125 offset:0
    v_mfma_f32_16x16x32_bf16 v[188:191], v[44:47], a[60:63], v[188:191]
    ds_read_b64_tr_b16 v[26:27], v125 offset:8192
    s_waitcnt lgkmcnt(6)
    v_mfma_f32_16x16x32_bf16 v[128:131], v[16:19], a[0:3], v[128:131]
    buffer_load_dwordx4 v4, s[12:15], s33 offen offset:0 lds
    v_mfma_f32_16x16x32_bf16 v[128:131], v[32:35], a[16:19], v[128:131]
    ds_read_b64_tr_b16 v[28:29], v126 offset:0
    v_mfma_f32_16x16x32_bf16 v[132:135], v[16:19], a[4:7], v[132:135]
    ds_read_b64_tr_b16 v[30:31], v126 offset:8192
    v_mfma_f32_16x16x32_bf16 v[132:135], v[32:35], a[20:23], v[132:135]
    ds_read_b64_tr_b16 v[40:41], v125 offset:16384
    v_mfma_f32_16x16x32_bf16 v[136:139], v[16:19], a[8:11], v[136:139]
    buffer_load_dwordx4 v5, s[12:15], s33 offen offset:1024 lds
    v_mfma_f32_16x16x32_bf16 v[136:139], v[32:35], a[24:27], v[136:139]
    s_add_u32 s36, s36, 8192
    ds_read_b64_tr_b16 v[42:43], v125 offset:24576
    v_mfma_f32_16x16x32_bf16 v[140:143], v[16:19], a[12:15], v[140:143]
    s_and_b32 s36, s36, 0xe000
    ds_read_b64_tr_b16 v[44:45], v126 offset:16384
    v_mfma_f32_16x16x32_bf16 v[140:143], v[32:35], a[28:31], v[140:143]
    s_waitcnt lgkmcnt(3)
    ds_read_b64_tr_b16 v[46:47], v126 offset:24576
    v_mfma_f32_16x16x32_bf16 v[144:147], v[20:23], a[0:3], v[144:147]
    s_waitcnt vmcnt(10)
    s_barrier
    buffer_load_dwordx4 v1, s[28:31], s32 offen offset:2048 sc1 lds
    v_mfma_f32_16x16x32_bf16 v[144:147], v[36:39], a[16:19], v[144:147]
    s_add_u32 s37, s36, s34
    ds_read_b64_tr_b16 v[16:17], v114 offset:32768
    v_mfma_f32_16x16x32_bf16 v[148:151], v[20:23], a[4:7], v[148:151]
    s_lshl3_add_u32 s33, s37, s35
    ds_read_b64_tr_b16 v[18:19], v114 offset:40960
    v_mfma_f32_16x16x32_bf16 v[148:151], v[36:39], a[20:23], v[148:151]
    ds_read_b64_tr_b16 v[32:33], v114 offset:49152
    v_mfma_f32_16x16x32_bf16 v[152:155], v[20:23], a[8:11], v[152:155]
    buffer_load_dwordx4 v1, s[28:31], s32 offen offset:3072 sc1 lds
    v_mfma_f32_16x16x32_bf16 v[152:155], v[36:39], a[24:27], v[152:155]
    ds_read_b64_tr_b16 v[34:35], v114 offset:57344
    buffer_load_dword v8, v9, s[28:31], s100 offen sc1
    v_mfma_f32_16x16x32_bf16 v[156:159], v[20:23], a[12:15], v[156:159]
    s_mov_b32 m0, s55
    ds_read_b128 a[32:35], v101 offset:32768
    v_mfma_f32_16x16x32_bf16 v[156:159], v[36:39], a[28:31], v[156:159]
    s_waitcnt lgkmcnt(7)
    ds_read_b128 a[48:51], v101 offset:49152
    v_mfma_f32_16x16x32_bf16 v[160:163], v[24:27], a[0:3], v[160:163]
    buffer_load_dwordx4 v4, s[12:15], s33 offen offset:0 lds
    v_mfma_f32_16x16x32_bf16 v[160:163], v[40:43], a[16:19], v[160:163]
    ds_read_b128 a[36:39], v101 offset:33792
    v_mfma_f32_16x16x32_bf16 v[164:167], v[24:27], a[4:7], v[164:167]
    ds_read_b128 a[52:55], v101 offset:50176
    v_mfma_f32_16x16x32_bf16 v[164:167], v[40:43], a[20:23], v[164:167]
    ds_read_b128 a[40:43], v101 offset:36864
    v_mfma_f32_16x16x32_bf16 v[168:171], v[24:27], a[8:11], v[168:171]
    buffer_load_dwordx4 v5, s[12:15], s33 offen offset:1024 lds
    v_mfma_f32_16x16x32_bf16 v[168:171], v[40:43], a[24:27], v[168:171]
    s_add_u32 s36, s36, 8192
    ds_read_b128 a[56:59], v101 offset:53248
    v_mfma_f32_16x16x32_bf16 v[172:175], v[24:27], a[12:15], v[172:175]
    s_and_b32 s36, s36, 0xe000
    ds_read_b128 a[44:47], v101 offset:37888
    v_mfma_f32_16x16x32_bf16 v[172:175], v[40:43], a[28:31], v[172:175]
    s_waitcnt lgkmcnt(11)
    ds_read_b128 a[60:63], v101 offset:54272
    v_mfma_f32_16x16x32_bf16 v[176:179], v[28:31], a[0:3], v[176:179]
    buffer_load_dwordx4 v1, s[28:31], s37 offen offset:2048 sc1 lds
    v_mfma_f32_16x16x32_bf16 v[176:179], v[44:47], a[16:19], v[176:179]
    s_add_u32 s32, s36, s34
    ds_read_b64_tr_b16 v[20:21], v124 offset:32768
    v_mfma_f32_16x16x32_bf16 v[180:183], v[28:31], a[4:7], v[180:183]
    s_lshl3_add_u32 s33, s32, s35
    ds_read_b64_tr_b16 v[22:23], v124 offset:40960
    v_mfma_f32_16x16x32_bf16 v[180:183], v[44:47], a[20:23], v[180:183]
    ds_read_b64_tr_b16 v[36:37], v124 offset:49152
    v_mfma_f32_16x16x32_bf16 v[184:187], v[28:31], a[8:11], v[184:187]
    buffer_load_dwordx4 v1, s[28:31], s37 offen offset:3072 sc1 lds
    v_mfma_f32_16x16x32_bf16 v[184:187], v[44:47], a[24:27], v[184:187]
    ds_read_b64_tr_b16 v[38:39], v124 offset:57344
    v_mfma_f32_16x16x32_bf16 v[188:191], v[28:31], a[12:15], v[188:191]
    s_mov_b32 m0, s56
    ds_read_b64_tr_b16 v[24:25], v125 offset:32768
    v_mfma_f32_16x16x32_bf16 v[188:191], v[44:47], a[28:31], v[188:191]
    ds_read_b64_tr_b16 v[26:27], v125 offset:40960
    s_waitcnt lgkmcnt(6)
    v_mfma_f32_16x16x32_bf16 v[128:131], v[16:19], a[32:35], v[128:131]
    buffer_load_dwordx4 v4, s[12:15], s33 offen offset:0 lds
    v_mfma_f32_16x16x32_bf16 v[128:131], v[32:35], a[48:51], v[128:131]
    ds_read_b64_tr_b16 v[28:29], v126 offset:32768
    v_mfma_f32_16x16x32_bf16 v[132:135], v[16:19], a[36:39], v[132:135]
    ds_read_b64_tr_b16 v[30:31], v126 offset:40960
    v_mfma_f32_16x16x32_bf16 v[132:135], v[32:35], a[52:55], v[132:135]
    ds_read_b64_tr_b16 v[40:41], v125 offset:49152
    v_mfma_f32_16x16x32_bf16 v[136:139], v[16:19], a[40:43], v[136:139]
    buffer_load_dwordx4 v5, s[12:15], s33 offen offset:1024 lds
    v_mfma_f32_16x16x32_bf16 v[136:139], v[32:35], a[56:59], v[136:139]
    s_add_u32 s36, s36, 8192
    ds_read_b64_tr_b16 v[42:43], v125 offset:57344
    v_mfma_f32_16x16x32_bf16 v[140:143], v[16:19], a[44:47], v[140:143]
    s_and_b32 s36, s36, 0xe000
    ds_read_b64_tr_b16 v[44:45], v126 offset:49152
    v_mfma_f32_16x16x32_bf16 v[140:143], v[32:35], a[60:63], v[140:143]
    s_waitcnt lgkmcnt(3)
    ds_read_b64_tr_b16 v[46:47], v126 offset:57344
    v_mfma_f32_16x16x32_bf16 v[144:147], v[20:23], a[32:35], v[144:147]
    s_waitcnt vmcnt(11)
    s_barrier
    buffer_load_dwordx4 v1, s[28:31], s32 offen offset:2048 sc1 lds
    v_mfma_f32_16x16x32_bf16 v[144:147], v[36:39], a[48:51], v[144:147]
    s_add_u32 s37, s36, s34
    ds_read_b64_tr_b16 v[16:17], v102 offset:16384
    v_mfma_f32_16x16x32_bf16 v[148:151], v[20:23], a[36:39], v[148:151]
    s_lshl3_add_u32 s33, s37, s35
    ds_read_b64_tr_b16 v[18:19], v102 offset:24576
    v_mfma_f32_16x16x32_bf16 v[148:151], v[36:39], a[52:55], v[148:151]
    ds_read_b64_tr_b16 v[32:33], v102 offset:32768
    v_mfma_f32_16x16x32_bf16 v[152:155], v[20:23], a[40:43], v[152:155]
    buffer_load_dwordx4 v1, s[28:31], s32 offen offset:3072 sc1 lds
    v_mfma_f32_16x16x32_bf16 v[152:155], v[36:39], a[56:59], v[152:155]
    ds_read_b64_tr_b16 v[34:35], v102 offset:40960
    v_mfma_f32_16x16x32_bf16 v[156:159], v[20:23], a[44:47], v[156:159]
    s_mov_b32 m0, s57
    ds_read_b128 a[0:3], v100 offset:16384
    v_mfma_f32_16x16x32_bf16 v[156:159], v[36:39], a[60:63], v[156:159]
    s_waitcnt lgkmcnt(7)
    ds_read_b128 a[16:19], v100 offset:32768
    v_mfma_f32_16x16x32_bf16 v[160:163], v[24:27], a[32:35], v[160:163]
    buffer_load_dwordx4 v4, s[12:15], s33 offen offset:0 lds
    v_mfma_f32_16x16x32_bf16 v[160:163], v[40:43], a[48:51], v[160:163]
    ds_read_b128 a[4:7], v100 offset:17408
    v_mfma_f32_16x16x32_bf16 v[164:167], v[24:27], a[36:39], v[164:167]
    ds_read_b128 a[20:23], v100 offset:33792
    v_mfma_f32_16x16x32_bf16 v[164:167], v[40:43], a[52:55], v[164:167]
    ds_read_b128 a[8:11], v100 offset:20480
    v_mfma_f32_16x16x32_bf16 v[168:171], v[24:27], a[40:43], v[168:171]
    buffer_load_dwordx4 v5, s[12:15], s33 offen offset:1024 lds
    v_mfma_f32_16x16x32_bf16 v[168:171], v[40:43], a[56:59], v[168:171]
    s_add_u32 s36, s36, 8192
    ds_read_b128 a[24:27], v100 offset:36864
    v_mfma_f32_16x16x32_bf16 v[172:175], v[24:27], a[44:47], v[172:175]
    s_and_b32 s36, s36, 0xe000
    ds_read_b128 a[12:15], v100 offset:21504
    v_mfma_f32_16x16x32_bf16 v[172:175], v[40:43], a[60:63], v[172:175]
    s_waitcnt lgkmcnt(11)
    ds_read_b128 a[28:31], v100 offset:37888
    v_mfma_f32_16x16x32_bf16 v[176:179], v[28:31], a[32:35], v[176:179]
    buffer_load_dwordx4 v1, s[28:31], s37 offen offset:2048 sc1 lds
    v_mfma_f32_16x16x32_bf16 v[176:179], v[44:47], a[48:51], v[176:179]
    s_add_u32 s32, s36, s34
    ds_read_b64_tr_b16 v[20:21], v103 offset:16384
    v_mfma_f32_16x16x32_bf16 v[180:183], v[28:31], a[36:39], v[180:183]
    s_lshl3_add_u32 s33, s32, s35
    ds_read_b64_tr_b16 v[22:23], v103 offset:24576
    v_mfma_f32_16x16x32_bf16 v[180:183], v[44:47], a[52:55], v[180:183]
    ds_read_b64_tr_b16 v[36:37], v103 offset:32768
    v_mfma_f32_16x16x32_bf16 v[184:187], v[28:31], a[40:43], v[184:187]
    buffer_load_dwordx4 v1, s[28:31], s37 offen offset:3072 sc1 lds
    v_mfma_f32_16x16x32_bf16 v[184:187], v[44:47], a[56:59], v[184:187]
    ds_read_b64_tr_b16 v[38:39], v103 offset:40960
    v_mfma_f32_16x16x32_bf16 v[188:191], v[28:31], a[44:47], v[188:191]
    s_mov_b32 m0, s58
    ds_read_b64_tr_b16 v[24:25], v112 offset:16384
    v_mfma_f32_16x16x32_bf16 v[188:191], v[44:47], a[60:63], v[188:191]
    ds_read_b64_tr_b16 v[26:27], v112 offset:24576
    s_waitcnt lgkmcnt(6)
    v_mfma_f32_16x16x32_bf16 v[128:131], v[16:19], a[0:3], v[128:131]
    buffer_load_dwordx4 v4, s[12:15], s33 offen offset:0 lds
    v_mfma_f32_16x16x32_bf16 v[128:131], v[32:35], a[16:19], v[128:131]
    ds_read_b64_tr_b16 v[28:29], v113 offset:16384
    v_mfma_f32_16x16x32_bf16 v[132:135], v[16:19], a[4:7], v[132:135]
    ds_read_b64_tr_b16 v[30:31], v113 offset:24576
    v_mfma_f32_16x16x32_bf16 v[132:135], v[32:35], a[20:23], v[132:135]
    ds_read_b64_tr_b16 v[40:41], v112 offset:32768
    v_mfma_f32_16x16x32_bf16 v[136:139], v[16:19], a[8:11], v[136:139]
    buffer_load_dwordx4 v5, s[12:15], s33 offen offset:1024 lds
    v_mfma_f32_16x16x32_bf16 v[136:139], v[32:35], a[24:27], v[136:139]
    s_add_u32 s36, s36, 8192
    ds_read_b64_tr_b16 v[42:43], v112 offset:40960
    v_mfma_f32_16x16x32_bf16 v[140:143], v[16:19], a[12:15], v[140:143]
    s_and_b32 s36, s36, 0xe000
    ds_read_b64_tr_b16 v[44:45], v113 offset:32768
    v_mfma_f32_16x16x32_bf16 v[140:143], v[32:35], a[28:31], v[140:143]
    s_waitcnt lgkmcnt(3)
    ds_read_b64_tr_b16 v[46:47], v113 offset:40960
    v_mfma_f32_16x16x32_bf16 v[144:147], v[20:23], a[0:3], v[144:147]
    s_waitcnt vmcnt(10)
    s_barrier
    buffer_load_dwordx4 v1, s[28:31], s32 offen offset:2048 sc1 lds
    v_mfma_f32_16x16x32_bf16 v[144:147], v[36:39], a[16:19], v[144:147]
    s_add_u32 s37, s36, s34
    ds_read_b64_tr_b16 v[16:17], v102 offset:0
    v_mfma_f32_16x16x32_bf16 v[148:151], v[20:23], a[4:7], v[148:151]
    s_lshl3_add_u32 s33, s37, s35
    ds_read_b64_tr_b16 v[18:19], v102 offset:8192
    v_mfma_f32_16x16x32_bf16 v[148:151], v[36:39], a[20:23], v[148:151]
    ds_read_b64_tr_b16 v[32:33], v102 offset:49152
    v_mfma_f32_16x16x32_bf16 v[152:155], v[20:23], a[8:11], v[152:155]
    buffer_load_dwordx4 v1, s[28:31], s32 offen offset:3072 sc1 lds
    v_mfma_f32_16x16x32_bf16 v[152:155], v[36:39], a[24:27], v[152:155]
    ds_read_b64_tr_b16 v[34:35], v102 offset:57344
    v_mfma_f32_16x16x32_bf16 v[156:159], v[20:23], a[12:15], v[156:159]
    s_mov_b32 m0, s59
    ds_read_b128 a[32:35], v100 offset:0
    v_mfma_f32_16x16x32_bf16 v[156:159], v[36:39], a[28:31], v[156:159]
    s_waitcnt lgkmcnt(7)
    ds_read_b128 a[48:51], v100 offset:49152
    v_mfma_f32_16x16x32_bf16 v[160:163], v[24:27], a[0:3], v[160:163]
    buffer_load_dwordx4 v4, s[12:15], s33 offen offset:0 lds
    v_mfma_f32_16x16x32_bf16 v[160:163], v[40:43], a[16:19], v[160:163]
    s_add_u32 s68, s68, 1
    ds_read_b128 a[36:39], v100 offset:1024
    v_mfma_f32_16x16x32_bf16 v[164:167], v[24:27], a[4:7], v[164:167]
    ds_read_b128 a[52:55], v100 offset:50176
    v_readlane_b32 s34, v3, s68
    v_mfma_f32_16x16x32_bf16 v[164:167], v[40:43], a[20:23], v[164:167]
    s_lshl_b64 s[66:67], s[66:67], 2
    ds_read_b128 a[40:43], v100 offset:4096
    v_mfma_f32_16x16x32_bf16 v[168:171], v[24:27], a[8:11], v[168:171]
    buffer_load_dwordx4 v5, s[12:15], s33 offen offset:1024 lds
    v_mfma_f32_16x16x32_bf16 v[168:171], v[40:43], a[24:27], v[168:171]
    s_add_u32 s36, s36, 8192
    s_waitcnt vmcnt(18)
    ds_read_b128 a[56:59], v100 offset:53248
    v_mfma_f32_16x16x32_bf16 v[172:175], v[24:27], a[12:15], v[172:175]
    s_and_b32 s36, s36, 0xe000
    ds_read_b128 a[44:47], v100 offset:5120
    v_cmp_eq_u32 vcc, v12, v8
    v_mfma_f32_16x16x32_bf16 v[172:175], v[40:43], a[28:31], v[172:175]
    s_waitcnt lgkmcnt(11)
    ds_read_b128 a[60:63], v100 offset:54272
    v_mfma_f32_16x16x32_bf16 v[176:179], v[28:31], a[0:3], v[176:179]
    buffer_load_dwordx4 v1, s[28:31], s37 offen offset:2048 sc1 lds
    v_mfma_f32_16x16x32_bf16 v[176:179], v[44:47], a[16:19], v[176:179]
    s_add_u32 s32, s36, s34
    ds_read_b64_tr_b16 v[20:21], v103 offset:0
    v_mfma_f32_16x16x32_bf16 v[180:183], v[28:31], a[4:7], v[180:183]
    s_lshl3_add_u32 s33, s32, s35
    ds_read_b64_tr_b16 v[22:23], v103 offset:8192
    v_mfma_f32_16x16x32_bf16 v[180:183], v[44:47], a[20:23], v[180:183]
    ds_read_b64_tr_b16 v[36:37], v103 offset:49152
    v_mfma_f32_16x16x32_bf16 v[184:187], v[28:31], a[8:11], v[184:187]
    buffer_load_dwordx4 v1, s[28:31], s37 offen offset:3072 sc1 lds
    v_mfma_f32_16x16x32_bf16 v[184:187], v[44:47], a[24:27], v[184:187]
    s_andn2_b64 s[4:5], s[66:67], vcc
    ds_read_b64_tr_b16 v[38:39], v103 offset:57344
    v_mfma_f32_16x16x32_bf16 v[188:191], v[28:31], a[12:15], v[188:191]
    s_mov_b32 m0, s53
    ds_read_b64_tr_b16 v[24:25], v112 offset:0
    v_mfma_f32_16x16x32_bf16 v[188:191], v[44:47], a[28:31], v[188:191]
    ds_read_b64_tr_b16 v[26:27], v112 offset:8192
    s_waitcnt lgkmcnt(6)
    s_cbranch_scc0 L_c_loop
    s_lshl1_add_u32 s4, s41, 14
    s_cmp_lg_u32 s68, s4
    s_cbranch_scc1 L_spin_l
L_tail:
    v_mfma_f32_16x16x32_bf16 v[128:131], v[16:19], a[32:35], v[128:131]
    s_add_u32 s5, s47, 4096
    buffer_load_dwordx4 v[224:227], v14, s[28:31], s47 offen offset:0 sc1
    buffer_load_dwordx4 v[232:235], v14, s[28:31], s47 offen offset:2048 sc1
    v_mfma_f32_16x16x32_bf16 v[128:131], v[32:35], a[48:51], v[128:131]
    ds_read_b64_tr_b16 v[28:29], v113 offset:0
    v_mfma_f32_16x16x32_bf16 v[132:135], v[16:19], a[36:39], v[132:135]
    ds_read_b64_tr_b16 v[30:31], v113 offset:8192
    v_mfma_f32_16x16x32_bf16 v[132:135], v[32:35], a[52:55], v[132:135]
    ds_read_b64_tr_b16 v[40:41], v112 offset:49152
    v_mfma_f32_16x16x32_bf16 v[136:139], v[16:19], a[40:43], v[136:139]
    buffer_load_dwordx4 v[240:243], v14, s[28:31], s5 offen offset:0 sc1
    buffer_load_dwordx4 v[248:251], v14, s[28:31], s5 offen offset:2048 sc1
    v_mfma_f32_16x16x32_bf16 v[136:139], v[32:35], a[56:59], v[136:139]
    ds_read_b64_tr_b16 v[42:43], v112 offset:57344
    v_mfma_f32_16x16x32_bf16 v[140:143], v[16:19], a[44:47], v[140:143]
    ds_read_b64_tr_b16 v[44:45], v113 offset:49152
    v_mfma_f32_16x16x32_bf16 v[140:143], v[32:35], a[60:63], v[140:143]
    s_waitcnt lgkmcnt(3)
    ds_read_b64_tr_b16 v[46:47], v113 offset:57344
    v_mfma_f32_16x16x32_bf16 v[144:147], v[20:23], a[32:35], v[144:147]
    s_waitcnt vmcnt(12)
    s_barrier
    buffer_load_dwordx4 v[228:231], v14, s[28:31], s47 offen offset:1024 sc1
    buffer_load_dwordx4 v[236:239], v14, s[28:31], s47 offen offset:3072 sc1
    v_mfma_f32_16x16x32_bf16 v[144:147], v[36:39], a[48:51], v[144:147]
    ds_read_b64_tr_b16 v[16:17], v114 offset:0
    v_mfma_f32_16x16x32_bf16 v[148:151], v[20:23], a[36:39], v[148:151]
    ds_read_b64_tr_b16 v[18:19], v114 offset:8192
    v_mfma_f32_16x16x32_bf16 v[148:151], v[36:39], a[52:55], v[148:151]
    ds_read_b64_tr_b16 v[32:33], v114 offset:16384
    v_mfma_f32_16x16x32_bf16 v[152:155], v[20:23], a[40:43], v[152:155]
    buffer_load_dwordx4 v[244:247], v14, s[28:31], s5 offen offset:1024 sc1
    buffer_load_dwordx4 v[252:255], v14, s[28:31], s5 offen offset:3072 sc1
    v_mfma_f32_16x16x32_bf16 v[152:155], v[36:39], a[56:59], v[152:155]
    ds_read_b64_tr_b16 v[34:35], v114 offset:24576
    v_mfma_f32_16x16x32_bf16 v[156:159], v[20:23], a[44:47], v[156:159]
    ds_read_b128 a[0:3], v101 offset:0
    v_mfma_f32_16x16x32_bf16 v[156:159], v[36:39], a[60:63], v[156:159]
    s_waitcnt lgkmcnt(7)
    ds_read_b128 a[16:19], v101 offset:16384
    v_mfma_f32_16x16x32_bf16 v[160:163], v[24:27], a[32:35], v[160:163]
    v_mfma_f32_16x16x32_bf16 v[160:163], v[40:43], a[48:51], v[160:163]
    ds_read_b128 a[4:7], v101 offset:1024
    v_mfma_f32_16x16x32_bf16 v[164:167], v[24:27], a[36:39], v[164:167]
    ds_read_b128 a[20:23], v101 offset:17408
    v_mfma_f32_16x16x32_bf16 v[164:167], v[40:43], a[52:55], v[164:167]
    ds_read_b128 a[8:11], v101 offset:4096
    v_mfma_f32_16x16x32_bf16 v[168:171], v[24:27], a[40:43], v[168:171]
    v_mfma_f32_16x16x32_bf16 v[168:171], v[40:43], a[56:59], v[168:171]
    ds_read_b128 a[24:27], v101 offset:20480
    v_mfma_f32_16x16x32_bf16 v[172:175], v[24:27], a[44:47], v[172:175]
    ds_read_b128 a[12:15], v101 offset:5120
    v_mfma_f32_16x16x32_bf16 v[172:175], v[40:43], a[60:63], v[172:175]
    s_waitcnt lgkmcnt(11)
    ds_read_b128 a[28:31], v101 offset:21504
    v_mfma_f32_16x16x32_bf16 v[176:179], v[28:31], a[32:35], v[176:179]
    v_mfma_f32_16x16x32_bf16 v[176:179], v[44:47], a[48:51], v[176:179]
    ds_read_b64_tr_b16 v[20:21], v124 offset:0
    v_mfma_f32_16x16x32_bf16 v[180:183], v[28:31], a[36:39], v[180:183]
    ds_read_b64_tr_b16 v[22:23], v124 offset:8192
    v_mfma_f32_16x16x32_bf16 v[180:183], v[44:47], a[52:55], v[180:183]
    ds_read_b64_tr_b16 v[36:37], v124 offset:16384
    v_mfma_f32_16x16x32_bf16 v[184:187], v[28:31], a[40:43], v[184:187]
    v_mfma_f32_16x16x32_bf16 v[184:187], v[44:47], a[56:59], v[184:187]
    ds_read_b64_tr_b16 v[38:39], v124 offset:24576
    v_mfma_f32_16x16x32_bf16 v[188:191], v[28:31], a[44:47], v[188:191]
    ds_read_b64_tr_b16 v[24:25], v125 offset:0
    v_mfma_f32_16x16x32_bf16 v[188:191], v[44:47], a[60:63], v[188:191]
    ds_read_b64_tr_b16 v[26:27], v125 offset:8192
    s_waitcnt lgkmcnt(6)
    s_cmp_eq_u32 s41, 0
    s_cbranch_scc1 L_c_g
    v_mfma_f32_16x16x32_bf16 v[128:131], v[16:19], a[0:3], v[128:131]
    ds_read_b64_tr_b16 v[40:41], v125 offset:16384
    v_mfma_f32_16x16x32_bf16 v[128:131], v[32:35], a[16:19], v[128:131]
    ds_read_b64_tr_b16 v[42:43], v125 offset:24576
    v_mfma_f32_16x16x32_bf16 v[132:135], v[16:19], a[4:7], v[132:135]
    v_mfma_f32_16x16x32_bf16 v[132:135], v[32:35], a[20:23], v[132:135]
    v_mfma_f32_16x16x32_bf16 v[136:139], v[16:19], a[8:11], v[136:139]
    s_waitcnt vmcnt(8)
    s_barrier
    v_mfma_f32_16x16x32_bf16 v[136:139], v[32:35], a[24:27], v[136:139]
    ds_read_b128 a[32:35], v101 offset:32768
    v_mfma_f32_16x16x32_bf16 v[140:143], v[16:19], a[12:15], v[140:143]
    ds_read_b128 a[48:51], v101 offset:49152
    v_mfma_f32_16x16x32_bf16 v[140:143], v[32:35], a[28:31], v[140:143]
    s_waitcnt lgkmcnt(6)
    ds_read_b128 a[36:39], v101 offset:33792
    v_mfma_f32_16x16x32_bf16 v[144:147], v[20:23], a[0:3], v[144:147]
    ds_read_b64_tr_b16 v[16:17], v114 offset:32768
    v_mfma_f32_16x16x32_bf16 v[144:147], v[36:39], a[16:19], v[144:147]
    ds_read_b64_tr_b16 v[18:19], v114 offset:40960
    v_mfma_f32_16x16x32_bf16 v[148:151], v[20:23], a[4:7], v[148:151]
    ds_read_b64_tr_b16 v[32:33], v114 offset:49152
    v_mfma_f32_16x16x32_bf16 v[148:151], v[36:39], a[20:23], v[148:151]
    ds_read_b64_tr_b16 v[34:35], v114 offset:57344
    v_mfma_f32_16x16x32_bf16 v[152:155], v[20:23], a[8:11], v[152:155]
    ds_read_b128 a[52:55], v101 offset:50176
    v_mfma_f32_16x16x32_bf16 v[152:155], v[36:39], a[24:27], v[152:155]
    ds_read_b128 a[40:43], v101 offset:36864
    v_mfma_f32_16x16x32_bf16 v[156:159], v[20:23], a[12:15], v[156:159]
    ds_read_b128 a[56:59], v101 offset:53248
    v_mfma_f32_16x16x32_bf16 v[156:159], v[36:39], a[28:31], v[156:159]
    s_waitcnt lgkmcnt(3)
    ds_read_b128 a[44:47], v101 offset:37888
    v_mfma_f32_16x16x32_bf16 v[128:131], v[16:19], a[32:35], v[128:131]
    ds_read_b128 a[60:63], v101 offset:54272
    v_mfma_f32_16x16x32_bf16 v[128:131], v[32:35], a[48:51], v[128:131]
    s_waitcnt lgkmcnt(4)
    ds_read_b64_tr_b16 v[20:21], v124 offset:32768
    v_mfma_f32_16x16x32_bf16 v[132:135], v[16:19], a[36:39], v[132:135]
    ds_read_b64_tr_b16 v[22:23], v124 offset:40960
    v_mfma_f32_16x16x32_bf16 v[132:135], v[32:35], a[52:55], v[132:135]
    s_waitcnt lgkmcnt(4)
    ds_read_b64_tr_b16 v[36:37], v124 offset:49152
    v_mfma_f32_16x16x32_bf16 v[136:139], v[16:19], a[40:43], v[136:139]
    ds_read_b64_tr_b16 v[38:39], v124 offset:57344
    v_mfma_f32_16x16x32_bf16 v[136:139], v[32:35], a[56:59], v[136:139]
    s_waitcnt lgkmcnt(4)
    ds_read_b64_tr_b16 v[28:29], v125 offset:32768
    v_mfma_f32_16x16x32_bf16 v[140:143], v[16:19], a[44:47], v[140:143]
    ds_read_b64_tr_b16 v[30:31], v125 offset:40960
    v_mfma_f32_16x16x32_bf16 v[140:143], v[32:35], a[60:63], v[140:143]
    s_waitcnt lgkmcnt(2)
    ds_read_b64_tr_b16 v[44:45], v125 offset:49152
    v_mfma_f32_16x16x32_bf16 v[144:147], v[20:23], a[32:35], v[144:147]
    s_waitcnt vmcnt(4)
    ds_read_b64_tr_b16 v[46:47], v125 offset:57344
    v_max3_u32 v2, v224, v225, v226
    v_mfma_f32_16x16x32_bf16 v[144:147], v[36:39], a[48:51], v[144:147]
    ds_read_b64_tr_b16 v[16:17], v126 offset:0
    v_max3_u32 v7, v227, v232, v233
    v_mfma_f32_16x16x32_bf16 v[148:151], v[20:23], a[36:39], v[148:151]
    ds_read_b64_tr_b16 v[18:19], v126 offset:8192
    v_max3_u32 v2, v234, v235, v2
    v_mfma_f32_16x16x32_bf16 v[148:151], v[36:39], a[52:55], v[148:151]
    ds_read_b64_tr_b16 v[32:33], v126 offset:16384
    v_max3_u32 v7, v240, v241, v7
    v_mfma_f32_16x16x32_bf16 v[152:155], v[20:23], a[40:43], v[152:155]
    ds_read_b64_tr_b16 v[34:35], v126 offset:24576
    v_max3_u32 v2, v242, v243, v2
    v_mfma_f32_16x16x32_bf16 v[152:155], v[36:39], a[56:59], v[152:155]
    v_max3_u32 v7, v248, v249, v7
    v_max3_u32 v2, v250, v251, v2
    v_mfma_f32_16x16x32_bf16 v[156:159], v[20:23], a[44:47], v[156:159]
    v_max_u32 v2, v2, v7
    v_cmp_eq_u32 vcc, -1, v2
    v_mfma_f32_16x16x32_bf16 v[156:159], v[36:39], a[60:63], v[156:159]
    s_waitcnt lgkmcnt(4)
    s_cbranch_vccnz L_q_late
    v_lshlrev_b32 v192, 16, v224
    v_mfma_f32_16x16x32_bf16 v[160:163], v[24:27], a[0:3], v[160:163]
    ds_read_b64_tr_b16 v[20:21], v126 offset:32768
    v_and_b32 v193, 0xffff0000, v224
    v_mfma_f32_16x16x32_bf16 v[160:163], v[40:43], a[16:19], v[160:163]
    ds_read_b64_tr_b16 v[22:23], v126 offset:40960
    v_lshlrev_b32 v194, 16, v225
    v_mfma_f32_16x16x32_bf16 v[160:163], v[28:31], a[32:35], v[160:163]
    ds_read_b64_tr_b16 v[36:37], v126 offset:49152
    v_and_b32 v195, 0xffff0000, v225
    v_mfma_f32_16x16x32_bf16 v[160:163], v[44:47], a[48:51], v[160:163]
    ds_read_b64_tr_b16 v[38:39], v126 offset:57344
    v_lshlrev_b32 v196, 16, v226
    v_mfma_f32_16x16x32_bf16 v[164:167], v[24:27], a[4:7], v[164:167]
    v_and_b32 v197, 0xffff0000, v226
    v_lshlrev_b32 v198, 16, v227
    v_mfma_f32_16x16x32_bf16 v[164:167], v[40:43], a[20:23], v[164:167]
    v_and_b32 v199, 0xffff0000, v227
    v_fma_f32 v128, v128, v192, v80
    v_mfma_f32_16x16x32_bf16 v[164:167], v[28:31], a[36:39], v[164:167]
    v_fma_f32 v129, v129, v193, v81
    v_fma_f32 v130, v130, v194, v82
    v_mfma_f32_16x16x32_bf16 v[164:167], v[44:47], a[52:55], v[164:167]
    v_fma_f32 v131, v131, v195, v83
    v_fma_f32 v144, v144, v196, v84
    v_mfma_f32_16x16x32_bf16 v[168:171], v[24:27], a[8:11], v[168:171]
    v_fma_f32 v145, v145, v197, v85
    v_fma_f32 v146, v146, v198, v86
    v_mfma_f32_16x16x32_bf16 v[168:171], v[40:43], a[24:27], v[168:171]
    v_fma_f32 v147, v147, v199, v87
    v_cvt_pk_bf16_f32 v80, v128, v129
    v_mfma_f32_16x16x32_bf16 v[168:171], v[28:31], a[40:43], v[168:171]
    v_cvt_pk_bf16_f32 v81, v130, v131
    v_cvt_pk_bf16_f32 v82, v144, v145
    v_mfma_f32_16x16x32_bf16 v[168:171], v[44:47], a[56:59], v[168:171]
    v_cvt_pk_bf16_f32 v83, v146, v147
    v_mfma_f32_16x16x32_bf16 v[172:175], v[24:27], a[12:15], v[172:175]
    s_nop 0
    v_permlane16_swap_b32 v80, v82
    v_permlane16_swap_b32 v81, v83
    v_mfma_f32_16x16x32_bf16 v[172:175], v[40:43], a[28:31], v[172:175]
    ds_bpermute_b32 v80, v13, v80
    v_lshlrev_b32 v200, 16, v232
    v_mfma_f32_16x16x32_bf16 v[172:175], v[28:31], a[44:47], v[172:175]
    ds_bpermute_b32 v81, v13, v81
    v_and_b32 v201, 0xffff0000, v232
    v_mfma_f32_16x16x32_bf16 v[172:175], v[44:47], a[60:63], v[172:175]
    s_waitcnt lgkmcnt(2)
    ds_bpermute_b32 v82, v13, v82
    v_lshlrev_b32 v202, 16, v233
    v_mfma_f32_16x16x32_bf16 v[176:179], v[16:19], a[0:3], v[176:179]
    ds_bpermute_b32 v83, v13, v83
    v_and_b32 v203, 0xffff0000, v233
    v_mfma_f32_16x16x32_bf16 v[176:179], v[32:35], a[16:19], v[176:179]
    v_lshlrev_b32 v204, 16, v234
    v_and_b32 v205, 0xffff0000, v234
    v_mfma_f32_16x16x32_bf16 v[176:179], v[20:23], a[32:35], v[176:179]
    v_lshlrev_b32 v206, 16, v235
    v_and_b32 v207, 0xffff0000, v235
    v_mfma_f32_16x16x32_bf16 v[176:179], v[36:39], a[48:51], v[176:179]
    v_fma_f32 v132, v132, v200, v104
    v_fma_f32 v133, v133, v201, v105
    v_mfma_f32_16x16x32_bf16 v[180:183], v[16:19], a[4:7], v[180:183]
    v_fma_f32 v134, v134, v202, v106
    v_fma_f32 v135, v135, v203, v107
    v_mfma_f32_16x16x32_bf16 v[180:183], v[32:35], a[20:23], v[180:183]
    v_fma_f32 v148, v148, v204, v108
    v_fma_f32 v149, v149, v205, v109
    v_mfma_f32_16x16x32_bf16 v[180:183], v[20:23], a[36:39], v[180:183]
    v_fma_f32 v150, v150, v206, v110
    v_fma_f32 v151, v151, v207, v111
    v_mfma_f32_16x16x32_bf16 v[180:183], v[36:39], a[52:55], v[180:183]
    v_cvt_pk_bf16_f32 v104, v132, v133
    v_cvt_pk_bf16_f32 v105, v134, v135
    v_mfma_f32_16x16x32_bf16 v[184:187], v[16:19], a[8:11], v[184:187]
    v_cvt_pk_bf16_f32 v106, v148, v149
    v_cvt_pk_bf16_f32 v107, v150, v151
    v_mfma_f32_16x16x32_bf16 v[184:187], v[32:35], a[24:27], v[184:187]
    s_add_u32 s4, s101, 0
    s_waitcnt lgkmcnt(0)
    buffer_store_dwordx4 v[80:83], v15, s[76:79], s4 offen offset:0 sc1
    v_mfma_f32_16x16x32_bf16 v[184:187], v[20:23], a[40:43], v[184:187]
    v_permlane16_swap_b32 v104, v106
    v_permlane16_swap_b32 v105, v107
    v_mfma_f32_16x16x32_bf16 v[184:187], v[36:39], a[56:59], v[184:187]
    ds_bpermute_b32 v104, v13, v104
    v_lshlrev_b32 v208, 16, v240
    v_mfma_f32_16x16x32_bf16 v[188:191], v[16:19], a[12:15], v[188:191]
    ds_bpermute_b32 v105, v13, v105
    v_and_b32 v209, 0xffff0000, v240
    v_mfma_f32_16x16x32_bf16 v[188:191], v[32:35], a[28:31], v[188:191]
    ds_bpermute_b32 v106, v13, v106
    v_lshlrev_b32 v210, 16, v241
    v_mfma_f32_16x16x32_bf16 v[188:191], v[20:23], a[44:47], v[188:191]
    ds_bpermute_b32 v107, v13, v107
    v_and_b32 v211, 0xffff0000, v241
    v_mfma_f32_16x16x32_bf16 v[188:191], v[36:39], a[60:63], v[188:191]
    v_lshlrev_b32 v212, 16, v242
    v_and_b32 v213, 0xffff0000, v242
    v_lshlrev_b32 v214, 16, v243
    v_and_b32 v215, 0xffff0000, v243
    s_nop 1
    v_pk_fma_f32 v[136:137], v[136:137], v[208:209], v[48:49]
    v_pk_fma_f32 v[138:139], v[138:139], v[210:211], v[50:51]
    v_pk_fma_f32 v[152:153], v[152:153], v[212:213], v[52:53]
    v_pk_fma_f32 v[154:155], v[154:155], v[214:215], v[54:55]
    v_cvt_pk_bf16_f32 v48, v136, v137
    v_cvt_pk_bf16_f32 v49, v138, v139
    v_cvt_pk_bf16_f32 v50, v152, v153
    v_cvt_pk_bf16_f32 v51, v154, v155
    s_add_u32 s4, s101, 32768
    s_waitcnt lgkmcnt(0)
    buffer_store_dwordx4 v[104:107], v15, s[76:79], s4 offen offset:0 sc1
    v_permlane16_swap_b32 v48, v50
    v_permlane16_swap_b32 v49, v51
    ds_bpermute_b32 v48, v13, v48
    v_lshlrev_b32 v216, 16, v248
    ds_bpermute_b32 v49, v13, v49
    v_and_b32 v217, 0xffff0000, v248
    ds_bpermute_b32 v50, v13, v50
    v_lshlrev_b32 v218, 16, v249
    ds_bpermute_b32 v51, v13, v51
    v_and_b32 v219, 0xffff0000, v249
    v_lshlrev_b32 v220, 16, v250
    v_and_b32 v221, 0xffff0000, v250
    v_lshlrev_b32 v222, 16, v251
    v_and_b32 v223, 0xffff0000, v251
L_q_r:
    s_waitcnt vmcnt(2)
    v_max3_u32 v2, v228, v229, v230
    v_max3_u32 v7, v231, v236, v237
    v_max3_u32 v2, v238, v239, v2
    v_max3_u32 v7, v244, v245, v7
    v_max3_u32 v2, v246, v247, v2
    v_max3_u32 v7, v252, v253, v7
    v_max3_u32 v2, v254, v255, v2
    v_max_u32 v2, v2, v7
    v_cmp_eq_u32 vcc, -1, v2
    s_cbranch_vccnz L_q_late_r
L_q_back_r:
    v_pk_fma_f32 v[140:141], v[140:141], v[216:217], v[64:65]
    v_pk_fma_f32 v[142:143], v[142:143], v[218:219], v[66:67]
    v_pk_fma_f32 v[156:157], v[156:157], v[220:221], v[68:69]
    v_pk_fma_f32 v[158:159], v[158:159], v[222:223], v[70:71]
    v_cvt_pk_bf16_f32 v64, v140, v141
    v_cvt_pk_bf16_f32 v65, v142, v143
    v_cvt_pk_bf16_f32 v66, v156, v157
    v_cvt_pk_bf16_f32 v67, v158, v159
    s_add_u32 s4, s101, 65536
    s_waitcnt lgkmcnt(0)
    buffer_store_dwordx4 v[48:51], v15, s[76:79], s4 offen offset:0 sc1
    v_permlane16_swap_b32 v64, v66
    v_permlane16_swap_b32 v65, v67
    ds_bpermute_b32 v64, v13, v64
    v_lshlrev_b32 v192, 16, v228
    ds_bpermute_b32 v65, v13, v65
    v_and_b32 v193, 0xffff0000, v228
    ds_bpermute_b32 v66, v13, v66
    v_lshlrev_b32 v194, 16, v229
    ds_bpermute_b32 v67, v13, v67
    v_and_b32 v195, 0xffff0000, v229
    v_lshlrev_b32 v196, 16, v230
    v_and_b32 v197, 0xffff0000, v230
    v_lshlrev_b32 v198, 16, v231
    v_and_b32 v199, 0xffff0000, v231
    v_pk_fma_f32 v[160:161], v[160:161], v[192:193], v[88:89]
    v_pk_fma_f32 v[162:163], v[162:163], v[194:195], v[90:91]
    v_pk_fma_f32 v[176:177], v[176:177], v[196:197], v[92:93]
    v_pk_fma_f32 v[178:179], v[178:179], v[198:199], v[94:95]
    v_cvt_pk_bf16_f32 v88, v160, v161
    v_cvt_pk_bf16_f32 v89, v162, v163
    v_cvt_pk_bf16_f32 v90, v176, v177
    v_cvt_pk_bf16_f32 v91, v178, v179
    s_add_u32 s4, s101, 98304
    s_waitcnt lgkmcnt(0)
    buffer_store_dwordx4 v[64:67], v15, s[76:79], s4 offen offset:0 sc1
    v_permlane16_swap_b32 v88, v90
    v_permlane16_swap_b32 v89, v91
    ds_bpermute_b32 v88, v13, v88
    v_lshlrev_b32 v200, 16, v236
    ds_bpermute_b32 v89, v13, v89
    v_and_b32 v201, 0xffff0000, v236
    ds_bpermute_b32 v90, v13, v90
    v_lshlrev_b32 v202, 16, v237
    ds_bpermute_b32 v91, v13, v91
    v_and_b32 v203, 0xffff0000, v237
    v_lshlrev_b32 v204, 16, v238
    v_and_b32 v205, 0xffff0000, v238
    v_lshlrev_b32 v206, 16, v239
    v_and_b32 v207, 0xffff0000, v239
    v_pk_fma_f32 v[164:165], v[164:165], v[200:201], v[116:117]
    v_pk_fma_f32 v[166:167], v[166:167], v[202:203], v[118:119]
    v_pk_fma_f32 v[180:181], v[180:181], v[204:205], v[120:121]
    v_pk_fma_f32 v[182:183], v[182:183], v[206:207], v[122:123]
    v_cvt_pk_bf16_f32 v116, v164, v165
    v_cvt_pk_bf16_f32 v117, v166, v167
    v_cvt_pk_bf16_f32 v118, v180, v181
    v_cvt_pk_bf16_f32 v119, v182, v183
    s_add_u32 s4, s101, 0
    s_waitcnt lgkmcnt(0)
    buffer_store_dwordx4 v[88:91], v15, s[76:79], s4 offen offset:64 sc1
    v_permlane16_swap_b32 v116, v118
    v_permlane16_swap_b32 v117, v119
    ds_bpermute_b32 v116, v13, v116
    v_lshlrev_b32 v208, 16, v244
    ds_bpermute_b32 v117, v13, v117
    v_and_b32 v209, 0xffff0000, v244
    ds_bpermute_b32 v118, v13, v118
    v_lshlrev_b32 v210, 16, v245
    ds_bpermute_b32 v119, v13, v119
    v_and_b32 v211, 0xffff0000, v245
    v_lshlrev_b32 v212, 16, v246
    v_and_b32 v213, 0xffff0000, v246
    v_lshlrev_b32 v214, 16, v247
    v_and_b32 v215, 0xffff0000, v247
    v_pk_fma_f32 v[168:169], v[168:169], v[208:209], v[56:57]
    v_pk_fma_f32 v[170:171], v[170:171], v[210:211], v[58:59]
    v_pk_fma_f32 v[184:185], v[184:185], v[212:213], v[60:61]
    v_pk_fma_f32 v[186:187], v[186:187], v[214:215], v[62:63]
    v_cvt_pk_bf16_f32 v56, v168, v169
    v_cvt_pk_bf16_f32 v57, v170, v171
    v_cvt_pk_bf16_f32 v58, v184, v185
    v_cvt_pk_bf16_f32 v59, v186, v187
    s_add_u32 s4, s101, 32768
    s_waitcnt lgkmcnt(0)
    buffer_store_dwordx4 v[116:119], v15, s[76:79], s4 offen offset:64 sc1
    v_permlane16_swap_b32 v56, v58
    v_permlane16_swap_b32 v57, v59
    ds_bpermute_b32 v56, v13, v56
    v_lshlrev_b32 v216, 16, v252
    ds_bpermute_b32 v57, v13, v57
    v_and_b32 v217, 0xffff0000, v252
    ds_bpermute_b32 v58, v13, v58
    v_lshlrev_b32 v218, 16, v253
    ds_bpermute_b32 v59, v13, v59
    v_and_b32 v219, 0xffff0000, v253
    v_lshlrev_b32 v220, 16, v254
    v_and_b32 v221, 0xffff0000, v254
    v_lshlrev_b32 v222, 16, v255
    v_and_b32 v223, 0xffff0000, v255
    v_pk_fma_f32 v[172:173], v[172:173], v[216:217], v[72:73]
    v_pk_fma_f32 v[174:175], v[174:175], v[218:219], v[74:75]
    v_pk_fma_f32 v[188:189], v[188:189], v[220:221], v[76:77]
    v_pk_fma_f32 v[190:191], v[190:191], v[222:223], v[78:79]
    v_cvt_pk_bf16_f32 v72, v172, v173
    v_cvt_pk_bf16_f32 v73, v174, v175
    v_cvt_pk_bf16_f32 v74, v188, v189
    v_cvt_pk_bf16_f32 v75, v190, v191
    s_add_u32 s4, s101, 65536
    s_waitcnt lgkmcnt(0)
    buffer_store_dwordx4 v[56:59], v15, s[76:79], s4 offen offset:64 sc1
    v_permlane16_swap_b32 v72, v74
    v_permlane16_swap_b32 v73, v75
    ds_bpermute_b32 v72, v13, v72
    ds_bpermute_b32 v73, v13, v73
    ds_bpermute_b32 v74, v13, v74
    ds_bpermute_b32 v75, v13, v75
    s_add_u32 s4, s101, 98304
    s_waitcnt lgkmcnt(0)
    buffer_store_dwordx4 v[72:75], v15, s[76:79], s4 offen offset:64 sc1
L_end:
    s_endpgm
L_q_late:
    s_waitcnt lgkmcnt(0)
    buffer_load_dwordx4 v[224:227], v14, s[28:31], s47 offen offset:0 sc1
    buffer_load_dwordx4 v[232:235], v14, s[28:31], s47 offen offset:2048 sc1
    buffer_load_dwordx4 v[240:243], v14, s[28:31], s5 offen offset:0 sc1
    buffer_load_dwordx4 v[248:251], v14, s[28:31], s5 offen offset:2048 sc1
    buffer_load_dwordx4 v[228:231], v14, s[28:31], s47 offen offset:1024 sc1
    buffer_load_dwordx4 v[236:239], v14, s[28:31], s47 offen offset:3072 sc1
    buffer_load_dwordx4 v[244:247], v14, s[28:31], s5 offen offset:1024 sc1
    buffer_load_dwordx4 v[252:255], v14, s[28:31], s5 offen offset:3072 sc1
    v_mfma_f32_16x16x32_bf16 v[160:163], v[24:27], a[0:3], v[160:163]
    ds_read_b64_tr_b16 v[20:21], v126 offset:32768
    s_waitcnt lgkmcnt(0)
    v_mfma_f32_16x16x32_bf16 v[160:163], v[40:43], a[16:19], v[160:163]
    ds_read_b64_tr_b16 v[22:23], v126 offset:40960
    s_waitcnt lgkmcnt(0)
    v_mfma_f32_16x16x32_bf16 v[160:163], v[28:31], a[32:35], v[160:163]
    ds_read_b64_tr_b16 v[36:37], v126 offset:49152
    s_waitcnt lgkmcnt(0)
    v_mfma_f32_16x16x32_bf16 v[160:163], v[44:47], a[48:51], v[160:163]
    ds_read_b64_tr_b16 v[38:39], v126 offset:57344
    s_waitcnt lgkmcnt(0)
    v_mfma_f32_16x16x32_bf16 v[164:167], v[24:27], a[4:7], v[164:167]
    v_mfma_f32_16x16x32_bf16 v[164:167], v[40:43], a[20:23], v[164:167]
    v_mfma_f32_16x16x32_bf16 v[164:167], v[28:31], a[36:39], v[164:167]
    v_mfma_f32_16x16x32_bf16 v[164:167], v[44:47], a[52:55], v[164:167]
    v_mfma_f32_16x16x32_bf16 v[168:171], v[24:27], a[8:11], v[168:171]
    v_mfma_f32_16x16x32_bf16 v[168:171], v[40:43], a[24:27], v[168:171]
    v_mfma_f32_16x16x32_bf16 v[168:171], v[28:31], a[40:43], v[168:171]
    v_mfma_f32_16x16x32_bf16 v[168:171], v[44:47], a[56:59], v[168:171]
    v_mfma_f32_16x16x32_bf16 v[172:175], v[24:27], a[12:15], v[172:175]
    v_mfma_f32_16x16x32_bf16 v[172:175], v[40:43], a[28:31], v[172:175]
    v_mfma_f32_16x16x32_bf16 v[172:175], v[28:31], a[44:47], v[172:175]
    v_mfma_f32_16x16x32_bf16 v[172:175], v[44:47], a[60:63], v[172:175]
    v_mfma_f32_16x16x32_bf16 v[176:179], v[16:19], a[0:3], v[176:179]
    v_mfma_f32_16x16x32_bf16 v[176:179], v[32:35], a[16:19], v[176:179]
    v_mfma_f32_16x16x32_bf16 v[176:179], v[20:23], a[32:35], v[176:179]
    v_mfma_f32_16x16x32_bf16 v[176:179], v[36:39], a[48:51], v[176:179]
    v_mfma_f32_16x16x32_bf16 v[180:183], v[16:19], a[4:7], v[180:183]
    v_mfma_f32_16x16x32_bf16 v[180:183], v[32:35], a[20:23], v[180:183]
    v_mfma_f32_16x16x32_bf16 v[180:183], v[20:23], a[36:39], v[180:183]
    v_mfma_f32_16x16x32_bf16 v[180:183], v[36:39], a[52:55], v[180:183]
    v_mfma_f32_16x16x32_bf16 v[184:187], v[16:19], a[8:11], v[184:187]
    v_mfma_f32_16x16x32_bf16 v[184:187], v[32:35], a[24:27], v[184:187]
    v_mfma_f32_16x16x32_bf16 v[184:187], v[20:23], a[40:43], v[184:187]
    v_mfma_f32_16x16x32_bf16 v[184:187], v[36:39], a[56:59], v[184:187]
    v_mfma_f32_16x16x32_bf16 v[188:191], v[16:19], a[12:15], v[188:191]
    v_mfma_f32_16x16x32_bf16 v[188:191], v[32:35], a[28:31], v[188:191]
    v_mfma_f32_16x16x32_bf16 v[188:191], v[20:23], a[44:47], v[188:191]
    v_mfma_f32_16x16x32_bf16 v[188:191], v[36:39], a[60:63], v[188:191]
    s_mov_b32 s6, 0x100000
L_g_late2:
    s_waitcnt vmcnt(4)
    v_max3_u32 v2, v224, v225, v226
    v_max3_u32 v7, v227, v232, v233
    v_max3_u32 v2, v234, v235, v2
    v_max3_u32 v7, v240, v241, v7
    v_max3_u32 v2, v242, v243, v2
    v_max3_u32 v7, v248, v249, v7
    v_max3_u32 v2, v250, v251, v2
    v_max_u32 v2, v2, v7
    v_cmp_eq_u32 vcc, -1, v2
    s_cbranch_vccz L_g_done
    s_waitcnt vmcnt(0)
    buffer_load_dwordx4 v[224:227], v14, s[28:31], s47 offen offset:0 sc1
    buffer_load_dwordx4 v[232:235], v14, s[28:31], s47 offen offset:2048 sc1
    buffer_load_dwordx4 v[240:243], v14, s[28:31], s5 offen offset:0 sc1
    buffer_load_dwordx4 v[248:251], v14, s[28:31], s5 offen offset:2048 sc1
    buffer_load_dwordx4 v[228:231], v14, s[28:31], s47 offen offset:1024 sc1
    buffer_load_dwordx4 v[236:239], v14, s[28:31], s47 offen offset:3072 sc1
    buffer_load_dwordx4 v[244:247], v14, s[28:31], s5 offen offset:1024 sc1
    buffer_load_dwordx4 v[252:255], v14, s[28:31], s5 offen offset:3072 sc1
    s_sub_u32 s6, s6, 1
    s_cbranch_scc0 L_g_late2
L_g_done:
    v_lshlrev_b32 v192, 16, v224
    v_and_b32 v193, 0xffff0000, v224
    v_lshlrev_b32 v194, 16, v225
    v_and_b32 v195, 0xffff0000, v225
    v_lshlrev_b32 v196, 16, v226
    v_and_b32 v197, 0xffff0000, v226
    v_lshlrev_b32 v198, 16, v227
    v_and_b32 v199, 0xffff0000, v227
    v_pk_fma_f32 v[128:129], v[128:129], v[192:193], v[80:81]
    v_pk_fma_f32 v[130:131], v[130:131], v[194:195], v[82:83]
    v_pk_fma_f32 v[144:145], v[144:145], v[196:197], v[84:85]
    v_pk_fma_f32 v[146:147], v[146:147], v[198:199], v[86:87]
    v_cvt_pk_bf16_f32 v80, v128, v129
    v_cvt_pk_bf16_f32 v81, v130, v131
    v_cvt_pk_bf16_f32 v82, v144, v145
    v_cvt_pk_bf16_f32 v83, v146, v147
    s_nop 0
    v_permlane16_swap_b32 v80, v82
    v_permlane16_swap_b32 v81, v83
    ds_bpermute_b32 v80, v13, v80
    v_lshlrev_b32 v200, 16, v232
    ds_bpermute_b32 v81, v13, v81
    v_and_b32 v201, 0xffff0000, v232
    ds_bpermute_b32 v82, v13, v82
    v_lshlrev_b32 v202, 16, v233
    ds_bpermute_b32 v83, v13, v83
    v_and_b32 v203, 0xffff0000, v233
    v_lshlrev_b32 v204, 16, v234
    v_and_b32 v205, 0xffff0000, v234
    v_lshlrev_b32 v206, 16, v235
    v_and_b32 v207, 0xffff0000, v235
    v_pk_fma_f32 v[132:133], v[132:133], v[200:201], v[104:105]
    v_pk_fma_f32 v[134:135], v[134:135], v[202:203], v[106:107]
    v_pk_fma_f32 v[148:149], v[148:149], v[204:205], v[108:109]
    v_pk_fma_f32 v[150:151], v[150:151], v[206:207], v[110:111]
    v_cvt_pk_bf16_f32 v104, v132, v133
    v_cvt_pk_bf16_f32 v105, v134, v135
    v_cvt_pk_bf16_f32 v106, v148, v149
    v_cvt_pk_bf16_f32 v107, v150, v151
    s_add_u32 s4, s101, 0
    s_waitcnt lgkmcnt(0)
    buffer_store_dwordx4 v[80:83], v15, s[76:79], s4 offen offset:0 sc1
    v_permlane16_swap_b32 v104, v106
    v_permlane16_swap_b32 v105, v107
    ds_bpermute_b32 v104, v13, v104
    v_lshlrev_b32 v208, 16, v240
    ds_bpermute_b32 v105, v13, v105
    v_and_b32 v209, 0xffff0000, v240
    ds_bpermute_b32 v106, v13, v106
    v_lshlrev_b32 v210, 16, v241
    ds_bpermute_b32 v107, v13, v107
    v_and_b32 v211, 0xffff0000, v241
    v_lshlrev_b32 v212, 16, v242
    v_and_b32 v213, 0xffff0000, v242
    v_lshlrev_b32 v214, 16, v243
    v_and_b32 v215, 0xffff0000, v243
    v_pk_fma_f32 v[136:137], v[136:137], v[208:209], v[48:49]
    v_pk_fma_f32 v[138:139], v[138:139], v[210:211], v[50:51]
    v_pk_fma_f32 v[152:153], v[152:153], v[212:213], v[52:53]
    v_pk_fma_f32 v[154:155], v[154:155], v[214:215], v[54:55]
    v_cvt_pk_bf16_f32 v48, v136, v137
    v_cvt_pk_bf16_f32 v49, v138, v139
    v_cvt_pk_bf16_f32 v50, v152, v153
    v_cvt_pk_bf16_f32 v51, v154, v155
    s_add_u32 s4, s101, 32768
    s_waitcnt lgkmcnt(0)
    buffer_store_dwordx4 v[104:107], v15, s[76:79], s4 offen offset:0 sc1
    v_permlane16_swap_b32 v48, v50
    v_permlane16_swap_b32 v49, v51
    ds_bpermute_b32 v48, v13, v48
    v_lshlrev_b32 v216, 16, v248
    ds_bpermute_b32 v49, v13, v49
    v_and_b32 v217, 0xffff0000, v248
    ds_bpermute_b32 v50, v13, v50
    v_lshlrev_b32 v218, 16, v249
    ds_bpermute_b32 v51, v13, v51
    v_and_b32 v219, 0xffff0000, v249
    v_lshlrev_b32 v220, 16, v250
    v_and_b32 v221, 0xffff0000, v250
    v_lshlrev_b32 v222, 16, v251
    v_and_b32 v223, 0xffff0000, v251
    s_branch L_q_r
L_q_late_r:
    s_mov_b32 s6, 0x100000
L_q_late_r2:
    buffer_load_dwordx4 v[228:231], v14, s[28:31], s47 offen offset:1024 sc1
    buffer_load_dwordx4 v[236:239], v14, s[28:31], s47 offen offset:3072 sc1
    buffer_load_dwordx4 v[244:247], v14, s[28:31], s5 offen offset:1024 sc1
    buffer_load_dwordx4 v[252:255], v14, s[28:31], s5 offen offset:3072 sc1
    s_waitcnt vmcnt(0)
    v_max3_u32 v2, v228, v229, v230
    v_max3_u32 v7, v231, v236, v237
    v_max3_u32 v2, v238, v239, v2
    v_max3_u32 v7, v244, v245, v7
    v_max3_u32 v2, v246, v247, v2
    v_max3_u32 v7, v252, v253, v7
    v_max3_u32 v2, v254, v255, v2
    v_max_u32 v2, v2, v7
    v_cmp_eq_u32 vcc, -1, v2
    s_cbranch_vccz L_q_back_r
    s_sub_u32 s6, s6, 1
    s_cbranch_scc0 L_q_late_r2
    s_branch L_q_back_r
L_c_g:
    v_mfma_f32_16x16x32_bf16 v[128:131], v[16:19], a[0:3], v[128:131]
    ds_read_b64_tr_b16 v[40:41], v125 offset:16384
    v_mfma_f32_16x16x32_bf16 v[128:131], v[32:35], a[16:19], v[128:131]
    ds_read_b64_tr_b16 v[42:43], v125 offset:24576
    v_mfma_f32_16x16x32_bf16 v[132:135], v[16:19], a[4:7], v[132:135]
    v_mfma_f32_16x16x32_bf16 v[132:135], v[32:35], a[20:23], v[132:135]
    v_mfma_f32_16x16x32_bf16 v[136:139], v[16:19], a[8:11], v[136:139]
    s_waitcnt vmcnt(8)
    s_barrier
    v_mfma_f32_16x16x32_bf16 v[136:139], v[32:35], a[24:27], v[136:139]
    ds_read_b128 a[32:35], v101 offset:32768
    v_mfma_f32_16x16x32_bf16 v[140:143], v[16:19], a[12:15], v[140:143]
    ds_read_b128 a[48:51], v101 offset:49152
    v_mfma_f32_16x16x32_bf16 v[140:143], v[32:35], a[28:31], v[140:143]
    s_waitcnt lgkmcnt(6)
    ds_read_b128 a[36:39], v101 offset:33792
    v_mfma_f32_16x16x32_bf16 v[144:147], v[20:23], a[0:3], v[144:147]
    ds_read_b64_tr_b16 v[16:17], v114 offset:32768
    v_mfma_f32_16x16x32_bf16 v[144:147], v[36:39], a[16:19], v[144:147]
    ds_read_b64_tr_b16 v[18:19], v114 offset:40960
    v_mfma_f32_16x16x32_bf16 v[148:151], v[20:23], a[4:7], v[148:151]
    ds_read_b64_tr_b16 v[32:33], v114 offset:49152
    v_mfma_f32_16x16x32_bf16 v[148:151], v[36:39], a[20:23], v[148:151]
    ds_read_b64_tr_b16 v[34:35], v114 offset:57344
    v_mfma_f32_16x16x32_bf16 v[152:155], v[20:23], a[8:11], v[152:155]
    ds_read_b128 a[52:55], v101 offset:50176
    v_mfma_f32_16x16x32_bf16 v[152:155], v[36:39], a[24:27], v[152:155]
    ds_read_b128 a[40:43], v101 offset:36864
    v_mfma_f32_16x16x32_bf16 v[156:159], v[20:23], a[12:15], v[156:159]
    ds_read_b128 a[56:59], v101 offset:53248
    v_mfma_f32_16x16x32_bf16 v[156:159], v[36:39], a[28:31], v[156:159]
    s_waitcnt lgkmcnt(3)
    ds_read_b128 a[44:47], v101 offset:37888
    v_mfma_f32_16x16x32_bf16 v[128:131], v[16:19], a[32:35], v[128:131]
    ds_read_b128 a[60:63], v101 offset:54272
    v_mfma_f32_16x16x32_bf16 v[128:131], v[32:35], a[48:51], v[128:131]
    s_waitcnt lgkmcnt(4)
    ds_read_b64_tr_b16 v[20:21], v124 offset:32768
    v_mfma_f32_16x16x32_bf16 v[132:135], v[16:19], a[36:39], v[132:135]
    ds_read_b64_tr_b16 v[22:23], v124 offset:40960
    v_mfma_f32_16x16x32_bf16 v[132:135], v[32:35], a[52:55], v[132:135]
    s_waitcnt lgkmcnt(4)
    ds_read_b64_tr_b16 v[36:37], v124 offset:49152
    v_mfma_f32_16x16x32_bf16 v[136:139], v[16:19], a[40:43], v[136:139]
    ds_read_b64_tr_b16 v[38:39], v124 offset:57344
    v_mfma_f32_16x16x32_bf16 v[136:139], v[32:35], a[56:59], v[136:139]
    s_waitcnt lgkmcnt(4)
    ds_read_b64_tr_b16 v[28:29], v125 offset:32768
    v_mfma_f32_16x16x32_bf16 v[140:143], v[16:19], a[44:47], v[140:143]
    ds_read_b64_tr_b16 v[30:31], v125 offset:40960
    v_mfma_f32_16x16x32_bf16 v[140:143], v[32:35], a[60:63], v[140:143]
    s_waitcnt lgkmcnt(2)
    ds_read_b64_tr_b16 v[44:45], v125 offset:49152
    v_mfma_f32_16x16x32_bf16 v[144:147], v[20:23], a[32:35], v[144:147]
    ds_read_b64_tr_b16 v[46:47], v125 offset:57344
    v_mfma_f32_16x16x32_bf16 v[144:147], v[36:39], a[48:51], v[144:147]
    ds_read_b64_tr_b16 v[16:17], v126 offset:0
    v_mfma_f32_16x16x32_bf16 v[148:151], v[20:23], a[36:39], v[148:151]
    ds_read_b64_tr_b16 v[18:19], v126 offset:8192
    v_mfma_f32_16x16x32_bf16 v[148:151], v[36:39], a[52:55], v[148:151]
    ds_read_b64_tr_b16 v[32:33], v126 offset:16384
    v_mfma_f32_16x16x32_bf16 v[152:155], v[20:23], a[40:43], v[152:155]
    ds_read_b64_tr_b16 v[34:35], v126 offset:24576
    v_mfma_f32_16x16x32_bf16 v[152:155], v[36:39], a[56:59], v[152:155]
    v_mfma_f32_16x16x32_bf16 v[156:159], v[20:23], a[44:47], v[156:159]
    v_mfma_f32_16x16x32_bf16 v[156:159], v[36:39], a[60:63], v[156:159]
    s_waitcnt lgkmcnt(4)
    v_mfma_f32_16x16x32_bf16 v[160:163], v[24:27], a[0:3], v[160:163]
    ds_read_b64_tr_b16 v[20:21], v126 offset:32768
    v_mul_f32 v192, v128, v52
    v_mfma_f32_16x16x32_bf16 v[160:163], v[40:43], a[16:19], v[160:163]
    ds_read_b64_tr_b16 v[22:23], v126 offset:40960
    v_mul_f32 v193, v129, v52
    v_mfma_f32_16x16x32_bf16 v[160:163], v[28:31], a[32:35], v[160:163]
    ds_read_b64_tr_b16 v[36:37], v126 offset:49152
    v_mul_f32 v194, v130, v52
    v_mfma_f32_16x16x32_bf16 v[160:163], v[44:47], a[48:51], v[160:163]
    ds_read_b64_tr_b16 v[38:39], v126 offset:57344
    v_mul_f32 v195, v131, v52
    v_mfma_f32_16x16x32_bf16 v[164:167], v[24:27], a[4:7], v[164:167]
    v_mul_f32 v196, v144, v52
    v_mul_f32 v197, v145, v52
    v_mfma_f32_16x16x32_bf16 v[164:167], v[40:43], a[20:23], v[164:167]
    v_mul_f32 v198, v146, v52
    v_mul_f32 v199, v147, v52
    v_mfma_f32_16x16x32_bf16 v[164:167], v[28:31], a[36:39], v[164:167]
    v_exp_f32 v192, v192
    v_mfma_f32_16x16x32_bf16 v[164:167], v[44:47], a[52:55], v[164:167]
    v_exp_f32 v193, v193
    v_mfma_f32_16x16x32_bf16 v[168:171], v[24:27], a[8:11], v[168:171]
    v_exp_f32 v194, v194
    v_mfma_f32_16x16x32_bf16 v[168:171], v[40:43], a[24:27], v[168:171]
    v_exp_f32 v195, v195
    v_mfma_f32_16x16x32_bf16 v[168:171], v[28:31], a[40:43], v[168:171]
    v_exp_f32 v196, v196
    v_mfma_f32_16x16x32_bf16 v[168:171], v[44:47], a[56:59], v[168:171]
    v_exp_f32 v197, v197
    v_mfma_f32_16x16x32_bf16 v[172:175], v[24:27], a[12:15], v[172:175]
    v_exp_f32 v198, v198
    v_mfma_f32_16x16x32_bf16 v[172:175], v[40:43], a[28:31], v[172:175]
    v_exp_f32 v199, v199
    v_mfma_f32_16x16x32_bf16 v[172:175], v[28:31], a[44:47], v[172:175]
    v_fma_f32 v192, v192, v48, v48
    v_fma_f32 v193, v193, v48, v48
    v_mfma_f32_16x16x32_bf16 v[172:175], v[44:47], a[60:63], v[172:175]
    s_waitcnt lgkmcnt(0)
    v_fma_f32 v194, v194, v48, v48
    v_fma_f32 v195, v195, v48, v48
    v_mfma_f32_16x16x32_bf16 v[176:179], v[16:19], a[0:3], v[176:179]
    v_fma_f32 v196, v196, v48, v48
    v_fma_f32 v197, v197, v48, v48
    v_mfma_f32_16x16x32_bf16 v[176:179], v[32:35], a[16:19], v[176:179]
    v_fma_f32 v198, v198, v48, v48
    v_fma_f32 v199, v199, v48, v48
    v_mfma_f32_16x16x32_bf16 v[176:179], v[20:23], a[32:35], v[176:179]
    v_rcp_f32 v192, v192
    v_mfma_f32_16x16x32_bf16 v[176:179], v[36:39], a[48:51], v[176:179]
    v_rcp_f32 v193, v193
    v_mfma_f32_16x16x32_bf16 v[180:183], v[16:19], a[4:7], v[180:183]
    v_rcp_f32 v194, v194
    v_mfma_f32_16x16x32_bf16 v[180:183], v[32:35], a[20:23], v[180:183]
    v_rcp_f32 v195, v195
    v_mfma_f32_16x16x32_bf16 v[180:183], v[20:23], a[36:39], v[180:183]
    v_rcp_f32 v196, v196
    v_mfma_f32_16x16x32_bf16 v[180:183], v[36:39], a[52:55], v[180:183]
    v_rcp_f32 v197, v197
    v_mfma_f32_16x16x32_bf16 v[184:187], v[16:19], a[8:11], v[184:187]
    v_rcp_f32 v198, v198
    v_mfma_f32_16x16x32_bf16 v[184:187], v[32:35], a[24:27], v[184:187]
    v_rcp_f32 v199, v199
    v_mfma_f32_16x16x32_bf16 v[184:187], v[20:23], a[40:43], v[184:187]
    v_mul_f32 v192, v192, v128
    v_mul_f32 v193, v193, v129
    v_mfma_f32_16x16x32_bf16 v[184:187], v[36:39], a[56:59], v[184:187]
    v_mul_f32 v194, v194, v130
    v_mul_f32 v195, v195, v131
    v_mfma_f32_16x16x32_bf16 v[188:191], v[16:19], a[12:15], v[188:191]
    v_mul_f32 v196, v196, v144
    v_mul_f32 v197, v197, v145
    v_mfma_f32_16x16x32_bf16 v[188:191], v[32:35], a[28:31], v[188:191]
    v_mul_f32 v198, v198, v146
    v_mul_f32 v199, v199, v147
    v_mfma_f32_16x16x32_bf16 v[188:191], v[20:23], a[44:47], v[188:191]
    v_cvt_pk_bf16_f32 v192, v192, v193
    v_cvt_pk_bf16_f32 v193, v194, v195
    v_mfma_f32_16x16x32_bf16 v[188:191], v[36:39], a[60:63], v[188:191]
    v_cvt_pk_bf16_f32 v194, v196, v197
    v_cvt_pk_bf16_f32 v195, v198, v199
    v_min_u32 v192, -2, v192
    v_min_u32 v193, -2, v193
    v_min_u32 v194, -2, v194
    v_min_u32 v195, -2, v195
    s_add_u32 s4, s38, 0
    buffer_store_dwordx4 v[192:195], v14, s[28:31], s4 offen offset:0 sc1
    s_nop 1
    v_pk_mul_f32 v[200:201], v[132:133], v[52:53] op_sel:[0,1] op_sel_hi:[1,1]
    v_pk_mul_f32 v[202:203], v[134:135], v[52:53] op_sel:[0,1] op_sel_hi:[1,1]
    v_pk_mul_f32 v[204:205], v[148:149], v[52:53] op_sel:[0,1] op_sel_hi:[1,1]
    v_pk_mul_f32 v[206:207], v[150:151], v[52:53] op_sel:[0,1] op_sel_hi:[1,1]
    v_exp_f32 v200, v200
    v_exp_f32 v201, v201
    v_exp_f32 v202, v202
    v_exp_f32 v203, v203
    v_exp_f32 v204, v204
    v_exp_f32 v205, v205
    v_exp_f32 v206, v206
    v_exp_f32 v207, v207
    v_pk_fma_f32 v[200:201], v[200:201], v[48:49], v[48:49] op_sel:[0,1,1] op_sel_hi:[1,1,1]
    v_pk_fma_f32 v[202:203], v[202:203], v[48:49], v[48:49] op_sel:[0,1,1] op_sel_hi:[1,1,1]
    v_pk_fma_f32 v[204:205], v[204:205], v[48:49], v[48:49] op_sel:[0,1,1] op_sel_hi:[1,1,1]
    v_pk_fma_f32 v[206:207], v[206:207], v[48:49], v[48:49] op_sel:[0,1,1] op_sel_hi:[1,1,1]
    v_rcp_f32 v200, v200
    v_rcp_f32 v201, v201
    v_rcp_f32 v202, v202
    v_rcp_f32 v203, v203
    v_rcp_f32 v204, v204
    v_rcp_f32 v205, v205
    v_rcp_f32 v206, v206
    v_rcp_f32 v207, v207
    v_pk_mul_f32 v[200:201], v[200:201], v[132:133]
    v_pk_mul_f32 v[202:203], v[202:203], v[134:135]
    v_pk_mul_f32 v[204:205], v[204:205], v[148:149]
    v_pk_mul_f32 v[206:207], v[206:207], v[150:151]
    v_cvt_pk_bf16_f32 v200, v200, v201
    v_cvt_pk_bf16_f32 v201, v202, v203
    v_cvt_pk_bf16_f32 v202, v204, v205
    v_cvt_pk_bf16_f32 v203, v206, v207
    v_min_u32 v200, -2, v200
    v_min_u32 v201, -2, v201
    v_min_u32 v202, -2, v202
    v_min_u32 v203, -2, v203
    s_add_u32 s4, s38, 0
    buffer_store_dwordx4 v[200:203], v14, s[28:31], s4 offen offset:2048 sc1
    v_pk_mul_f32 v[192:193], v[136:137], v[54:55] op_sel:[0,0] op_sel_hi:[1,0]
    v_pk_mul_f32 v[194:195], v[138:139], v[54:55] op_sel:[0,0] op_sel_hi:[1,0]
    v_pk_mul_f32 v[196:197], v[152:153], v[54:55] op_sel:[0,0] op_sel_hi:[1,0]
    v_pk_mul_f32 v[198:199], v[154:155], v[54:55] op_sel:[0,0] op_sel_hi:[1,0]
    v_exp_f32 v192, v192
    v_exp_f32 v193, v193
    v_exp_f32 v194, v194
    v_exp_f32 v195, v195
    v_exp_f32 v196, v196
    v_exp_f32 v197, v197
    v_exp_f32 v198, v198
    v_exp_f32 v199, v199
    v_pk_fma_f32 v[192:193], v[192:193], v[50:51], v[50:51] op_sel:[0,0,0] op_sel_hi:[1,0,0]
    v_pk_fma_f32 v[194:195], v[194:195], v[50:51], v[50:51] op_sel:[0,0,0] op_sel_hi:[1,0,0]
    v_pk_fma_f32 v[196:197], v[196:197], v[50:51], v[50:51] op_sel:[0,0,0] op_sel_hi:[1,0,0]
    v_pk_fma_f32 v[198:199], v[198:199], v[50:51], v[50:51] op_sel:[0,0,0] op_sel_hi:[1,0,0]
    v_rcp_f32 v192, v192
    v_rcp_f32 v193, v193
    v_rcp_f32 v194, v194
    v_rcp_f32 v195, v195
    v_rcp_f32 v196, v196
    v_rcp_f32 v197, v197
    v_rcp_f32 v198, v198
    v_rcp_f32 v199, v199
    v_pk_mul_f32 v[192:193], v[192:193], v[136:137]
    v_pk_mul_f32 v[194:195], v[194:195], v[138:139]
    v_pk_mul_f32 v[196:197], v[196:197], v[152:153]
    v_pk_mul_f32 v[198:199], v[198:199], v[154:155]
    v_cvt_pk_bf16_f32 v192, v192, v193
    v_cvt_pk_bf16_f32 v193, v194, v195
    v_cvt_pk_bf16_f32 v194, v196, v197
    v_cvt_pk_bf16_f32 v195, v198, v199
    v_min_u32 v192, -2, v192
    v_min_u32 v193, -2, v193
    v_min_u32 v194, -2, v194
    v_min_u32 v195, -2, v195
    s_add_u32 s4, s38, 4096
    buffer_store_dwordx4 v[192:195], v14, s[28:31], s4 offen offset:0 sc1
    v_pk_mul_f32 v[200:201], v[140:141], v[54:55] op_sel:[0,1] op_sel_hi:[1,1]
    v_pk_mul_f32 v[202:203], v[142:143], v[54:55] op_sel:[0,1] op_sel_hi:[1,1]
    v_pk_mul_f32 v[204:205], v[156:157], v[54:55] op_sel:[0,1] op_sel_hi:[1,1]
    v_pk_mul_f32 v[206:207], v[158:159], v[54:55] op_sel:[0,1] op_sel_hi:[1,1]
    v_exp_f32 v200, v200
    v_exp_f32 v201, v201
    v_exp_f32 v202, v202
    v_exp_f32 v203, v203
    v_exp_f32 v204, v204
    v_exp_f32 v205, v205
    v_exp_f32 v206, v206
    v_exp_f32 v207, v207
    v_pk_fma_f32 v[200:201], v[200:201], v[50:51], v[50:51] op_sel:[0,1,1] op_sel_hi:[1,1,1]
    v_pk_fma_f32 v[202:203], v[202:203], v[50:51], v[50:51] op_sel:[0,1,1] op_sel_hi:[1,1,1]
    v_pk_fma_f32 v[204:205], v[204:205], v[50:51], v[50:51] op_sel:[0,1,1] op_sel_hi:[1,1,1]
    v_pk_fma_f32 v[206:207], v[206:207], v[50:51], v[50:51] op_sel:[0,1,1] op_sel_hi:[1,1,1]
    v_rcp_f32 v200, v200
    v_rcp_f32 v201, v201
    v_rcp_f32 v202, v202
    v_rcp_f32 v203, v203
    v_rcp_f32 v204, v204
    v_rcp_f32 v205, v205
    v_rcp_f32 v206, v206
    v_rcp_f32 v207, v207
    v_pk_mul_f32 v[200:201], v[200:201], v[140:141]
    v_pk_mul_f32 v[202:203], v[202:203], v[142:143]
    v_pk_mul_f32 v[204:205], v[204:205], v[156:157]
    v_pk_mul_f32 v[206:207], v[206:207], v[158:159]
    v_cvt_pk_bf16_f32 v200, v200, v201
    v_cvt_pk_bf16_f32 v201, v202, v203
    v_cvt_pk_bf16_f32 v202, v204, v205
    v_cvt_pk_bf16_f32 v203, v206, v207
    v_min_u32 v200, -2, v200
    v_min_u32 v201, -2, v201
    v_min_u32 v202, -2, v202
    v_min_u32 v203, -2, v203
    s_add_u32 s4, s38, 4096
    buffer_store_dwordx4 v[200:203], v14, s[28:31], s4 offen offset:2048 sc1
    v_pk_mul_f32 v[192:193], v[160:161], v[52:53] op_sel:[0,0] op_sel_hi:[1,0]
    v_pk_mul_f32 v[194:195], v[162:163], v[52:53] op_sel:[0,0] op_sel_hi:[1,0]
    v_pk_mul_f32 v[196:197], v[176:177], v[52:53] op_sel:[0,0] op_sel_hi:[1,0]
    v_pk_mul_f32 v[198:199], v[178:179], v[52:53] op_sel:[0,0] op_sel_hi:[1,0]
    v_exp_f32 v192, v192
    v_exp_f32 v193, v193
    v_exp_f32 v194, v194
    v_exp_f32 v195, v195
    v_exp_f32 v196, v196
    v_exp_f32 v197, v197
    v_exp_f32 v198, v198
    v_exp_f32 v199, v199
    v_pk_fma_f32 v[192:193], v[192:193], v[48:49], v[48:49] op_sel:[0,0,0] op_sel_hi:[1,0,0]
    v_pk_fma_f32 v[194:195], v[194:195], v[48:49], v[48:49] op_sel:[0,0,0] op_sel_hi:[1,0,0]
    v_pk_fma_f32 v[196:197], v[196:197], v[48:49], v[48:49] op_sel:[0,0,0] op_sel_hi:[1,0,0]
    v_pk_fma_f32 v[198:199], v[198:199], v[48:49], v[48:49] op_sel:[0,0,0] op_sel_hi:[1,0,0]
    v_rcp_f32 v192, v192
    v_rcp_f32 v193, v193
    v_rcp_f32 v194, v194
    v_rcp_f32 v195, v195
    v_rcp_f32 v196, v196
    v_rcp_f32 v197, v197
    v_rcp_f32 v198, v198
    v_rcp_f32 v199, v199
    v_pk_mul_f32 v[192:193], v[192:193], v[160:161]
    v_pk_mul_f32 v[194:195], v[194:195], v[162:163]
    v_pk_mul_f32 v[196:197], v[196:197], v[176:177]
    v_pk_mul_f32 v[198:199], v[198:199], v[178:179]
    v_cvt_pk_bf16_f32 v192, v192, v193
    v_cvt_pk_bf16_f32 v193, v194, v195
    v_cvt_pk_bf16_f32 v194, v196, v197
    v_cvt_pk_bf16_f32 v195, v198, v199
    v_min_u32 v192, -2, v192
    v_min_u32 v193, -2, v193
    v_min_u32 v194, -2, v194
    v_min_u32 v195, -2, v195
    s_add_u32 s4, s38, 0
    buffer_store_dwordx4 v[192:195], v14, s[28:31], s4 offen offset:1024 sc1
    v_pk_mul_f32 v[200:201], v[164:165], v[52:53] op_sel:[0,1] op_sel_hi:[1,1]
    v_pk_mul_f32 v[202:203], v[166:167], v[52:53] op_sel:[0,1] op_sel_hi:[1,1]
    v_pk_mul_f32 v[204:205], v[180:181], v[52:53] op_sel:[0,1] op_sel_hi:[1,1]
    v_pk_mul_f32 v[206:207], v[182:183], v[52:53] op_sel:[0,1] op_sel_hi:[1,1]
    v_exp_f32 v200, v200
    v_exp_f32 v201, v201
    v_exp_f32 v202, v202
    v_exp_f32 v203, v203
    v_exp_f32 v204, v204
    v_exp_f32 v205, v205
    v_exp_f32 v206, v206
    v_exp_f32 v207, v207
    v_pk_fma_f32 v[200:201], v[200:201], v[48:49], v[48:49] op_sel:[0,1,1] op_sel_hi:[1,1,1]
    v_pk_fma_f32 v[202:203], v[202:203], v[48:49], v[48:49] op_sel:[0,1,1] op_sel_hi:[1,1,1]
    v_pk_fma_f32 v[204:205], v[204:205], v[48:49], v[48:49] op_sel:[0,1,1] op_sel_hi:[1,1,1]
    v_pk_fma_f32 v[206:207], v[206:207], v[48:49], v[48:49] op_sel:[0,1,1] op_sel_hi:[1,1,1]
    v_rcp_f32 v200, v200
    v_rcp_f32 v201, v201
    v_rcp_f32 v202, v202
    v_rcp_f32 v203, v203
    v_rcp_f32 v204, v204
    v_rcp_f32 v205, v205
    v_rcp_f32 v206, v206
    v_rcp_f32 v207, v207
    v_pk_mul_f32 v[200:201], v[200:201], v[164:165]
    v_pk_mul_f32 v[202:203], v[202:203], v[166:167]
    v_pk_mul_f32 v[204:205], v[204:205], v[180:181]
    v_pk_mul_f32 v[206:207], v[206:207], v[182:183]
    v_cvt_pk_bf16_f32 v200, v200, v201
    v_cvt_pk_bf16_f32 v201, v202, v203
    v_cvt_pk_bf16_f32 v202, v204, v205
    v_cvt_pk_bf16_f32 v203, v206, v207
    v_min_u32 v200, -2, v200
    v_min_u32 v201, -2, v201
    v_min_u32 v202, -2, v202
    v_min_u32 v203, -2, v203
    s_add_u32 s4, s38, 0
    buffer_store_dwordx4 v[200:203], v14, s[28:31], s4 offen offset:3072 sc1
    v_pk_mul_f32 v[192:193], v[168:169], v[54:55] op_sel:[0,0] op_sel_hi:[1,0]
    v_pk_mul_f32 v[194:195], v[170:171], v[54:55] op_sel:[0,0] op_sel_hi:[1,0]
    v_pk_mul_f32 v[196:197], v[184:185], v[54:55] op_sel:[0,0] op_sel_hi:[1,0]
    v_pk_mul_f32 v[198:199], v[186:187], v[54:55] op_sel:[0,0] op_sel_hi:[1,0]
    v_exp_f32 v192, v192
    v_exp_f32 v193, v193
    v_exp_f32 v194, v194
    v_exp_f32 v195, v195
    v_exp_f32 v196, v196
    v_exp_f32 v197, v197
    v_exp_f32 v198, v198
    v_exp_f32 v199, v199
    v_pk_fma_f32 v[192:193], v[192:193], v[50:51], v[50:51] op_sel:[0,0,0] op_sel_hi:[1,0,0]
    v_pk_fma_f32 v[194:195], v[194:195], v[50:51], v[50:51] op_sel:[0,0,0] op_sel_hi:[1,0,0]
    v_pk_fma_f32 v[196:197], v[196:197], v[50:51], v[50:51] op_sel:[0,0,0] op_sel_hi:[1,0,0]
    v_pk_fma_f32 v[198:199], v[198:199], v[50:51], v[50:51] op_sel:[0,0,0] op_sel_hi:[1,0,0]
    v_rcp_f32 v192, v192
    v_rcp_f32 v193, v193
    v_rcp_f32 v194, v194
    v_rcp_f32 v195, v195
    v_rcp_f32 v196, v196
    v_rcp_f32 v197, v197
    v_rcp_f32 v198, v198
    v_rcp_f32 v199, v199
    v_pk_mul_f32 v[192:193], v[192:193], v[168:169]
    v_pk_mul_f32 v[194:195], v[194:195], v[170:171]
    v_pk_mul_f32 v[196:197], v[196:197], v[184:185]
    v_pk_mul_f32 v[198:199], v[198:199], v[186:187]
    v_cvt_pk_bf16_f32 v192, v192, v193
    v_cvt_pk_bf16_f32 v193, v194, v195
    v_cvt_pk_bf16_f32 v194, v196, v197
    v_cvt_pk_bf16_f32 v195, v198, v199
    v_min_u32 v192, -2, v192
    v_min_u32 v193, -2, v193
    v_min_u32 v194, -2, v194
    v_min_u32 v195, -2, v195
    s_add_u32 s4, s38, 4096
    buffer_store_dwordx4 v[192:195], v14, s[28:31], s4 offen offset:1024 sc1
    v_pk_mul_f32 v[200:201], v[172:173], v[54:55] op_sel:[0,1] op_sel_hi:[1,1]
    v_pk_mul_f32 v[202:203], v[174:175], v[54:55] op_sel:[0,1] op_sel_hi:[1,1]
    v_pk_mul_f32 v[204:205], v[188:189], v[54:55] op_sel:[0,1] op_sel_hi:[1,1]
    v_pk_mul_f32 v[206:207], v[190:191], v[54:55] op_sel:[0,1] op_sel_hi:[1,1]
    v_exp_f32 v200, v200
    v_exp_f32 v201, v201
    v_exp_f32 v202, v202
    v_exp_f32 v203, v203
    v_exp_f32 v204, v204
    v_exp_f32 v205, v205
    v_exp_f32 v206, v206
    v_exp_f32 v207, v207
    v_pk_fma_f32 v[200:201], v[200:201], v[50:51], v[50:51] op_sel:[0,1,1] op_sel_hi:[1,1,1]
    v_pk_fma_f32 v[202:203], v[202:203], v[50:51], v[50:51] op_sel:[0,1,1] op_sel_hi:[1,1,1]
    v_pk_fma_f32 v[204:205], v[204:205], v[50:51], v[50:51] op_sel:[0,1,1] op_sel_hi:[1,1,1]
    v_pk_fma_f32 v[206:207], v[206:207], v[50:51], v[50:51] op_sel:[0,1,1] op_sel_hi:[1,1,1]
    v_rcp_f32 v200, v200
    v_rcp_f32 v201, v201
    v_rcp_f32 v202, v202
    v_rcp_f32 v203, v203
    v_rcp_f32 v204, v204
    v_rcp_f32 v205, v205
    v_rcp_f32 v206, v206
    v_rcp_f32 v207, v207
    v_pk_mul_f32 v[200:201], v[200:201], v[172:173]
    v_pk_mul_f32 v[202:203], v[202:203], v[174:175]
    v_pk_mul_f32 v[204:205], v[204:205], v[188:189]
    v_pk_mul_f32 v[206:207], v[206:207], v[190:191]
    v_cvt_pk_bf16_f32 v200, v200, v201
    v_cvt_pk_bf16_f32 v201, v202, v203
    v_cvt_pk_bf16_f32 v202, v204, v205
    v_cvt_pk_bf16_f32 v203, v206, v207
    v_min_u32 v200, -2, v200
    v_min_u32 v201, -2, v201
    v_min_u32 v202, -2, v202
    v_min_u32 v203, -2, v203
    s_add_u32 s4, s38, 4096
    buffer_store_dwordx4 v[200:203], v14, s[28:31], s4 offen offset:3072 sc1
    s_endpgm
L_cnt_wait:
    s_mov_b32 s7, 0x100000
L_cnt_wait2:
    buffer_load_dword v2, v9, s[80:83], 0 offen sc1
    s_waitcnt vmcnt(0)
    v_cmp_eq_u32 vcc, 32, v2
    s_nop 0
    s_and_b32 s4, vcc_lo, 0xff
    s_cmp_eq_u32 s4, 0xff
    s_cbranch_scc1 L_cnt_ok
    s_sub_u32 s7, s7, 1
    s_cbranch_scc0 L_cnt_wait2
    s_branch L_cnt_ok
L_st_wait:
    s_mov_b32 s6, 0x100000
L_st_wait2:
    buffer_load_dword v7, v127, s[80:83], 0 offen sc1
    s_waitcnt vmcnt(0)
    v_cmp_ne_u32 vcc, v7, v5
    s_cbranch_vccz L_st_ok
    s_sub_u32 s6, s6, 1
    s_cbranch_scc0 L_st_wait2
    s_branch L_st_ok
L_rare_0:
    s_waitcnt vmcnt(0) lgkmcnt(0)
    s_nop 15
    v_and_b32 v160, 15, v6
    v_lshrrev_b32 v161, 4, v6
    v_lshlrev_b32 v0, 8, v160
    v_lshl_add_u32 v0, v161, 4, v0
    v_lshlrev_b32 v7, 1, v160
    v_lshl_add_u32 v7, v161, 10, v7
    v_mov_b32 v116, 0xff800000
    v_mov_b32 v117, 0xff800000
    v_mov_b32 v118, 0xff800000
    v_mov_b32 v119, 0xff800000
    s_mov_b32 s4, 0
L_fb_max:
    s_add_u32 s5, s4, 4096
    buffer_load_dwordx4 a[192:195], v0, s[20:23], s4 offen offset:0
    buffer_load_dwordx4 a[196:199], v0, s[20:23], s4 offen offset:64
    buffer_load_dwordx4 a[200:203], v0, s[20:23], s4 offen offset:128
    buffer_load_dwordx4 a[204:207], v0, s[20:23], s4 offen offset:192
    buffer_load_dwordx4 a[208:211], v0, s[20:23], s5 offen offset:0
    buffer_load_dwordx4 a[212:215], v0, s[20:23], s5 offen offset:64
    buffer_load_dwordx4 a[216:219], v0, s[20:23], s5 offen offset:128
    buffer_load_dwordx4 a[220:223], v0, s[20:23], s5 offen offset:192
    s_waitcnt vmcnt(0)
    v_mfma_f32_16x16x32_bf16 v[160:163], a[192:195], v[32:35], 0
    v_mfma_f32_16x16x32_bf16 v[160:163], a[196:199], v[36:39], v[160:163]
    v_mfma_f32_16x16x32_bf16 v[160:163], a[200:203], v[40:43], v[160:163]
    v_mfma_f32_16x16x32_bf16 v[160:163], a[204:207], v[44:47], v[160:163]
    v_mfma_f32_16x16x32_bf16 v[164:167], a[192:195], v[48:51], 0
    v_mfma_f32_16x16x32_bf16 v[164:167], a[196:199], v[52:55], v[164:167]
    v_mfma_f32_16x16x32_bf16 v[164:167], a[200:203], v[56:59], v[164:167]
    v_mfma_f32_16x16x32_bf16 v[164:167], a[204:207], v[60:63], v[164:167]
    v_mfma_f32_16x16x32_bf16 v[168:171], a[192:195], v[64:67], 0
    v_mfma_f32_16x16x32_bf16 v[168:171], a[196:199], v[68:71], v[168:171]
    v_mfma_f32_16x16x32_bf16 v[168:171], a[200:203], v[72:75], v[168:171]
    v_mfma_f32_16x16x32_bf16 v[168:171], a[204:207], v[76:79], v[168:171]
    v_mfma_f32_16x16x32_bf16 v[172:175], a[192:195], v[80:83], 0
    v_mfma_f32_16x16x32_bf16 v[172:175], a[196:199], v[84:87], v[172:175]
    v_mfma_f32_16x16x32_bf16 v[172:175], a[200:203], v[88:91], v[172:175]
    v_mfma_f32_16x16x32_bf16 v[172:175], a[204:207], v[92:95], v[172:175]
    v_mfma_f32_16x16x32_bf16 v[176:179], a[208:211], v[32:35], 0
    v_mfma_f32_16x16x32_bf16 v[176:179], a[212:215], v[36:39], v[176:179]
    v_mfma_f32_16x16x32_bf16 v[176:179], a[216:219], v[40:43], v[176:179]
    v_mfma_f32_16x16x32_bf16 v[176:179], a[220:223], v[44:47], v[176:179]
    v_mfma_f32_16x16x32_bf16 v[180:183], a[208:211], v[48:51], 0
    v_mfma_f32_16x16x32_bf16 v[180:183], a[212:215], v[52:55], v[180:183]
    v_mfma_f32_16x16x32_bf16 v[180:183], a[216:219], v[56:59], v[180:183]
    v_mfma_f32_16x16x32_bf16 v[180:183], a[220:223], v[60:63], v[180:183]
    v_mfma_f32_16x16x32_bf16 v[184:187], a[208:211], v[64:67], 0
    v_mfma_f32_16x16x32_bf16 v[184:187], a[212:215], v[68:71], v[184:187]
    v_mfma_f32_16x16x32_bf16 v[184:187], a[216:219], v[72:75], v[184:187]
    v_mfma_f32_16x16x32_bf16 v[184:187], a[220:223], v[76:79], v[184:187]
    v_mfma_f32_16x16x32_bf16 v[188:191], a[208:211], v[80:83], 0
    v_mfma_f32_16x16x32_bf16 v[188:191], a[212:215], v[84:87], v[188:191]
    v_mfma_f32_16x16x32_bf16 v[188:191], a[216:219], v[88:91], v[188:191]
    v_mfma_f32_16x16x32_bf16 v[188:191], a[220:223], v[92:95], v[188:191]
    s_nop 7
    v_max3_f32 v116, v116, v160, v161
    v_max3_f32 v116, v116, v162, v163
    v_max3_f32 v116, v116, v176, v177
    v_max3_f32 v116, v116, v178, v179
    v_max3_f32 v117, v117, v164, v165
    v_max3_f32 v117, v117, v166, v167
    v_max3_f32 v117, v117, v180, v181
    v_max3_f32 v117, v117, v182, v183
    v_max3_f32 v118, v118, v168, v169
    v_max3_f32 v118, v118, v170, v171
    v_max3_f32 v118, v118, v184, v185
    v_max3_f32 v118, v118, v186, v187
    v_max3_f32 v119, v119, v172, v173
    v_max3_f32 v119, v119, v174, v175
    v_max3_f32 v119, v119, v188, v189
    v_max3_f32 v119, v119, v190, v191
    s_add_u32 s4, s4, 8192
    s_cmp_lt_u32 s4, 524288
    s_cbranch_scc1 L_fb_max
    v_mov_b32 v120, v116
    v_mov_b32 v121, v117
    v_mov_b32 v122, v118
    v_mov_b32 v123, v119
    v_permlane32_swap_b32 v116, v120
    v_permlane32_swap_b32 v117, v121
    v_permlane32_swap_b32 v118, v122
    v_permlane32_swap_b32 v119, v123
    v_max_f32 v116, v116, v120
    v_max_f32 v117, v117, v121
    v_max_f32 v118, v118, v122
    v_max_f32 v119, v119, v123
    v_mov_b32 v120, v116
    v_mov_b32 v121, v117
    v_mov_b32 v122, v118
    v_mov_b32 v123, v119
    v_permlane16_swap_b32 v116, v120
    v_permlane16_swap_b32 v117, v121
    v_permlane16_swap_b32 v118, v122
    v_permlane16_swap_b32 v119, v123
    v_max_f32 v116, v116, v120
    v_max_f32 v117, v117, v121
    v_max_f32 v118, v118, v122
    v_max_f32 v119, v119, v123
    v_sub_f32 v16, 0, v116
    v_sub_f32 v17, 0, v116
    v_sub_f32 v18, 0, v116
    v_sub_f32 v19, 0, v116
    v_sub_f32 v20, 0, v117
    v_sub_f32 v21, 0, v117
    v_sub_f32 v22, 0, v117
    v_sub_f32 v23, 0, v117
    v_sub_f32 v24, 0, v118
    v_sub_f32 v25, 0, v118
    v_sub_f32 v26, 0, v118
    v_sub_f32 v27, 0, v118
    v_sub_f32 v28, 0, v119
    v_sub_f32 v29, 0, v119
    v_sub_f32 v30, 0, v119
    v_sub_f32 v31, 0, v119
    v_mov_b32 v120, 0x3f803f80
    v_mov_b32 v121, 0x3f803f80
    v_mov_b32 v122, 0x3f803f80
    v_mov_b32 v123, 0x3f803f80
    v_accvgpr_write_b32 a0, 0
    v_accvgpr_write_b32 a1, 0
    v_accvgpr_write_b32 a2, 0
    v_accvgpr_write_b32 a3, 0
    v_accvgpr_write_b32 a4, 0
    v_accvgpr_write_b32 a5, 0
    v_accvgpr_write_b32 a6, 0
    v_accvgpr_write_b32 a7, 0
    v_accvgpr_write_b32 a8, 0
    v_accvgpr_write_b32 a9, 0
    v_accvgpr_write_b32 a10, 0
    v_accvgpr_write_b32 a11, 0
    v_accvgpr_write_b32 a12, 0
    v_accvgpr_write_b32 a13, 0
    v_accvgpr_write_b32 a14, 0
    v_accvgpr_write_b32 a15, 0
    v_accvgpr_write_b32 a16, 0
    v_accvgpr_write_b32 a17, 0
    v_accvgpr_write_b32 a18, 0
    v_accvgpr_write_b32 a19, 0
    v_accvgpr_write_b32 a20, 0
    v_accvgpr_write_b32 a21, 0
    v_accvgpr_write_b32 a22, 0
    v_accvgpr_write_b32 a23, 0
    v_accvgpr_write_b32 a24, 0
    v_accvgpr_write_b32 a25, 0
    v_accvgpr_write_b32 a26, 0
    v_accvgpr_write_b32 a27, 0
    v_accvgpr_write_b32 a28, 0
    v_accvgpr_write_b32 a29, 0
    v_accvgpr_write_b32 a30, 0
    v_accvgpr_write_b32 a31, 0
    v_accvgpr_write_b32 a32, 0
    v_accvgpr_write_b32 a33, 0
    v_accvgpr_write_b32 a34, 0
    v_accvgpr_write_b32 a35, 0
    v_accvgpr_write_b32 a36, 0
    v_accvgpr_write_b32 a37, 0
    v_accvgpr_write_b32 a38, 0
    v_accvgpr_write_b32 a39, 0
    v_accvgpr_write_b32 a40, 0
    v_accvgpr_write_b32 a41, 0
    v_accvgpr_write_b32 a42, 0
    v_accvgpr_write_b32 a43, 0
    v_accvgpr_write_b32 a44, 0
    v_accvgpr_write_b32 a45, 0
    v_accvgpr_write_b32 a46, 0
    v_accvgpr_write_b32 a47, 0
    v_accvgpr_write_b32 a48, 0
    v_accvgpr_write_b32 a49, 0
    v_accvgpr_write_b32 a50, 0
    v_accvgpr_write_b32 a51, 0
    v_accvgpr_write_b32 a52, 0
    v_accvgpr_write_b32 a53, 0
    v_accvgpr_write_b32 a54, 0
    v_accvgpr_write_b32 a55, 0
    v_accvgpr_write_b32 a56, 0
    v_accvgpr_write_b32 a57, 0
    v_accvgpr_write_b32 a58, 0
    v_accvgpr_write_b32 a59, 0
    v_accvgpr_write_b32 a60, 0
    v_accvgpr_write_b32 a61, 0
    v_accvgpr_write_b32 a62, 0
    v_accvgpr_write_b32 a63, 0
    v_accvgpr_write_b32 a64, 0
    v_accvgpr_write_b32 a65, 0
    v_accvgpr_write_b32 a66, 0
    v_accvgpr_write_b32 a67, 0
    v_accvgpr_write_b32 a68, 0
    v_accvgpr_write_b32 a69, 0
    v_accvgpr_write_b32 a70, 0
    v_accvgpr_write_b32 a71, 0
    v_accvgpr_write_b32 a72, 0
    v_accvgpr_write_b32 a73, 0
    v_accvgpr_write_b32 a74, 0
    v_accvgpr_write_b32 a75, 0
    v_accvgpr_write_b32 a76, 0
    v_accvgpr_write_b32 a77, 0
    v_accvgpr_write_b32 a78, 0
    v_accvgpr_write_b32 a79, 0
    v_accvgpr_write_b32 a80, 0
    v_accvgpr_write_b32 a81, 0
    v_accvgpr_write_b32 a82, 0
    v_accvgpr_write_b32 a83, 0
    v_accvgpr_write_b32 a84, 0
    v_accvgpr_write_b32 a85, 0
    v_accvgpr_write_b32 a86, 0
    v_accvgpr_write_b32 a87, 0
    v_accvgpr_write_b32 a88, 0
    v_accvgpr_write_b32 a89, 0
    v_accvgpr_write_b32 a90, 0
    v_accvgpr_write_b32 a91, 0
    v_accvgpr_write_b32 a92, 0
    v_accvgpr_write_b32 a93, 0
    v_accvgpr_write_b32 a94, 0
    v_accvgpr_write_b32 a95, 0
    v_accvgpr_write_b32 a96, 0
    v_accvgpr_write_b32 a97, 0
    v_accvgpr_write_b32 a98, 0
    v_accvgpr_write_b32 a99, 0
    v_accvgpr_write_b32 a100, 0
    v_accvgpr_write_b32 a101, 0
    v_accvgpr_write_b32 a102, 0
    v_accvgpr_write_b32 a103, 0
    v_accvgpr_write_b32 a104, 0
    v_accvgpr_write_b32 a105, 0
    v_accvgpr_write_b32 a106, 0
    v_accvgpr_write_b32 a107, 0
    v_accvgpr_write_b32 a108, 0
    v_accvgpr_write_b32 a109, 0
    v_accvgpr_write_b32 a110, 0
    v_accvgpr_write_b32 a111, 0
    v_accvgpr_write_b32 a112, 0
    v_accvgpr_write_b32 a113, 0
    v_accvgpr_write_b32 a114, 0
    v_accvgpr_write_b32 a115, 0
    v_accvgpr_write_b32 a116, 0
    v_accvgpr_write_b32 a117, 0
    v_accvgpr_write_b32 a118, 0
    v_accvgpr_write_b32 a119, 0
    v_accvgpr_write_b32 a120, 0
    v_accvgpr_write_b32 a121, 0
    v_accvgpr_write_b32 a122, 0
    v_accvgpr_write_b32 a123, 0
    v_accvgpr_write_b32 a124, 0
    v_accvgpr_write_b32 a125, 0
    v_accvgpr_write_b32 a126, 0
    v_accvgpr_write_b32 a127, 0
    v_accvgpr_write_b32 a144, 0
    v_accvgpr_write_b32 a145, 0
    v_accvgpr_write_b32 a146, 0
    v_accvgpr_write_b32 a147, 0
    v_accvgpr_write_b32 a148, 0
    v_accvgpr_write_b32 a149, 0
    v_accvgpr_write_b32 a150, 0
    v_accvgpr_write_b32 a151, 0
    v_accvgpr_write_b32 a152, 0
    v_accvgpr_write_b32 a153, 0
    v_accvgpr_write_b32 a154, 0
    v_accvgpr_write_b32 a155, 0
    v_accvgpr_write_b32 a156, 0
    v_accvgpr_write_b32 a157, 0
    v_accvgpr_write_b32 a158, 0
    v_accvgpr_write_b32 a159, 0
    s_mov_b32 s4, 0
L_fb_pv:
    s_add_u32 s5, s4, 4096
    buffer_load_dwordx4 a[192:195], v0, s[20:23], s4 offen offset:0
    buffer_load_dwordx4 a[196:199], v0, s[20:23], s4 offen offset:64
    buffer_load_dwordx4 a[200:203], v0, s[20:23], s4 offen offset:128
    buffer_load_dwordx4 a[204:207], v0, s[20:23], s4 offen offset:192
    buffer_load_dwordx4 a[208:211], v0, s[20:23], s5 offen offset:0
    buffer_load_dwordx4 a[212:215], v0, s[20:23], s5 offen offset:64
    buffer_load_dwordx4 a[216:219], v0, s[20:23], s5 offen offset:128
    buffer_load_dwordx4 a[220:223], v0, s[20:23], s5 offen offset:192
    s_waitcnt vmcnt(0)
    v_mfma_f32_16x16x32_bf16 v[160:163], a[192:195], v[32:35], v[16:19]
    v_mfma_f32_16x16x32_bf16 v[160:163], a[196:199], v[36:39], v[160:163]
    v_mfma_f32_16x16x32_bf16 v[160:163], a[200:203], v[40:43], v[160:163]
    v_mfma_f32_16x16x32_bf16 v[160:163], a[204:207], v[44:47], v[160:163]
    v_mfma_f32_16x16x32_bf16 v[164:167], a[192:195], v[48:51], v[20:23]
    v_mfma_f32_16x16x32_bf16 v[164:167], a[196:199], v[52:55], v[164:167]
    v_mfma_f32_16x16x32_bf16 v[164:167], a[200:203], v[56:59], v[164:167]
    v_mfma_f32_16x16x32_bf16 v[164:167], a[204:207], v[60:63], v[164:167]
    v_mfma_f32_16x16x32_bf16 v[168:171], a[192:195], v[64:67], v[24:27]
    v_mfma_f32_16x16x32_bf16 v[168:171], a[196:199], v[68:71], v[168:171]
    v_mfma_f32_16x16x32_bf16 v[168:171], a[200:203], v[72:75], v[168:171]
    v_mfma_f32_16x16x32_bf16 v[168:171], a[204:207], v[76:79], v[168:171]
    v_mfma_f32_16x16x32_bf16 v[172:175], a[192:195], v[80:83], v[28:31]
    v_mfma_f32_16x16x32_bf16 v[172:175], a[196:199], v[84:87], v[172:175]
    v_mfma_f32_16x16x32_bf16 v[172:175], a[200:203], v[88:91], v[172:175]
    v_mfma_f32_16x16x32_bf16 v[172:175], a[204:207], v[92:95], v[172:175]
    v_mfma_f32_16x16x32_bf16 v[176:179], a[208:211], v[32:35], v[16:19]
    v_mfma_f32_16x16x32_bf16 v[176:179], a[212:215], v[36:39], v[176:179]
    v_mfma_f32_16x16x32_bf16 v[176:179], a[216:219], v[40:43], v[176:179]
    v_mfma_f32_16x16x32_bf16 v[176:179], a[220:223], v[44:47], v[176:179]
    v_mfma_f32_16x16x32_bf16 v[180:183], a[208:211], v[48:51], v[20:23]
    v_mfma_f32_16x16x32_bf16 v[180:183], a[212:215], v[52:55], v[180:183]
    v_mfma_f32_16x16x32_bf16 v[180:183], a[216:219], v[56:59], v[180:183]
    v_mfma_f32_16x16x32_bf16 v[180:183], a[220:223], v[60:63], v[180:183]
    v_mfma_f32_16x16x32_bf16 v[184:187], a[208:211], v[64:67], v[24:27]
    v_mfma_f32_16x16x32_bf16 v[184:187], a[212:215], v[68:71], v[184:187]
    v_mfma_f32_16x16x32_bf16 v[184:187], a[216:219], v[72:75], v[184:187]
    v_mfma_f32_16x16x32_bf16 v[184:187], a[220:223], v[76:79], v[184:187]
    v_mfma_f32_16x16x32_bf16 v[188:191], a[208:211], v[80:83], v[28:31]
    v_mfma_f32_16x16x32_bf16 v[188:191], a[212:215], v[84:87], v[188:191]
    v_mfma_f32_16x16x32_bf16 v[188:191], a[216:219], v[88:91], v[188:191]
    v_mfma_f32_16x16x32_bf16 v[188:191], a[220:223], v[92:95], v[188:191]
    s_nop 7
    v_exp_f32 v160, v160
    v_exp_f32 v161, v161
    v_exp_f32 v162, v162
    v_exp_f32 v163, v163
    v_exp_f32 v164, v164
    v_exp_f32 v165, v165
    v_exp_f32 v166, v166
    v_exp_f32 v167, v167
    v_exp_f32 v168, v168
    v_exp_f32 v169, v169
    v_exp_f32 v170, v170
    v_exp_f32 v171, v171
    v_exp_f32 v172, v172
    v_exp_f32 v173, v173
    v_exp_f32 v174, v174
    v_exp_f32 v175, v175
    v_exp_f32 v176, v176
    v_exp_f32 v177, v177
    v_exp_f32 v178, v178
    v_exp_f32 v179, v179
    v_exp_f32 v180, v180
    v_exp_f32 v181, v181
    v_exp_f32 v182, v182
    v_exp_f32 v183, v183
    v_exp_f32 v184, v184
    v_exp_f32 v185, v185
    v_exp_f32 v186, v186
    v_exp_f32 v187, v187
    v_exp_f32 v188, v188
    v_exp_f32 v189, v189
    v_exp_f32 v190, v190
    v_exp_f32 v191, v191
    s_nop 0
    v_cvt_pk_bf16_f32 v192, v160, v161
    v_cvt_pk_bf16_f32 v193, v162, v163
    v_cvt_pk_bf16_f32 v194, v176, v177
    v_cvt_pk_bf16_f32 v195, v178, v179
    v_cvt_pk_bf16_f32 v196, v164, v165
    v_cvt_pk_bf16_f32 v197, v166, v167
    v_cvt_pk_bf16_f32 v198, v180, v181
    v_cvt_pk_bf16_f32 v199, v182, v183
    v_cvt_pk_bf16_f32 v200, v168, v169
    v_cvt_pk_bf16_f32 v201, v170, v171
    v_cvt_pk_bf16_f32 v202, v184, v185
    v_cvt_pk_bf16_f32 v203, v186, v187
    v_cvt_pk_bf16_f32 v204, v172, v173
    v_cvt_pk_bf16_f32 v205, v174, v175
    v_cvt_pk_bf16_f32 v206, v188, v189
    v_cvt_pk_bf16_f32 v207, v190, v191
    buffer_load_ushort v208, v7, s[24:27], s4 offen offset:0
    buffer_load_ushort v209, v7, s[24:27], s4 offen offset:256
    buffer_load_ushort v210, v7, s[24:27], s4 offen offset:512
    buffer_load_ushort v211, v7, s[24:27], s4 offen offset:768
    buffer_load_ushort v212, v7, s[24:27], s5 offen offset:0
    buffer_load_ushort v213, v7, s[24:27], s5 offen offset:256
    buffer_load_ushort v214, v7, s[24:27], s5 offen offset:512
    buffer_load_ushort v215, v7, s[24:27], s5 offen offset:768
    buffer_load_ushort v216, v7, s[24:27], s4 offen offset:32
    buffer_load_ushort v217, v7, s[24:27], s4 offen offset:288
    buffer_load_ushort v218, v7, s[24:27], s4 offen offset:544
    buffer_load_ushort v219, v7, s[24:27], s4 offen offset:800
    buffer_load_ushort v220, v7, s[24:27], s5 offen offset:32
    buffer_load_ushort v221, v7, s[24:27], s5 offen offset:288
    buffer_load_ushort v222, v7, s[24:27], s5 offen offset:544
    buffer_load_ushort v223, v7, s[24:27], s5 offen offset:800
    buffer_load_ushort v224, v7, s[24:27], s4 offen offset:64
    buffer_load_ushort v225, v7, s[24:27], s4 offen offset:320
    buffer_load_ushort v226, v7, s[24:27], s4 offen offset:576
    buffer_load_ushort v227, v7, s[24:27], s4 offen offset:832
    buffer_load_ushort v228, v7, s[24:27], s5 offen offset:64
    buffer_load_ushort v229, v7, s[24:27], s5 offen offset:320
    buffer_load_ushort v230, v7, s[24:27], s5 offen offset:576
    buffer_load_ushort v231, v7, s[24:27], s5 offen offset:832
    buffer_load_ushort v232, v7, s[24:27], s4 offen offset:96
    buffer_load_ushort v233, v7, s[24:27], s4 offen offset:352
    buffer_load_ushort v234, v7, s[24:27], s4 offen offset:608
    buffer_load_ushort v235, v7, s[24:27], s4 offen offset:864
    buffer_load_ushort v236, v7, s[24:27], s5 offen offset:96
    buffer_load_ushort v237, v7, s[24:27], s5 offen offset:352
    buffer_load_ushort v238, v7, s[24:27], s5 offen offset:608
    buffer_load_ushort v239, v7, s[24:27], s5 offen offset:864
    s_waitcnt vmcnt(0)
    v_lshl_or_b32 v240, v209, 16, v208
    v_lshl_or_b32 v241, v211, 16, v210
    v_lshl_or_b32 v242, v213, 16, v212
    v_lshl_or_b32 v243, v215, 16, v214
    v_lshl_or_b32 v244, v217, 16, v216
    v_lshl_or_b32 v245, v219, 16, v218
    v_lshl_or_b32 v246, v221, 16, v220
    v_lshl_or_b32 v247, v223, 16, v222
    v_lshl_or_b32 v248, v225, 16, v224
    v_lshl_or_b32 v249, v227, 16, v226
    v_lshl_or_b32 v250, v229, 16, v228
    v_lshl_or_b32 v251, v231, 16, v230
    v_lshl_or_b32 v252, v233, 16, v232
    v_lshl_or_b32 v253, v235, 16, v234
    v_lshl_or_b32 v254, v237, 16, v236
    v_lshl_or_b32 v255, v239, 16, v238
    s_nop 1
    v_mfma_f32_16x16x32_bf16 a[0:3], v[240:243], v[192:195], a[0:3]
    v_mfma_f32_16x16x32_bf16 a[4:7], v[240:243], v[196:199], a[4:7]
    v_mfma_f32_16x16x32_bf16 a[8:11], v[240:243], v[200:203], a[8:11]
    v_mfma_f32_16x16x32_bf16 a[12:15], v[240:243], v[204:207], a[12:15]
    v_mfma_f32_16x16x32_bf16 a[16:19], v[244:247], v[192:195], a[16:19]
    v_mfma_f32_16x16x32_bf16 a[20:23], v[244:247], v[196:199], a[20:23]
    v_mfma_f32_16x16x32_bf16 a[24:27], v[244:247], v[200:203], a[24:27]
    v_mfma_f32_16x16x32_bf16 a[28:31], v[244:247], v[204:207], a[28:31]
    v_mfma_f32_16x16x32_bf16 a[32:35], v[248:251], v[192:195], a[32:35]
    v_mfma_f32_16x16x32_bf16 a[36:39], v[248:251], v[196:199], a[36:39]
    v_mfma_f32_16x16x32_bf16 a[40:43], v[248:251], v[200:203], a[40:43]
    v_mfma_f32_16x16x32_bf16 a[44:47], v[248:251], v[204:207], a[44:47]
    v_mfma_f32_16x16x32_bf16 a[48:51], v[252:255], v[192:195], a[48:51]
    v_mfma_f32_16x16x32_bf16 a[52:55], v[252:255], v[196:199], a[52:55]
    v_mfma_f32_16x16x32_bf16 a[56:59], v[252:255], v[200:203], a[56:59]
    v_mfma_f32_16x16x32_bf16 a[60:63], v[252:255], v[204:207], a[60:63]
    buffer_load_ushort v208, v7, s[24:27], s4 offen offset:128
    buffer_load_ushort v209, v7, s[24:27], s4 offen offset:384
    buffer_load_ushort v210, v7, s[24:27], s4 offen offset:640
    buffer_load_ushort v211, v7, s[24:27], s4 offen offset:896
    buffer_load_ushort v212, v7, s[24:27], s5 offen offset:128
    buffer_load_ushort v213, v7, s[24:27], s5 offen offset:384
    buffer_load_ushort v214, v7, s[24:27], s5 offen offset:640
    buffer_load_ushort v215, v7, s[24:27], s5 offen offset:896
    buffer_load_ushort v216, v7, s[24:27], s4 offen offset:160
    buffer_load_ushort v217, v7, s[24:27], s4 offen offset:416
    buffer_load_ushort v218, v7, s[24:27], s4 offen offset:672
    buffer_load_ushort v219, v7, s[24:27], s4 offen offset:928
    buffer_load_ushort v220, v7, s[24:27], s5 offen offset:160
    buffer_load_ushort v221, v7, s[24:27], s5 offen offset:416
    buffer_load_ushort v222, v7, s[24:27], s5 offen offset:672
    buffer_load_ushort v223, v7, s[24:27], s5 offen offset:928
    buffer_load_ushort v224, v7, s[24:27], s4 offen offset:192
    buffer_load_ushort v225, v7, s[24:27], s4 offen offset:448
    buffer_load_ushort v226, v7, s[24:27], s4 offen offset:704
    buffer_load_ushort v227, v7, s[24:27], s4 offen offset:960
    buffer_load_ushort v228, v7, s[24:27], s5 offen offset:192
    buffer_load_ushort v229, v7, s[24:27], s5 offen offset:448
    buffer_load_ushort v230, v7, s[24:27], s5 offen offset:704
    buffer_load_ushort v231, v7, s[24:27], s5 offen offset:960
    buffer_load_ushort v232, v7, s[24:27], s4 offen offset:224
    buffer_load_ushort v233, v7, s[24:27], s4 offen offset:480
    buffer_load_ushort v234, v7, s[24:27], s4 offen offset:736
    buffer_load_ushort v235, v7, s[24:27], s4 offen offset:992
    buffer_load_ushort v236, v7, s[24:27], s5 offen offset:224
    buffer_load_ushort v237, v7, s[24:27], s5 offen offset:480
    buffer_load_ushort v238, v7, s[24:27], s5 offen offset:736
    buffer_load_ushort v239, v7, s[24:27], s5 offen offset:992
    s_waitcnt vmcnt(0)
    v_lshl_or_b32 v240, v209, 16, v208
    v_lshl_or_b32 v241, v211, 16, v210
    v_lshl_or_b32 v242, v213, 16, v212
    v_lshl_or_b32 v243, v215, 16, v214
    v_lshl_or_b32 v244, v217, 16, v216
    v_lshl_or_b32 v245, v219, 16, v218
    v_lshl_or_b32 v246, v221, 16, v220
    v_lshl_or_b32 v247, v223, 16, v222
    v_lshl_or_b32 v248, v225, 16, v224
    v_lshl_or_b32 v249, v227, 16, v226
    v_lshl_or_b32 v250, v229, 16, v228
    v_lshl_or_b32 v251, v231, 16, v230
    v_lshl_or_b32 v252, v233, 16, v232
    v_lshl_or_b32 v253, v235, 16, v234
    v_lshl_or_b32 v254, v237, 16, v236
    v_lshl_or_b32 v255, v239, 16, v238
    s_nop 1
    v_mfma_f32_16x16x32_bf16 a[64:67], v[240:243], v[192:195], a[64:67]
    v_mfma_f32_16x16x32_bf16 a[68:71], v[240:243], v[196:199], a[68:71]
    v_mfma_f32_16x16x32_bf16 a[72:75], v[240:243], v[200:203], a[72:75]
    v_mfma_f32_16x16x32_bf16 a[76:79], v[240:243], v[204:207], a[76:79]
    v_mfma_f32_16x16x32_bf16 a[80:83], v[244:247], v[192:195], a[80:83]
    v_mfma_f32_16x16x32_bf16 a[84:87], v[244:247], v[196:199], a[84:87]
    v_mfma_f32_16x16x32_bf16 a[88:91], v[244:247], v[200:203], a[88:91]
    v_mfma_f32_16x16x32_bf16 a[92:95], v[244:247], v[204:207], a[92:95]
    v_mfma_f32_16x16x32_bf16 a[96:99], v[248:251], v[192:195], a[96:99]
    v_mfma_f32_16x16x32_bf16 a[100:103], v[248:251], v[196:199], a[100:103]
    v_mfma_f32_16x16x32_bf16 a[104:107], v[248:251], v[200:203], a[104:107]
    v_mfma_f32_16x16x32_bf16 a[108:111], v[248:251], v[204:207], a[108:111]
    v_mfma_f32_16x16x32_bf16 a[112:115], v[252:255], v[192:195], a[112:115]
    v_mfma_f32_16x16x32_bf16 a[116:119], v[252:255], v[196:199], a[116:119]
    v_mfma_f32_16x16x32_bf16 a[120:123], v[252:255], v[200:203], a[120:123]
    v_mfma_f32_16x16x32_bf16 a[124:127], v[252:255], v[204:207], a[124:127]
    v_mfma_f32_16x16x32_bf16 a[144:147], v[120:123], v[192:195], a[144:147]
    v_mfma_f32_16x16x32_bf16 a[148:151], v[120:123], v[196:199], a[148:151]
    v_mfma_f32_16x16x32_bf16 a[152:155], v[120:123], v[200:203], a[152:155]
    v_mfma_f32_16x16x32_bf16 a[156:159], v[120:123], v[204:207], a[156:159]
    s_nop 7
    s_add_u32 s4, s4, 8192
    s_cmp_lt_u32 s4, 524288
    s_cbranch_scc1 L_fb_pv
    s_nop 7
    v_accvgpr_read_b32 v116, a144
    v_accvgpr_read_b32 v117, a148
    v_accvgpr_read_b32 v118, a152
    v_accvgpr_read_b32 v119, a156
    v_mov_b32 v192, 0
    v_mov_b32 v193, 0
    v_mov_b32 v194, 0
    v_mov_b32 v195, 0
    v_mov_b32 v200, 0
    v_mov_b32 v201, 0
    v_mov_b32 v202, 0
    v_mov_b32 v203, 0
    v_mov_b32 v208, 0
    v_mov_b32 v209, 0
    v_mov_b32 v210, 0
    v_mov_b32 v211, 0
    v_mov_b32 v216, 0
    v_mov_b32 v217, 0
    v_mov_b32 v218, 0
    v_mov_b32 v219, 0
    v_mov_b32 v196, 0
    v_mov_b32 v197, 0
    v_mov_b32 v198, 0
    v_mov_b32 v199, 0
    v_mov_b32 v204, 0
    v_mov_b32 v205, 0
    v_mov_b32 v206, 0
    v_mov_b32 v207, 0
    v_mov_b32 v212, 0
    v_mov_b32 v213, 0
    v_mov_b32 v214, 0
    v_mov_b32 v215, 0
    v_mov_b32 v220, 0
    v_mov_b32 v221, 0
    v_mov_b32 v222, 0
    v_mov_b32 v223, 0
    s_cmp_lg_u32 s41, 0
    s_cbranch_scc1 L_back_s
    s_branch L_back_g
.section .rodata,"a"
.p2align 6
.amdhsa_kernel recurrent_scan__mha_block_cached__dense_activation_relu__prompt_kernel
  .amdhsa_next_free_vgpr 512
  .amdhsa_next_free_sgpr 102
  .amdhsa_accum_offset 256
  .amdhsa_group_segment_fixed_size 0
  .amdhsa_kernarg_size 88
  .amdhsa_user_sgpr_count 2
  .amdhsa_user_sgpr_kernarg_segment_ptr 1
  .amdhsa_system_sgpr_workgroup_id_x 1
  .amdhsa_float_denorm_mode_32 3
.end_amdhsa_kernel
```
